```python
import torch

def _softmax(x, axis=-1):
    return torch.softmax(x, dim=axis)
def _gelu(x):
    return torch.nn.functional.gelu(x, approximate="tanh")
def _silu(x):
    return torch.nn.functional.silu(x)
def _sigmoid(x):
    return torch.sigmoid(x)
def _layernorm(x, axis=-1, eps=1e-5):
    m = x.mean(dim=axis, keepdim=True)
    v = x.var(dim=axis, keepdim=True, unbiased=False)
    return (x - m) / torch.sqrt(v + eps)
def _scatter_add(tgt, idx, src, axis=0):
    return tgt.clone().index_add_(axis, idx, src)
def _segment_sum(src, seg, n):
    out = torch.zeros((n,) + src.shape[1:], dtype=src.dtype)
    return out.index_add_(0, seg, src)
def _pad(x, pw):
    flat = tuple(v for pair in reversed(pw) for v in pair)
    return torch.nn.functional.pad(x, flat)

kernel_name = 'parallel_sum__ssm_conv_s5__glu_gated_glu__prompt'

def setup_inputs():

    _w = (lambda a: (lambda t: t.to(torch.bfloat16) if t.is_floating_point() else t)(torch.as_tensor(a)))
    def _A_setup():
        B, S, D = 1, 2048, 640
        P = D
        Lambda_re = -0.5 * (lambda _x: torch.exp(torch.as_tensor(_x)))((lambda *s: torch.randn(*s, dtype=torch.bfloat16) * 0.8)(P))
        Lambda_im = (lambda *s: torch.randn(*s, dtype=torch.bfloat16) * 0.8)(P) * 1.0
        B_re = (lambda *s: torch.randn(*s, dtype=torch.bfloat16) * 0.8)(P, D) * (D ** -0.5)
        B_im = (lambda *s: torch.randn(*s, dtype=torch.bfloat16) * 0.8)(P, D) * (D ** -0.5)
        C_re = (lambda *s: torch.randn(*s, dtype=torch.bfloat16) * 0.8)(D, P) * (P ** -0.5)
        C_im = (lambda *s: torch.randn(*s, dtype=torch.bfloat16) * 0.8)(D, P) * (P ** -0.5)
        log_dt = (lambda *s: torch.randn(*s, dtype=torch.bfloat16) * 0.8)(P) * 0.3 - 2.0
        Dskip = (lambda *s: torch.randn(*s, dtype=torch.bfloat16) * 0.8)(D)
        return {
            "x": _w((lambda *s: torch.randn(*s, dtype=torch.bfloat16) * 0.05)(B, S, D)),
            "Lambda_re": _w(Lambda_re),
            "Lambda_im": _w(Lambda_im),
            "B_re": _w(B_re),
            "B_im": _w(B_im),
            "C_re": _w(C_re),
            "C_im": _w(C_im),
            "log_dt": _w(log_dt),
            "Dskip": _w(Dskip),
        }
    _A_in = _A_setup()

    def _B_setup():
        B, S, D, F = 1, 2048, 640, 1728
        return {
            "x": _w((lambda *s: torch.randn(*s, dtype=torch.bfloat16) * 0.05)(B, S, D)),
            "w_gate": _w((lambda *s: torch.randn(*s, dtype=torch.bfloat16) * 0.05)(D, F)),
            "w_up": _w((lambda *s: torch.randn(*s, dtype=torch.bfloat16) * 0.05)(D, F)),
            "w_down": _w((lambda *s: torch.randn(*s, dtype=torch.bfloat16) * 0.05)(F, D)),
        }
    _B_in = _B_setup()

    return {
        "A_x": _A_in["x"],
        "A_Lambda_re": _A_in["Lambda_re"],
        "A_Lambda_im": _A_in["Lambda_im"],
        "A_B_re": _A_in["B_re"],
        "A_B_im": _A_in["B_im"],
        "A_C_re": _A_in["C_re"],
        "A_C_im": _A_in["C_im"],
        "A_log_dt": _A_in["log_dt"],
        "A_Dskip": _A_in["Dskip"],
        "B_x": _B_in["x"],
        "B_w_gate": _B_in["w_gate"],
        "B_w_up": _B_in["w_up"],
        "B_w_down": _B_in["w_down"],
    }

def reference(A_x, A_Lambda_re, A_Lambda_im, A_B_re, A_B_im, A_C_re, A_C_im, A_log_dt, A_Dskip, B_x, B_w_gate, B_w_up, B_w_down):
    def _A_ref(x, Lambda_re, Lambda_im, B_re, B_im, C_re, C_im, log_dt, Dskip):
        Bsz, L, H = x.shape
        Lam = Lambda_re + 1j * Lambda_im
        Bmat = B_re + 1j * B_im
        Cmat = C_re + 1j * C_im
        dt = torch.exp(log_dt)
        Lam_bar = torch.exp(dt * Lam)
        B_bar = ((Lam_bar - 1.0) / Lam)[:, None] * Bmat
        Bu = torch.einsum("bld,pd->blp", x + 0j, B_bar)
        h = torch.zeros_like(Bu[:, 0, :])
        hs = []
        for t in range(L):
            h = Lam_bar[None, :] * h + Bu[:, t, :]
            hs.append(h)
        hseq = torch.stack(hs, 1)
        y = 2.0 * torch.einsum("blp,dp->bld", hseq, Cmat).real + x * Dskip[None, None, :]
        return y

    def _B_ref(x, w_gate, w_up, w_down):
        g = torch.einsum("bsd,df->bsf", x, w_gate)
        u = torch.einsum("bsd,df->bsf", x, w_up)
        h = _sigmoid(g) * u
        return torch.einsum("bsf,fd->bsd", h, w_down)

    x = A_x
    xn = _layernorm(x, axis=-1)
    return x + _A_ref(xn, A_Lambda_re, A_Lambda_im, A_B_re, A_B_im, A_C_re, A_C_im, A_log_dt, A_Dskip) + _B_ref(xn, B_w_gate, B_w_up, B_w_down)
```

```asm
; @launch grid=(256,1,1) block=(256,1,1) lds=163840
.amdgcn_target "amdgcn-amd-amdhsa--gfx950"
.text
.globl parallel_sum__ssm_conv_s5__glu_gated_glu__prompt_kernel
.p2align 8
.type parallel_sum__ssm_conv_s5__glu_gated_glu__prompt_kernel,@function
parallel_sum__ssm_conv_s5__glu_gated_glu__prompt_kernel:
    s_cmp_ge_u32 s2, 256
    s_cbranch_scc1 L_end
    s_load_dwordx16 s[16:31], s[0:1], 0
    s_load_dwordx16 s[32:47], s[0:1], 64
    v_lshrrev_b32 v2, 6, v0
    v_and_b32 v1, 63, v0
    v_readfirstlane_b32 s3, v2
    s_and_b32 s10, s2, 7
    s_lshr_b32 s11, s2, 3
    s_lshr_b32 s15, s11, 2
    s_lshr_b32 s4, s10, 2
    s_lshl_b32 s4, s4, 3
    s_add_u32 s4, s4, s15
    s_and_b32 s5, s11, 3
    s_lshl_b32 s5, s5, 2
    s_and_b32 s12, s10, 3
    s_add_u32 s5, s5, s12
    s_lshl_b32 s10, s5, 1
    s_sub_u32 s11, s10, 12
    s_min_u32 s13, s5, 9
    s_cmp_ge_u32 s5, 11
    s_cselect_b32 s6, s11, s13
    v_lshrrev_b32 v128, 3, v1
    v_and_b32 v129, 7, v1
    v_lshrrev_b32 v130, 1, v128
    v_xor_b32 v131, v129, v130
    v_lshlrev_b32 v131, 4, v131
    v_and_b32 v132, 3, v128
    v_lshrrev_b32 v133, 2, v128
    v_lshl_add_u32 v132, v133, 4, v132
    v_mul_u32_u24 v132, 1280, v132
    v_add_u32 v3, v132, v131
    v_xor_b32 v4, 64, v3
    v_add_u32 v4, 4096, v4
    v_add_u32 v5, 8192, v3
    v_add_u32 v6, 8192, v4
    s_lshl_b32 s82, s3, 12
    s_lshr_b32 s14, s3, 1
    s_lshl_b32 s15, s14, 7
    s_mul_i32 s91, s6, 40960
    s_add_u32 s10, s91, s15
    s_lshl_b32 s83, s4, 2
    s_add_u32 s83, s83, s3
    s_mul_i32 s83, s83, 40960
    v_and_b32 v136, 31, v1
    s_lshl_b32 s12, s4, 6
    s_lshl_b32 s11, s5, 2
    s_add_u32 s12, s12, s11
    s_add_u32 s12, s12, s3
    v_lshl_add_u32 v139, s12, 1, v133
    v_mul_u32_u24 v138, 1280, v139
    v_lshl_add_u32 v138, v136, 3, v138
    v_mov_b32 v142, 26214400
    s_waitcnt lgkmcnt(0)
    s_mov_b32 s64, s16
    s_mov_b32 s65, s17
    s_mov_b32 s66, 2621440
    s_mov_b32 s67, 0x00020000
    s_and_b32 s14, s3, 1
    s_cselect_b32 s60, s24, s22
    s_cselect_b32 s61, s25, s23
    s_mov_b32 s63, 0x00020000
    s_cmp_eq_u32 s5, 10
    s_cselect_b32 s62, 0, 819200
    buffer_load_dwordx2 v[116:117], v138, s[64:67], 0 offen offset:0
    buffer_load_dwordx2 v[118:119], v138, s[64:67], 0 offen offset:256
    buffer_load_dwordx2 v[120:121], v138, s[64:67], 0 offen offset:512
    buffer_load_dwordx2 v[122:123], v138, s[64:67], 0 offen offset:768
    buffer_load_dwordx2 v[124:125], v138, s[64:67], 0 offen offset:1024
    s_mov_b32 s48, s46
    s_mov_b32 s49, s47
    s_mov_b32 s50, 41943040
    s_mov_b32 s51, 0x00020000
    buffer_load_dword v26, v142, s[48:51], 0 offen sc1
    buffer_load_dword v142, off, s[64:67], 0
    s_getpc_b64 s[14:15]
L_pf_1:
    s_cmp_ge_u32 s5, 11
    s_cselect_b32 s80, L_typeB-L_pf_1, 0
    s_add_u32 s14, s14, s80
    s_addc_u32 s15, s15, 0
    s_and_b32 s80, s4, 7
    s_lshl_b32 s80, s80, 2
    s_add_u32 s80, s80, s3
    s_mul_i32 s80, s80, 1024
    v_lshlrev_b32 v134, 7, v1
    v_add_u32 v134, s80, v134
    v_min_u32 v134, 29400, v134
    v_and_b32 v134, -4, v134
    s_mov_b64 exec, 255
    global_load_dword v251, v134, s[14:15]
    s_mov_b64 exec, -1
    s_add_u32 m0, s82, 0
    s_nop 0
    buffer_load_dwordx4 v3, s[60:63], s10 offen offset:0 lds
    buffer_load_dwordx4 v4, s[60:63], s10 offen offset:1024 lds
    buffer_load_dwordx4 v5, s[60:63], s10 offen offset:2048 lds
    buffer_load_dwordx4 v6, s[60:63], s10 offen offset:3072 lds
    s_add_u32 m0, s82, 81920
    s_nop 0
    buffer_load_dwordx4 v3, s[64:67], s83 offen offset:0 lds
    buffer_load_dwordx4 v4, s[64:67], s83 offen offset:1024 lds
    buffer_load_dwordx4 v5, s[64:67], s83 offen offset:2048 lds
    buffer_load_dwordx4 v6, s[64:67], s83 offen offset:3072 lds
    s_add_u32 s7, s6, 1
    s_bfe_u32 s8, s2, 0x10002
    s_lshl_b32 s8, s8, 3
    s_lshr_b32 s14, s2, 5
    s_add_u32 s8, s8, s14
    s_lshr_b32 s15, s2, 3
    s_mul_i32 s14, s14, 1
    s_add_u32 s15, s15, s14
    s_and_b32 s15, s15, 3
    s_bfe_u32 s9, s2, 0x10001
    s_lshl_b32 s9, s9, 2
    s_add_u32 s9, s9, s15
    v_lshlrev_b32 v131, 3, v139
    v_add_u32 v131, 26218496, v131
    v_cmp_eq_u32 vcc, 0, v136
    v_mov_b32 v139, 1073741824
    v_lshlrev_b32 v20, 4, v1
    v_cndmask_b32 v139, v139, v131, vcc
    v_mul_u32_u24 v132, 1280, v128
    v_lshl_add_u32 v209, v129, 4, v132
    v_and_b32 v130, 1, v130
    v_lshlrev_b32 v130, 2, v130
    v_xor_b32 v131, v129, v130
    v_lshlrev_b32 v131, 4, v131
    v_mul_u32_u24 v132, 3456, v128
    v_add_u32 v7, v132, v131
    v_add_u32 v8, 26624, v7
    v_lshl_add_u32 v248, v129, 4, v132
    s_lshr_b32 s14, s3, 1
    s_lshl_b32 s15, s14, 7
    s_add_u32 s11, s91, s15
    s_add_u32 s11, s11, 40960
    s_lshl_b32 s92, s4, 1
    s_add_u32 s92, s92, s14
    s_bfe_u32 s14, s92, 0x10002
    s_lshl_b32 s14, s14, 4
    s_and_b32 s15, s92, 3
    s_add_u32 s14, s14, s15
    s_lshr_b32 s15, s92, 3
    s_lshl_b32 s15, s15, 2
    s_add_u32 s14, s14, s15
    s_mul_i32 s14, s14, 1280
    s_add_u32 s91, s91, s14
    s_lshl_b32 s92, s92, 4
    s_lshl_b32 s14, s6, 1
    s_add_u32 s14, s14, 108
    s_and_b32 s15, s3, 1
    s_add_u32 s14, s14, s15
    s_lshl_b32 s14, s14, 10
    s_add_u32 s92, s92, s14
    s_cmp_eq_u32 s5, 10
    s_cselect_b32 s92, 1073741824, s92
    s_mul_i32 s14, s3, 55296
    s_lshl_b32 s12, s5, 7
    s_add_u32 s12, s12, s14
    s_add_u32 s13, s12, 2048
    s_lshr_b32 s14, s4, 3
    s_lshl_b32 s14, s14, 4
    s_add_u32 s14, s14, s5
    s_and_b32 s15, s4, 3
    s_lshl_b32 s89, s15, 2
    s_add_u32 s89, s89, s3
    s_mul_i32 s89, s89, 138240
    s_lshl_b32 s90, s14, 7
    s_add_u32 s89, s89, s90
    s_lshl_b32 s90, s14, 12
    s_cmp_ge_u32 s14, 27
    s_cselect_b32 s14, 1073741824, 0
    s_add_u32 s89, s89, s14
    s_cmp_lg_u32 s3, 0
    s_cselect_b32 s14, 1073741824, s14
    s_add_u32 s90, s90, s14
    s_bfe_u32 s14, s4, 0x10002
    s_lshl_b32 s14, s14, 10
    s_add_u32 s90, s90, s14
    s_lshr_b32 s14, s15, 1
    s_lshl_b32 s14, s14, 9
    s_add_u32 s90, s90, s14
    s_and_b32 s14, s15, 1
    s_lshl_b32 s14, s14, 3
    s_add_u32 s90, s90, s14
    v_and_b32 v130, 3, v1
    v_lshl_add_u32 v130, v130, 3, v128
    v_lshlrev_b32 v130, 4, v130
    v_bfe_u32 v131, v1, 2, 1
    v_lshl_add_u32 v249, v131, 11, v130
    s_cmp_eq_u32 s3, 0
    s_cselect_b32 s14, -1, 0
    v_and_b32 v249, s14, v249
    v_lshrrev_b32 v130, 5, v1
    v_lshlrev_b32 v130, 9, v130
    v_bfe_u32 v131, v1, 4, 1
    v_lshl_add_u32 v130, v131, 3, v130
    v_and_b32 v131, 15, v1
    v_cmp_eq_u32 vcc, 0, v131
    v_mov_b32 v140, 1073741824
    v_lshlrev_b32 v250, 2, v1
    v_cndmask_b32 v140, v140, v130, vcc
    v_bfe_u32 v128, v1, 2, 1
    v_bfe_u32 v129, v1, 3, 2
    v_and_b32 v137, 3, v1
    v_lshl_add_u32 v137, v128, 4, v137
    v_lshl_add_u32 v137, v129, 2, v137
    v_lshlrev_b32 v141, 1, v137
    v_lshlrev_b32 v210, 3, v137
    v_mul_u32_u24 v24, 80, v137
    v_lshrrev_b32 v128, 2, v1
    v_and_b32 v129, 3, v1
    v_lshlrev_b32 v129, 2, v129
    v_lshl_add_u32 v128, v128, 9, v129
    s_lshl_b32 s14, s8, 13
    s_lshl_b32 s15, s3, 11
    s_add_u32 s14, s14, s15
    v_add_u32 v128, s14, v128
    v_cmp_gt_u32 vcc, 16, v1
    v_mov_b32 v2, 1073741824
    s_nop 0
    v_cndmask_b32 v2, v2, v128, vcc
    s_lshl_b32 s14, s4, 13
    s_lshl_b32 s15, s5, 9
    s_add_u32 s14, s14, s15
    s_lshl_b32 s15, s3, 2
    s_add_u32 s14, s14, s15
    v_mov_b32 v27, 1073741824
    v_writelane_b32 v27, s14, 0
    v_lshrrev_b32 v128, 5, v1
    v_bfe_u32 v129, v1, 2, 2
    v_lshl_add_u32 v128, v128, 3, v129
    v_lshlrev_b32 v128, 7, v128
    v_bfe_u32 v129, v1, 3, 1
    v_lshl_add_u32 v128, v129, 6, v128
    v_bfe_u32 v129, v1, 4, 1
    v_lshl_add_u32 v128, v129, 5, v128
    v_and_b32 v129, 3, v1
    v_lshl_add_u32 v9, v129, 3, v128
    v_xor_b32 v12, 64, v9
    v_add_u32 v10, 65536, v9
    v_add_u32 v11, 131072, v9
    v_add_u32 v13, 65536, v12
    v_add_u32 v14, 131072, v12
    v_bfe_u32 v128, v1, 1, 3
    v_lshrrev_b32 v129, 5, v1
    v_xor_b32 v128, v128, v129
    v_lshlrev_b32 v128, 4, v128
    v_lshl_add_u32 v15, v136, 7, v128
    v_xor_b32 v16, 32, v15
    v_xor_b32 v17, 64, v15
    v_xor_b32 v18, 96, v15
    s_add_u32 s14, s82, 81920
    v_add_u32 v252, s14, v15
    v_add_u32 v253, s14, v16
    v_add_u32 v254, s14, v17
    v_add_u32 v255, s14, v18
    s_mov_b32 s52, s36
    s_mov_b32 s53, s37
    s_mov_b32 s54, 2211840
    s_mov_b32 s55, 0x00020000
    s_sub_u32 s56, s38, 2048
    s_subb_u32 s57, s39, 0
    s_mov_b32 s58, 2213888
    s_mov_b32 s59, 0x00020000
    s_add_u32 s76, s46, 26345472
    s_addc_u32 s77, s47, 0
    s_mov_b32 s78, 262144
    s_mov_b32 s79, 0x00020000
    s_cmp_ge_u32 s5, 11
    s_cbranch_scc1 L_typeB
    buffer_load_dwordx4 v[168:171], v20, s[60:63], s91 offen
    buffer_load_dword v172, v250, s[60:63], s91 offen offset:1024
    s_lshl_b32 s14, s6, 6
    s_mov_b32 s72, s18
    s_mov_b32 s73, s19
    s_mov_b32 s74, 1280
    s_mov_b32 s75, 0x00020000
    buffer_load_ushort v60, v141, s[72:75], s14 offen
    s_mov_b32 s72, s20
    s_mov_b32 s73, s21
    s_mov_b32 s74, 1280
    s_mov_b32 s75, 0x00020000
    buffer_load_ushort v61, v141, s[72:75], s14 offen
    s_mov_b32 s72, s30
    s_mov_b32 s73, s31
    s_mov_b32 s74, 1280
    s_mov_b32 s75, 0x00020000
    buffer_load_ushort v62, v141, s[72:75], s14 offen
    s_bitcmp1_b32 s4, 2
    s_cselect_b32 s72, s38, s36
    s_cselect_b32 s73, s39, s37
    s_mov_b32 s74, 2211840
    s_mov_b32 s75, 0x00020000
    s_mov_b32 s0, s89
    s_mov_b32 s1, s90
    s_add_u32 m0, s82, 98304
    s_add_u32 s83, s83, 128
    buffer_load_dwordx4 v3, s[64:67], s83 offen offset:0 lds
    buffer_load_dwordx4 v4, s[64:67], s83 offen offset:1024 lds
    buffer_load_dwordx4 v5, s[64:67], s83 offen offset:2048 lds
    buffer_load_dwordx4 v6, s[64:67], s83 offen offset:3072 lds
    s_lshl_b32 s84, s2, 2
    s_add_u32 s84, s84, s3
    s_cmp_ge_u32 s84, 540
    s_cbranch_scc1 L_rt_c_2
    s_mul_i32 s85, s84, 6554
    s_lshr_b32 s85, s85, 16
    s_mul_i32 s86, s85, 10
    s_sub_u32 s86, s84, s86
    s_mov_b32 s68, s40
    s_mov_b32 s69, s41
    s_mov_b32 s70, 2211840
    s_mov_b32 s71, 0x00020000
    s_mul_i32 s40, s85, 40960
    s_lshl_b32 s14, s86, 7
    s_add_u32 s40, s40, s14
    s_mov_b32 s41, 9216
    v_lshrrev_b32 v208, 5, v1
    v_bfe_u32 v192, v1, 4, 1
    v_lshlrev_b32 v192, 2, v192
    v_lshl_add_u32 v208, v208, 4, v192
    v_bfe_u32 v192, v1, 2, 2
    v_add_u32 v208, v208, v192
    v_lshlrev_b32 v208, 7, v208
    v_and_b32 v192, 3, v1
    v_lshl_add_u32 v208, v192, 3, v208
    s_cmp_lt_u32 s85, 22
    s_cselect_b32 s14, 20, 40
    s_add_u32 s85, s85, s14
    s_mul_i32 s85, s85, 5120
    s_add_u32 s85, s85, 20971520
    s_lshl_b32 s14, s86, 2
    s_add_u32 s14, s14, 0
    s_mul_i32 s87, s14, 13108
    s_lshr_b32 s87, s87, 16
    s_mul_i32 s87, s87, 476160
    s_lshl_b32 s14, s14, 10
    s_add_u32 s14, s14, s87
    s_add_u32 s36, s14, s85
    s_lshl_b32 s14, s86, 2
    s_add_u32 s14, s14, 1
    s_mul_i32 s87, s14, 13108
    s_lshr_b32 s87, s87, 16
    s_mul_i32 s87, s87, 476160
    s_lshl_b32 s14, s14, 10
    s_add_u32 s14, s14, s87
    s_add_u32 s37, s14, s85
    s_lshl_b32 s14, s86, 2
    s_add_u32 s14, s14, 2
    s_mul_i32 s87, s14, 13108
    s_lshr_b32 s87, s87, 16
    s_mul_i32 s87, s87, 476160
    s_lshl_b32 s14, s14, 10
    s_add_u32 s14, s14, s87
    s_add_u32 s38, s14, s85
    s_lshl_b32 s14, s86, 2
    s_add_u32 s14, s14, 3
    s_mul_i32 s87, s14, 13108
    s_lshr_b32 s87, s87, 16
    s_mul_i32 s87, s87, 476160
    s_lshl_b32 s14, s14, 10
    s_add_u32 s14, s14, s87
    s_add_u32 s39, s14, s85
    s_branch L_rt_done_3
L_rt_c_2:
    s_sub_u32 s84, s84, 540
    s_cmp_ge_u32 s84, 200
    s_cselect_b32 s85, 1, 0
    s_cselect_b32 s68, s28, s26
    s_cselect_b32 s69, s29, s27
    s_mov_b32 s70, 819200
    s_mov_b32 s71, 0x00020000
    s_mul_i32 s14, s85, 200
    s_sub_u32 s84, s84, s14
    s_mul_i32 s86, s84, 13108
    s_lshr_b32 s86, s86, 16
    s_mul_i32 s14, s86, 5
    s_sub_u32 s87, s84, s14
    s_mul_i32 s40, s86, 20480
    s_lshl_b32 s14, s87, 8
    s_add_u32 s40, s40, s14
    s_mov_b32 s41, 4096
    v_lshrrev_b32 v192, 4, v1
    v_and_b32 v193, 15, v1
    v_mul_u32_u24 v209, 1280, v192
    v_lshlrev_b32 v194, 2, v192
    v_xor_b32 v194, v194, v193
    v_lshl_add_u32 v209, v194, 4, v209
    v_lshlrev_b32 v192, 4, v192
    v_lshl_add_u32 v208, v193, 8, v192
    v_and_b32 v194, 3, v1
    v_lshl_add_u32 v208, v194, 6, v208
    s_mul_i32 s84, s86, 13108
    s_lshr_b32 s84, s84, 16
    s_mul_i32 s84, s84, 476160
    s_lshl_b32 s14, s86, 10
    s_add_u32 s84, s84, s14
    s_lshl_b32 s14, s87, 3
    s_add_u32 s14, s14, s85
    s_mul_i32 s14, s14, 5120
    s_add_u32 s84, s84, s14
    s_cmp_ge_u32 s86, 40
    s_cselect_b32 s14, 1073741824, 20971520
    s_add_u32 s84, s84, s14
    s_cmp_ge_u32 s87, 3
    s_cselect_b32 s14, 112640, 0
    s_add_u32 s36, s84, s14
    s_add_u32 s37, s36, 10240
    s_cmp_ge_u32 s87, 2
    s_cselect_b32 s14, 112640, 0
    s_add_u32 s38, s84, s14
    s_add_u32 s38, s38, 20480
    s_add_u32 s39, s38, 10240
L_rt_done_3:
    s_add_u32 s14, s82, 65536
    v_add_u32 v208, s14, v208
    s_waitcnt vmcnt(20)
    v_lshlrev_b32 v96, 16, v116
    v_and_b32 v97, 0xffff0000, v116
    v_lshlrev_b32 v98, 16, v117
    v_and_b32 v99, 0xffff0000, v117
    v_lshlrev_b32 v100, 16, v118
    v_and_b32 v101, 0xffff0000, v118
    v_lshlrev_b32 v102, 16, v119
    v_and_b32 v103, 0xffff0000, v119
    v_lshlrev_b32 v104, 16, v120
    v_and_b32 v105, 0xffff0000, v120
    v_lshlrev_b32 v106, 16, v121
    v_and_b32 v107, 0xffff0000, v121
    v_lshlrev_b32 v108, 16, v122
    v_and_b32 v109, 0xffff0000, v122
    v_lshlrev_b32 v110, 16, v123
    v_and_b32 v111, 0xffff0000, v123
    v_lshlrev_b32 v112, 16, v124
    v_and_b32 v113, 0xffff0000, v124
    v_lshlrev_b32 v114, 16, v125
    v_and_b32 v115, 0xffff0000, v125
    v_pk_add_f32 v[128:129], v[96:97], v[98:99]
    v_pk_add_f32 v[130:131], v[100:101], v[102:103]
    v_pk_add_f32 v[128:129], v[128:129], v[104:105]
    v_pk_add_f32 v[130:131], v[130:131], v[106:107]
    v_pk_add_f32 v[128:129], v[128:129], v[108:109]
    v_pk_add_f32 v[130:131], v[130:131], v[110:111]
    v_pk_add_f32 v[128:129], v[128:129], v[112:113]
    v_pk_add_f32 v[130:131], v[130:131], v[114:115]
    v_pk_add_f32 v[128:129], v[128:129], v[130:131]
    v_add_f32 v128, v128, v129
    s_nop 1
    v_add_f32_dpp v128, v128, v128 row_ror:8 row_mask:0xf bank_mask:0xf
    s_nop 1
    v_add_f32_dpp v128, v128, v128 row_ror:4 row_mask:0xf bank_mask:0xf
    s_nop 1
    v_add_f32_dpp v128, v128, v128 row_ror:2 row_mask:0xf bank_mask:0xf
    s_nop 1
    v_add_f32_dpp v128, v128, v128 row_ror:1 row_mask:0xf bank_mask:0xf
    v_mov_b32 v129, v128
    s_nop 1
    v_permlane16_swap_b32 v128, v129
    s_nop 0
    v_add_f32 v128, v128, v129
    v_mul_f32 v128, 0xbacccccd, v128
    v_pk_add_f32 v[96:97], v[96:97], v[128:129] op_sel_hi:[1,0]
    v_pk_add_f32 v[98:99], v[98:99], v[128:129] op_sel_hi:[1,0]
    v_pk_add_f32 v[100:101], v[100:101], v[128:129] op_sel_hi:[1,0]
    v_pk_add_f32 v[102:103], v[102:103], v[128:129] op_sel_hi:[1,0]
    v_pk_add_f32 v[104:105], v[104:105], v[128:129] op_sel_hi:[1,0]
    v_pk_add_f32 v[106:107], v[106:107], v[128:129] op_sel_hi:[1,0]
    v_pk_add_f32 v[108:109], v[108:109], v[128:129] op_sel_hi:[1,0]
    v_pk_add_f32 v[110:111], v[110:111], v[128:129] op_sel_hi:[1,0]
    v_pk_add_f32 v[112:113], v[112:113], v[128:129] op_sel_hi:[1,0]
    v_pk_add_f32 v[114:115], v[114:115], v[128:129] op_sel_hi:[1,0]
    v_pk_mul_f32 v[130:131], v[96:97], v[96:97]
    v_pk_mul_f32 v[132:133], v[98:99], v[98:99]
    v_pk_fma_f32 v[130:131], v[100:101], v[100:101], v[130:131]
    v_pk_fma_f32 v[132:133], v[102:103], v[102:103], v[132:133]
    v_pk_fma_f32 v[130:131], v[104:105], v[104:105], v[130:131]
    v_pk_fma_f32 v[132:133], v[106:107], v[106:107], v[132:133]
    v_pk_fma_f32 v[130:131], v[108:109], v[108:109], v[130:131]
    v_pk_fma_f32 v[132:133], v[110:111], v[110:111], v[132:133]
    v_pk_fma_f32 v[130:131], v[112:113], v[112:113], v[130:131]
    v_pk_fma_f32 v[132:133], v[114:115], v[114:115], v[132:133]
    v_pk_add_f32 v[130:131], v[130:131], v[132:133]
    v_add_f32 v130, v130, v131
    s_nop 1
    v_add_f32_dpp v130, v130, v130 row_ror:8 row_mask:0xf bank_mask:0xf
    s_nop 1
    v_add_f32_dpp v130, v130, v130 row_ror:4 row_mask:0xf bank_mask:0xf
    s_nop 1
    v_add_f32_dpp v130, v130, v130 row_ror:2 row_mask:0xf bank_mask:0xf
    s_nop 1
    v_add_f32_dpp v130, v130, v130 row_ror:1 row_mask:0xf bank_mask:0xf
    v_mov_b32 v131, v130
    s_nop 1
    v_permlane16_swap_b32 v130, v131
    s_nop 0
    v_add_f32 v130, v130, v131
    v_mul_f32 v130, 0x3acccccd, v130
    v_cvt_pk_bf16_f32 v130, v130, v130
    v_lshlrev_b32 v130, 16, v130
    v_add_f32 v130, 0x3727c5ac, v130
    v_cvt_pk_bf16_f32 v130, v130, v130
    v_lshlrev_b32 v130, 16, v130
    v_sqrt_f32 v130, v130
    s_waitcnt vmcnt(18)
    v_lshl_add_u32 v26, v142, 1, v26
    v_add_u32 v26, 2654435769, v26
    v_and_b32 v26, 0xbfffbfff, v26
    v_mov_b32 v129, v26
    v_cvt_pk_bf16_f32 v128, v128, v130
    buffer_store_dwordx2 v[128:129], v139, s[48:51], 0 offen sc1
    s_add_u32 m0, s82, 16384
    s_add_u32 s10, s10, 256
    buffer_load_dwordx4 v3, s[60:63], s10 offen offset:0 lds
    buffer_load_dwordx4 v4, s[60:63], s10 offen offset:1024 lds
    buffer_load_dwordx4 v5, s[60:63], s10 offen offset:2048 lds
    buffer_load_dwordx4 v6, s[60:63], s10 offen offset:3072 lds
    s_waitcnt vmcnt(12)
    s_mov_b32 s14, 0x3f803f80
    v_dot2_f32_bf16 v173, v168, s14, 0
    v_dot2_f32_bf16 v173, v169, s14, v173
    v_dot2_f32_bf16 v173, v170, s14, v173
    v_dot2_f32_bf16 v173, v171, s14, v173
    v_dot2_f32_bf16 v173, v172, s14, v173
    s_nop 1
    s_nop 1
    v_add_f32_dpp v173, v173, v173 row_ror:8 row_mask:0xf bank_mask:0xf
    s_nop 1
    v_add_f32_dpp v173, v173, v173 row_ror:4 row_mask:0xf bank_mask:0xf
    s_nop 1
    v_add_f32_dpp v173, v173, v173 row_ror:2 row_mask:0xf bank_mask:0xf
    s_nop 1
    v_add_f32_dpp v173, v173, v173 row_ror:1 row_mask:0xf bank_mask:0xf
    v_cvt_pk_bf16_f32 v170, v173, v173
    v_lshlrev_b32 v170, 16, v170
    v_sub_f32 v173, v173, v170
    v_cvt_pk_bf16_f32 v168, v170, v173
    v_mov_b32 v169, v26
    buffer_store_dwordx2 v[168:169], v140, s[48:51], s92 offen offset:0 sc1
    s_add_u32 m0, s82, 114688
    s_add_u32 s83, s83, 128
    buffer_load_dwordx4 v3, s[64:67], s83 offen offset:0 lds
    buffer_load_dwordx4 v4, s[64:67], s83 offen offset:1024 lds
    buffer_load_dwordx4 v5, s[64:67], s83 offen offset:2048 lds
    buffer_load_dwordx4 v6, s[64:67], s83 offen offset:3072 lds
    s_add_u32 m0, s82, 131072
    s_add_u32 s83, s83, 128
    buffer_load_dwordx4 v3, s[64:67], s83 offen offset:0 lds
    buffer_load_dwordx4 v4, s[64:67], s83 offen offset:1024 lds
    buffer_load_dwordx4 v5, s[64:67], s83 offen offset:2048 lds
    buffer_load_dwordx4 v6, s[64:67], s83 offen offset:3072 lds
    s_barrier
    ds_read_b128 a[160:163], v15 offset:0
    ds_read_b128 a[164:167], v15 offset:4096
    ds_read_b128 a[168:171], v16 offset:0
    ds_read_b128 a[172:175], v16 offset:4096
    ds_read_b128 a[0:3], v252 offset:0
    ds_read_b128 a[4:7], v253 offset:0
    ds_read_b128 a[176:179], v17 offset:0
    ds_read_b128 a[180:183], v17 offset:4096
    ds_read_b128 a[184:187], v18 offset:0
    ds_read_b128 a[188:191], v18 offset:4096
    ds_read_b128 a[8:11], v254 offset:0
    ds_read_b128 a[12:15], v255 offset:0
    s_waitcnt lgkmcnt(6)
    v_mfma_f32_32x32x16_bf16 v[96:111], a[0:3], a[160:163], 0
    s_add_u32 m0, s82, 32768
    s_add_u32 s10, s10, 256
    ds_read_b128 a[192:195], v15 offset:8192
    buffer_load_dwordx4 v3, s[60:63], s10 offen offset:0 lds
    s_lshl_b32 s80, s2, 7
    s_add_u32 s80, s80, 131072
    s_cmp_lg_u32 s3, 0
    s_cselect_b32 s80, 1073741824, s80
    v_mov_b32 v92, 1073741824
    v_writelane_b32 v92, s80, 0
    v_mfma_f32_32x32x16_bf16 v[112:127], a[0:3], a[164:167], 0
    ds_read_b128 a[196:199], v15 offset:12288
    s_waitcnt vmcnt(15)
    ds_read_b128 a[16:19], v252 offset:16384
    buffer_load_dwordx4 v4, s[60:63], s10 offen offset:1024 lds
    s_or_b32 s80, s2, s3
    s_cselect_b32 s80, 1073741824, 26214400
    v_mov_b32 v94, 1073741824
    v_writelane_b32 v94, s80, 0
    s_lshl_b32 s80, s3, 13
    v_mfma_f32_32x32x16_bf16 v[96:111], a[4:7], a[168:171], v[96:111]
    ds_read_b128 a[200:203], v16 offset:8192
    buffer_load_dwordx4 v5, s[60:63], s10 offen offset:2048 lds
    s_add_u32 s80, s80, 131072
    v_lshl_add_u32 v91, v1, 7, s80
    v_lshlrev_b32 v62, 16, v62
    v_mul_f32 v62, 1069066811, v62
    v_exp_f32 v62, v62
    v_lshlrev_b32 v60, 16, v60
    v_mfma_f32_32x32x16_bf16 v[112:127], a[4:7], a[172:175], v[112:127]
    ds_read_b128 a[204:207], v16 offset:12288
    ds_read_b128 a[20:23], v253 offset:16384
    buffer_load_dwordx4 v6, s[60:63], s10 offen offset:3072 lds
    v_lshlrev_b32 v61, 16, v61
    v_cvt_pk_bf16_f32 v62, v62, v62
    v_lshlrev_b32 v62, 16, v62
    v_mul_f32 v68, v62, v60
    v_mul_f32 v69, v62, v61
    s_waitcnt lgkmcnt(6)
    v_mfma_f32_32x32x16_bf16 v[96:111], a[8:11], a[176:179], v[96:111]
    s_add_u32 m0, s82, 81920
    s_add_u32 s83, s83, 128
    ds_read_b128 a[160:163], v17 offset:8192
    buffer_load_dwordx4 v3, s[64:67], s83 offen offset:0 lds
    buffer_load_dwordx4 v[212:215], v248, s[72:75], s0 offen
    s_add_u32 s0, s0, 27648
    v_mul_f32 v68, 1069066811, v68
    v_mul_f32 v69, 0.15915494, v69
    v_mfma_f32_32x32x16_bf16 v[112:127], a[8:11], a[180:183], v[112:127]
    ds_read_b128 a[164:167], v17 offset:12288
    ds_read_b128 a[24:27], v254 offset:16384
    buffer_load_dwordx4 v4, s[64:67], s83 offen offset:1024 lds
    v_exp_f32 v68, v68
    v_fract_f32 v69, v69
    v_cos_f32 v70, v69
    v_mfma_f32_32x32x16_bf16 v[96:111], a[12:15], a[184:187], v[96:111]
    ds_read_b128 a[168:171], v18 offset:8192
    buffer_load_dwordx4 v5, s[64:67], s83 offen offset:2048 lds
    buffer_load_dwordx4 v[216:219], v248, s[72:75], s0 offen
    s_add_u32 s0, s0, 27648
    v_sin_f32 v71, v69
    v_mul_f32 v72, v60, v60
    v_fmac_f32 v72, v61, v61
    v_mfma_f32_32x32x16_bf16 v[112:127], a[12:15], a[188:191], v[112:127]
    ds_read_b128 a[172:175], v18 offset:12288
    ds_read_b128 a[28:31], v255 offset:16384
    buffer_load_dwordx4 v6, s[64:67], s83 offen offset:3072 lds
    v_mul_f32 v28, v68, v70
    v_mul_f32 v29, v68, v71
    v_rcp_f32 v72, v72
    v_sub_f32 v30, 0, v29
    s_waitcnt lgkmcnt(6)
    v_mfma_f32_32x32x16_bf16 v[96:111], a[16:19], a[192:195], v[96:111]
    s_waitcnt vmcnt(19)
    s_barrier
    ds_read_b128 a[176:179], v15 offset:16384
    buffer_load_dwordx4 v[220:223], v248, s[72:75], s0 offen
    s_add_u32 s0, s0, 27648
    v_add_f32 v73, -1.0, v28
    v_add_f32 v72, v72, v72
    v_mul_f32 v74, v73, v60
    v_mfma_f32_32x32x16_bf16 v[112:127], a[16:19], a[196:199], v[112:127]
    ds_read_b128 a[180:183], v15 offset:20480
    s_waitcnt vmcnt(15)
    ds_read_b128 a[32:35], v252 offset:32768
    v_fmac_f32 v74, v29, v61
    v_mul_f32 v75, v73, v61
    v_fmac_f32 v75, v30, v60
    v_mul_f32 v31, v74, v72
    v_mul_f32 v32, v75, v72
    v_sub_f32 v33, 0, v31
    v_mfma_f32_32x32x16_bf16 v[96:111], a[20:23], a[200:203], v[96:111]
    ds_read_b128 a[184:187], v16 offset:16384
    buffer_load_dwordx4 v[224:227], v248, s[72:75], s0 offen
    s_add_u32 s0, s0, 27648
    v_mul_f32 v76, v29, v29
    v_mul_f32 v69, v28, v29
    v_fma_f32 v68, v28, v28, -v76
    v_add_f32 v69, v69, v69
    v_mul_f32 v76, v69, v69
    v_mfma_f32_32x32x16_bf16 v[112:127], a[20:23], a[204:207], v[112:127]
    ds_read_b128 a[188:191], v16 offset:20480
    ds_read_b128 a[36:39], v253 offset:32768
    v_mul_f32 v71, v68, v69
    v_fma_f32 v70, v68, v68, -v76
    v_add_f32 v71, v71, v71
    v_mul_f32 v76, v71, v71
    v_mul_f32 v69, v70, v71
    v_fma_f32 v68, v70, v70, -v76
    s_waitcnt lgkmcnt(6)
    v_mfma_f32_32x32x16_bf16 v[96:111], a[24:27], a[160:163], v[96:111]
    s_add_u32 m0, s82, 98304
    s_add_u32 s83, s83, 128
    ds_read_b128 a[192:195], v17 offset:16384
    buffer_load_dwordx4 v3, s[64:67], s83 offen offset:0 lds
    buffer_load_dwordx4 v[228:231], v248, s[72:75], s0 offen
    v_add_f32 v69, v69, v69
    v_mul_f32 v76, v69, v69
    v_mul_f32 v35, v68, v69
    v_mfma_f32_32x32x16_bf16 v[112:127], a[24:27], a[164:167], v[112:127]
    ds_read_b128 a[196:199], v17 offset:20480
    ds_read_b128 a[40:43], v254 offset:32768
    buffer_load_dwordx4 v4, s[64:67], s83 offen offset:1024 lds
    v_fma_f32 v34, v68, v68, -v76
    v_add_f32 v35, v35, v35
    v_mul_f32 v76, v35, v35
    v_mul_f32 v69, v34, v35
    v_fma_f32 v68, v34, v34, -v76
    v_add_f32 v69, v69, v69
    v_mfma_f32_32x32x16_bf16 v[96:111], a[28:31], a[168:171], v[96:111]
    ds_read_b128 a[200:203], v18 offset:16384
    buffer_load_dwordx4 v5, s[64:67], s83 offen offset:2048 lds
    v_mul_f32 v76, v69, v69
    v_mul_f32 v71, v68, v69
    v_fma_f32 v70, v68, v68, -v76
    v_add_f32 v71, v71, v71
    v_mul_f32 v76, v71, v71
    v_mul_f32 v37, v70, v71
    v_fma_f32 v36, v70, v70, -v76
    v_mfma_f32_32x32x16_bf16 v[112:127], a[28:31], a[172:175], v[112:127]
    ds_read_b128 a[204:207], v18 offset:20480
    ds_read_b128 a[44:47], v255 offset:32768
    buffer_load_dwordx4 v6, s[64:67], s83 offen offset:3072 lds
    v_add_f32 v37, v37, v37
    v_mul_f32 v76, v37, v37
    v_mul_f32 v39, v36, v37
    v_fma_f32 v38, v36, v36, -v76
    v_add_f32 v39, v39, v39
    s_waitcnt lgkmcnt(6)
    v_mfma_f32_32x32x16_bf16 v[96:111], a[32:35], a[176:179], v[96:111]
    s_add_u32 m0, s82, 49152
    s_add_u32 s10, s10, 256
    ds_read_b128 a[160:163], v15 offset:24576
    buffer_load_dwordx4 v3, s[60:63], s10 offen offset:0 lds
    s_mov_b32 s80, 0
    s_mov_b32 s81, -1
    v_cndmask_b32 v40, 1.0, v34, s[80:81]
    v_cndmask_b32 v41, 0, v35, s[80:81]
    s_bfe_i32 s80, s3, 65536
    v_mfma_f32_32x32x16_bf16 v[112:127], a[32:35], a[180:183], v[112:127]
    ds_read_b128 a[164:167], v15 offset:28672
    s_waitcnt vmcnt(18)
    ds_read_b128 a[48:51], v252 offset:49152
    buffer_load_dwordx4 v4, s[60:63], s10 offen offset:1024 lds
    s_mov_b32 s81, s80
    v_cndmask_b32 v72, 1.0, v68, s[80:81]
    v_cndmask_b32 v73, 0, v69, s[80:81]
    v_mul_f32 v74, v40, v72
    v_mul_f32 v75, v40, v73
    v_mfma_f32_32x32x16_bf16 v[96:111], a[36:39], a[184:187], v[96:111]
    ds_read_b128 a[168:171], v16 offset:24576
    buffer_load_dwordx4 v5, s[60:63], s10 offen offset:2048 lds
    v_fma_f32 v40, -v41, v73, v74
    v_fma_f32 v41, v41, v72, v75
    s_bfe_i32 s80, s3, 65537
    s_mov_b32 s81, s80
    v_cndmask_b32 v72, 1.0, v70, s[80:81]
    v_cndmask_b32 v73, 0, v71, s[80:81]
    v_mul_f32 v74, v40, v72
    v_mfma_f32_32x32x16_bf16 v[112:127], a[36:39], a[188:191], v[112:127]
    ds_read_b128 a[172:175], v16 offset:28672
    ds_read_b128 a[52:55], v253 offset:49152
    buffer_load_dwordx4 v6, s[60:63], s10 offen offset:3072 lds
    v_mul_f32 v75, v40, v73
    v_fma_f32 v40, -v41, v73, v74
    v_fma_f32 v41, v41, v72, v75
    v_mov_b32 v42, 0
    v_mov_b32 v43, 0
    s_waitcnt lgkmcnt(6)
    v_mfma_f32_32x32x16_bf16 v[96:111], a[40:43], a[192:195], v[96:111]
    s_add_u32 m0, s82, 114688
    s_add_u32 s83, s83, 128
    ds_read_b128 a[176:179], v17 offset:24576
    buffer_load_dwordx4 v3, s[64:67], s83 offen offset:0 lds
    v_and_b32 v80, 31, v1
    v_lshrrev_b32 v82, 5, v1
    v_bfe_u32 v81, v1, 2, 1
    v_lshlrev_b32 v81, 10, v81
    v_lshl_add_u32 v81, v82, 8, v81
    v_mfma_f32_32x32x16_bf16 v[112:127], a[40:43], a[196:199], v[112:127]
    ds_read_b128 a[180:183], v17 offset:28672
    ds_read_b128 a[56:59], v254 offset:49152
    buffer_load_dwordx4 v4, s[64:67], s83 offen offset:1024 lds
    v_bfe_u32 v83, v1, 3, 2
    v_lshl_add_u32 v81, v83, 6, v81
    v_and_b32 v83, 3, v1
    v_lshl_add_u32 v19, v83, 4, v81
    s_lshl_b32 s80, s3, 9
    s_add_u32 s80, s80, 147456
    v_mfma_f32_32x32x16_bf16 v[96:111], a[44:47], a[200:203], v[96:111]
    ds_read_b128 a[184:187], v18 offset:24576
    buffer_load_dwordx4 v5, s[64:67], s83 offen offset:2048 lds
    v_lshl_add_u32 v21, v1, 3, s80
    v_lshlrev_b32 v81, 3, v80
    v_add_u32 v22, 147456, v81
    s_mul_i32 s80, s3, 2560
    s_add_u32 s80, s80, 151552
    v_lshl_add_u32 v24, v82, 5, v24
    v_add_u32 v24, s80, v24
    v_mfma_f32_32x32x16_bf16 v[112:127], a[44:47], a[204:207], v[112:127]
    ds_read_b128 a[188:191], v18 offset:28672
    ds_read_b128 a[60:63], v255 offset:49152
    buffer_load_dwordx4 v6, s[64:67], s83 offen offset:3072 lds
    v_lshrrev_b32 v81, 4, v1
    v_bfe_u32 v84, v1, 2, 2
    v_lshl_add_u32 v81, v81, 3, v84
    v_mul_u32_u24 v81, 80, v81
    v_lshl_add_u32 v81, v83, 3, v81
    s_waitcnt lgkmcnt(6)
    v_mfma_f32_32x32x16_bf16 v[96:111], a[48:51], a[160:163], v[96:111]
    s_waitcnt vmcnt(21)
    s_barrier
    ds_read_b128 a[192:195], v15 offset:32768
    v_add_u32 v25, s80, v81
    s_lshl_b32 s15, s4, 9
    s_or_b32 s81, s15, s3
    s_mov_b32 s99, 0x100000
    v_mfma_f32_32x32x16_bf16 v[112:127], a[48:51], a[164:167], v[112:127]
    ds_read_b128 a[196:199], v15 offset:36864
    s_waitcnt vmcnt(15)
    ds_read_b128 a[64:67], v252 offset:0
    s_cmp_eq_u32 s81, 1
    s_cselect_b32 s80, 8192, s99
    s_cmp_eq_u32 s3, 0
    s_cselect_b32 s80, s15, s80
    s_cselect_b32 s31, -1, 0
    v_mfma_f32_32x32x16_bf16 v[96:111], a[52:55], a[168:171], v[96:111]
    ds_read_b128 a[200:203], v16 offset:32768
    s_cmp_eq_u32 s5, 10
    s_cselect_b32 s80, s99, s80
    v_lshlrev_b32 v81, 4, v80
    v_add_u32 v23, s80, v81
    s_sub_u32 s15, s15, 512
    v_add_u32 v95, 8192, v81
    v_add_u32 v81, s15, v81
    v_mfma_f32_32x32x16_bf16 v[112:127], a[52:55], a[172:175], v[112:127]
    ds_read_b128 a[204:207], v16 offset:36864
    ds_read_b128 a[68:71], v253 offset:0
    v_lshlrev_b32 v82, 9, v82
    v_sub_u32 v80, v81, v82
    s_lshr_b32 s99, s3, 1
    s_and_b32 s99, s99, s2
    s_lshl_b32 s99, s99, 30
    v_subrev_u32 v81, 1024, v80
    s_waitcnt lgkmcnt(6)
    v_mfma_f32_32x32x16_bf16 v[96:111], a[56:59], a[176:179], v[96:111]
    s_add_u32 m0, s82, 131072
    s_add_u32 s83, s83, 128
    ds_read_b128 a[160:163], v17 offset:32768
    buffer_load_dwordx4 v3, s[64:67], s83 offen offset:0 lds
    v_subrev_u32 v82, 2048, v80
    v_subrev_u32 v83, 3072, v80
    v_subrev_u32 v84, 4096, v80
    v_subrev_u32 v85, 5120, v80
    v_subrev_u32 v86, 6144, v80
    v_mfma_f32_32x32x16_bf16 v[112:127], a[56:59], a[180:183], v[112:127]
    ds_read_b128 a[164:167], v17 offset:36864
    ds_read_b128 a[72:75], v254 offset:0
    buffer_load_dwordx4 v4, s[64:67], s83 offen offset:1024 lds
    v_subrev_u32 v87, 7168, v80
    v_min_u32 v80, v80, v95
    v_min_u32 v81, v81, v95
    v_min_u32 v82, v82, v95
    v_min_u32 v83, v83, v95
    v_min_u32 v84, v84, v95
    v_mfma_f32_32x32x16_bf16 v[96:111], a[60:63], a[184:187], v[96:111]
    ds_read_b128 a[168:171], v18 offset:32768
    buffer_load_dwordx4 v5, s[64:67], s83 offen offset:2048 lds
    v_min_u32 v85, v85, v95
    v_min_u32 v86, v86, v95
    v_min_u32 v87, v87, v95
    v_add_u32 v80, 151552, v80
    v_add_u32 v81, 151552, v81
    v_add_u32 v82, 151552, v82
    v_add_u32 v83, 151552, v83
    v_mfma_f32_32x32x16_bf16 v[112:127], a[60:63], a[188:191], v[112:127]
    ds_read_b128 a[172:175], v18 offset:36864
    ds_read_b128 a[76:79], v255 offset:0
    buffer_load_dwordx4 v6, s[64:67], s83 offen offset:3072 lds
    v_add_u32 v84, 151552, v84
    v_add_u32 v85, 151552, v85
    v_add_u32 v86, 151552, v86
    v_add_u32 v87, 151552, v87
    v_add_u32 v23, 151552, v23
    s_waitcnt lgkmcnt(6)
    v_mfma_f32_32x32x16_bf16 v[96:111], a[64:67], a[192:195], v[96:111]
    s_add_u32 m0, s82, 0
    s_add_u32 s10, s10, 256
    ds_read_b128 a[176:179], v15 offset:40960
    buffer_load_dwordx4 v3, s[60:63], s10 offen offset:0 lds
    s_mov_b32 s72, s46
    s_mov_b32 s73, s47
    s_cmp_eq_u32 s5, 10
    s_cselect_b32 s74, 0, 41943040
    s_mov_b32 s75, 0x00020000
    v_mfma_f32_32x32x16_bf16 v[112:127], a[64:67], a[196:199], v[112:127]
    ds_read_b128 a[180:183], v15 offset:45056
    s_waitcnt vmcnt(13)
    ds_read_b128 a[80:83], v252 offset:16384
    buffer_load_dwordx4 v4, s[60:63], s10 offen offset:1024 lds
    v_lshlrev_b32 v232, 16, v212
    v_and_b32 v233, 0xffff0000, v212
    v_lshlrev_b32 v234, 16, v213
    v_and_b32 v235, 0xffff0000, v213
    v_lshlrev_b32 v236, 16, v214
    v_mfma_f32_32x32x16_bf16 v[96:111], a[68:71], a[200:203], v[96:111]
    ds_read_b128 a[184:187], v16 offset:40960
    buffer_load_dwordx4 v5, s[60:63], s10 offen offset:2048 lds
    v_and_b32 v237, 0xffff0000, v214
    v_lshlrev_b32 v238, 16, v215
    v_and_b32 v239, 0xffff0000, v215
    v_lshlrev_b32 v240, 16, v216
    v_and_b32 v241, 0xffff0000, v216
    v_add_f32 v232, v232, v240
    v_add_f32 v233, v233, v241
    v_mfma_f32_32x32x16_bf16 v[112:127], a[68:71], a[204:207], v[112:127]
    ds_read_b128 a[188:191], v16 offset:45056
    ds_read_b128 a[84:87], v253 offset:16384
    buffer_load_dwordx4 v6, s[60:63], s10 offen offset:3072 lds
    v_lshlrev_b32 v242, 16, v217
    v_and_b32 v243, 0xffff0000, v217
    v_add_f32 v234, v234, v242
    v_add_f32 v235, v235, v243
    v_lshlrev_b32 v240, 16, v218
    s_waitcnt lgkmcnt(6)
    v_mfma_f32_32x32x16_bf16 v[96:111], a[72:75], a[160:163], v[96:111]
    s_add_u32 m0, s82, 81920
    s_add_u32 s83, s83, 128
    ds_read_b128 a[192:195], v17 offset:40960
    buffer_load_dwordx4 v3, s[64:67], s83 offen offset:0 lds
    v_and_b32 v241, 0xffff0000, v218
    v_add_f32 v236, v236, v240
    v_add_f32 v237, v237, v241
    v_lshlrev_b32 v242, 16, v219
    v_and_b32 v243, 0xffff0000, v219
    v_mfma_f32_32x32x16_bf16 v[112:127], a[72:75], a[164:167], v[112:127]
    ds_read_b128 a[196:199], v17 offset:45056
    ds_read_b128 a[88:91], v254 offset:16384
    buffer_load_dwordx4 v4, s[64:67], s83 offen offset:1024 lds
    v_add_f32 v238, v238, v242
    v_add_f32 v239, v239, v243
    v_lshlrev_b32 v240, 16, v220
    v_and_b32 v241, 0xffff0000, v220
    v_add_f32 v232, v232, v240
    v_add_f32 v233, v233, v241
    v_mfma_f32_32x32x16_bf16 v[96:111], a[76:79], a[168:171], v[96:111]
    ds_read_b128 a[200:203], v18 offset:40960
    buffer_load_dwordx4 v5, s[64:67], s83 offen offset:2048 lds
    v_lshlrev_b32 v242, 16, v221
    v_and_b32 v243, 0xffff0000, v221
    v_add_f32 v234, v234, v242
    v_add_f32 v235, v235, v243
    v_lshlrev_b32 v240, 16, v222
    v_and_b32 v241, 0xffff0000, v222
    v_add_f32 v236, v236, v240
    v_mfma_f32_32x32x16_bf16 v[112:127], a[76:79], a[172:175], v[112:127]
    ds_read_b128 a[204:207], v18 offset:45056
    ds_read_b128 a[92:95], v255 offset:16384
    buffer_load_dwordx4 v6, s[64:67], s83 offen offset:3072 lds
    v_add_f32 v237, v237, v241
    v_lshlrev_b32 v242, 16, v223
    v_and_b32 v243, 0xffff0000, v223
    v_add_f32 v238, v238, v242
    v_add_f32 v239, v239, v243
    s_waitcnt lgkmcnt(6)
    v_mfma_f32_32x32x16_bf16 v[96:111], a[80:83], a[176:179], v[96:111]
    s_waitcnt vmcnt(16)
    s_barrier
    ds_read_b128 a[160:163], v15 offset:49152
    v_lshlrev_b32 v240, 16, v224
    v_and_b32 v241, 0xffff0000, v224
    v_add_f32 v232, v232, v240
    v_add_f32 v233, v233, v241
    v_lshlrev_b32 v242, 16, v225
    v_and_b32 v243, 0xffff0000, v225
    v_mfma_f32_32x32x16_bf16 v[112:127], a[80:83], a[180:183], v[112:127]
    ds_read_b128 a[164:167], v15 offset:53248
    s_waitcnt vmcnt(12)
    ds_read_b128 a[96:99], v252 offset:32768
    v_add_f32 v234, v234, v242
    v_add_f32 v235, v235, v243
    v_lshlrev_b32 v240, 16, v226
    v_and_b32 v241, 0xffff0000, v226
    v_add_f32 v236, v236, v240
    v_add_f32 v237, v237, v241
    v_mfma_f32_32x32x16_bf16 v[96:111], a[84:87], a[184:187], v[96:111]
    ds_read_b128 a[168:171], v16 offset:49152
    v_lshlrev_b32 v242, 16, v227
    v_and_b32 v243, 0xffff0000, v227
    v_add_f32 v238, v238, v242
    v_add_f32 v239, v239, v243
    v_lshlrev_b32 v240, 16, v228
    v_and_b32 v241, 0xffff0000, v228
    v_add_f32 v232, v232, v240
    v_add_f32 v233, v233, v241
    v_mfma_f32_32x32x16_bf16 v[112:127], a[84:87], a[188:191], v[112:127]
    ds_read_b128 a[172:175], v16 offset:53248
    ds_read_b128 a[100:103], v253 offset:32768
    v_lshlrev_b32 v242, 16, v229
    v_and_b32 v243, 0xffff0000, v229
    v_add_f32 v234, v234, v242
    v_add_f32 v235, v235, v243
    v_lshlrev_b32 v240, 16, v230
    v_and_b32 v241, 0xffff0000, v230
    s_waitcnt lgkmcnt(6)
    v_mfma_f32_32x32x16_bf16 v[96:111], a[88:91], a[192:195], v[96:111]
    s_add_u32 m0, s82, 98304
    s_add_u32 s83, s83, 128
    ds_read_b128 a[176:179], v17 offset:49152
    buffer_load_dwordx4 v3, s[64:67], s83 offen offset:0 lds
    v_add_f32 v236, v236, v240
    v_add_f32 v237, v237, v241
    v_lshlrev_b32 v242, 16, v231
    v_and_b32 v243, 0xffff0000, v231
    v_add_f32 v238, v238, v242
    v_mfma_f32_32x32x16_bf16 v[112:127], a[88:91], a[196:199], v[112:127]
    ds_read_b128 a[180:183], v17 offset:53248
    ds_read_b128 a[104:107], v254 offset:32768
    buffer_load_dwordx4 v4, s[64:67], s83 offen offset:1024 lds
    v_add_f32 v239, v239, v243
    s_lshl_b32 s0, s3, 8
    v_add_u32 v250, 162816, v250
    v_add_u32 v240, s0, v250
    v_permlane32_swap_b32 v232, v236
    v_permlane32_swap_b32 v233, v237
    v_mfma_f32_32x32x16_bf16 v[96:111], a[92:95], a[200:203], v[96:111]
    ds_read_b128 a[184:187], v18 offset:49152
    buffer_load_dwordx4 v5, s[64:67], s83 offen offset:2048 lds
    v_permlane32_swap_b32 v234, v238
    v_permlane32_swap_b32 v235, v239
    v_add_f32 v232, v232, v236
    v_add_f32 v233, v233, v237
    v_add_f32 v234, v234, v238
    v_add_f32 v235, v235, v239
    s_mov_b32 s34, 0xff00ff00
    v_mfma_f32_32x32x16_bf16 v[112:127], a[92:95], a[204:207], v[112:127]
    ds_read_b128 a[188:191], v18 offset:53248
    ds_read_b128 a[108:111], v255 offset:32768
    buffer_load_dwordx4 v6, s[64:67], s83 offen offset:3072 lds
    v_permlane16_swap_b32 v232, v234
    v_permlane16_swap_b32 v233, v235
    v_add_f32 v232, v232, v234
    v_add_f32 v233, v233, v235
    s_mov_b32 s35, s34
    s_waitcnt lgkmcnt(6)
    v_mfma_f32_32x32x16_bf16 v[96:111], a[96:99], a[160:163], v[96:111]
    s_add_u32 m0, s82, 16384
    ds_read_b128 a[192:195], v15 offset:57344
    buffer_load_dwordx4 v7, s[52:55], s12 offen offset:0 lds
    v_add_f32_dpp v232, v232, v232 row_ror:8 row_mask:0xf bank_mask:0xf
    v_add_f32_dpp v233, v233, v233 row_ror:8 row_mask:0xf bank_mask:0xf
    v_cndmask_b32 v232, v232, v233, s[34:35]
    v_mfma_f32_32x32x16_bf16 v[112:127], a[96:99], a[164:167], v[112:127]
    ds_read_b128 a[196:199], v15 offset:61440
    s_waitcnt vmcnt(13)
    ds_read_b128 a[112:115], v252 offset:49152
    buffer_load_dwordx4 v8, s[52:55], s12 offen offset:1024 lds
    ds_write_b32 v240, v232
    s_lshl_b32 s80, s4, 2
    s_add_u32 s80, s80, s3
    v_mfma_f32_32x32x16_bf16 v[96:111], a[100:103], a[168:171], v[96:111]
    ds_read_b128 a[200:203], v16 offset:57344
    buffer_load_dwordx4 v7, s[56:59], s12 offen offset:2048 lds
    s_lshl_b32 s80, s80, 8
    s_add_u32 s80, s80, 26218496
    s_lshl_b32 s81, s6, 11
    s_add_u32 s81, s81, 110592
    s_cmp_eq_u32 s3, 0
    s_cselect_b32 s85, -1, 0
    s_mov_b32 s84, 0
    v_mfma_f32_32x32x16_bf16 v[112:127], a[100:103], a[172:175], v[112:127]
    ds_read_b128 a[204:207], v16 offset:61440
    ds_read_b128 a[116:119], v253 offset:49152
    buffer_load_dwordx4 v8, s[56:59], s12 offen offset:3072 lds
    buffer_load_dwordx2 v[212:213], v210, s[48:51], s80 offen sc1
    s_cmp_eq_u32 s3, 1
    s_cselect_b32 s86, -1, 0
    s_mov_b32 s87, 0
    s_waitcnt lgkmcnt(7)
    v_mfma_f32_32x32x16_bf16 v[96:111], a[104:107], a[176:179], v[96:111]
    s_add_u32 m0, s82, 114688
    s_add_u32 s12, s12, 221184
    ds_read_b128 a[160:163], v17 offset:57344
    buffer_load_dwordx4 v7, s[52:55], s12 offen offset:0 lds
    s_waitcnt lgkmcnt(4)
    buffer_load_dwordx4 v[216:219], v20, s[48:51], s81 offen offset:0 sc1
    s_cmp_eq_u32 s3, 1
    s_cselect_b32 s89, -1, 0
    s_mov_b32 s88, 0
    v_mfma_f32_32x32x16_bf16 v[112:127], a[104:107], a[180:183], v[112:127]
    ds_read_b128 a[164:167], v17 offset:61440
    ds_read_b128 a[120:123], v254 offset:49152
    buffer_load_dwordx4 v8, s[52:55], s12 offen offset:1024 lds
    buffer_load_dwordx4 v[220:223], v20, s[48:51], s81 offen offset:1024 sc1
    s_cmp_eq_u32 s3, 2
    s_cselect_b32 s90, -1, 0
    s_mov_b32 s91, 0
    v_mfma_f32_32x32x16_bf16 v[96:111], a[108:111], a[184:187], v[96:111]
    ds_read_b128 a[168:171], v18 offset:57344
    buffer_load_dwordx4 v7, s[56:59], s12 offen offset:2048 lds
    s_cmp_eq_u32 s3, 2
    s_cselect_b32 s93, -1, 0
    s_mov_b32 s92, 0
    s_cmp_eq_u32 s3, 3
    s_cselect_b32 s94, -1, 0
    s_mov_b32 s95, 0
    v_mfma_f32_32x32x16_bf16 v[112:127], a[108:111], a[188:191], v[112:127]
    ds_read_b128 a[172:175], v18 offset:61440
    ds_read_b128 a[124:127], v255 offset:49152
    buffer_load_dwordx4 v8, s[56:59], s12 offen offset:3072 lds
    s_cmp_eq_u32 s3, 3
    s_cselect_b32 s97, -1, 0
    s_mov_b32 s96, 0
    s_waitcnt lgkmcnt(6)
    v_mfma_f32_32x32x16_bf16 v[96:111], a[112:115], a[192:195], v[96:111]
    s_waitcnt vmcnt(19)
    s_barrier
    s_add_u32 m0, s82, 32768
    s_add_u32 s12, s12, 221184
    ds_read_b32 v232, v250 offset:0
    ds_read_b32 v233, v250 offset:256
    ds_read_b32 v234, v250 offset:512
    ds_read_b32 v235, v250 offset:768
    ds_read_b128 a[176:179], v15 offset:0
    buffer_load_dwordx4 v7, s[52:55], s12 offen offset:0 lds
    v_mfma_f32_32x32x16_bf16 v[112:127], a[112:115], a[196:199], v[112:127]
    ds_read_b128 a[180:183], v15 offset:4096
    s_waitcnt vmcnt(16)
    ds_read_b128 a[128:131], v252 offset:0
    buffer_load_dwordx4 v8, s[52:55], s12 offen offset:1024 lds
    v_mfma_f32_32x32x16_bf16 v[96:111], a[116:119], a[200:203], v[96:111]
    ds_read_b128 a[184:187], v16 offset:0
    buffer_load_dwordx4 v7, s[56:59], s12 offen offset:2048 lds
    v_mfma_f32_32x32x16_bf16 v[112:127], a[116:119], a[204:207], v[112:127]
    ds_read_b128 a[188:191], v16 offset:4096
    ds_read_b128 a[132:135], v253 offset:0
    buffer_load_dwordx4 v8, s[56:59], s12 offen offset:3072 lds
    s_waitcnt lgkmcnt(6)
    v_add_f32 v232, v232, v233
    v_add_f32 v234, v234, v235
    v_add_f32 v234, v232, v234
    v_cvt_pk_bf16_f32 v235, v234, v234
    v_lshlrev_b32 v235, 16, v235
    v_sub_f32 v234, v234, v235
    v_cvt_pk_bf16_f32 v232, v235, v234
    v_mov_b32 v233, v26
    buffer_store_dwordx2 v[232:233], v249, s[48:51], s1 offen sc1
    v_mfma_f32_32x32x16_bf16 v[96:111], a[120:123], a[160:163], v[96:111]
    s_add_u32 m0, s82, 131072
    s_add_u32 s12, s12, 221184
    ds_read_b128 a[192:195], v17 offset:0
    buffer_load_dwordx4 v7, s[52:55], s12 offen offset:0 lds
    s_lshl_b32 s0, s5, 12
    s_add_u32 s1, s0, 65536
    v_mfma_f32_32x32x16_bf16 v[112:127], a[120:123], a[164:167], v[112:127]
    ds_read_b128 a[196:199], v17 offset:4096
    ds_read_b128 a[136:139], v254 offset:0
    buffer_load_dwordx4 v8, s[52:55], s12 offen offset:1024 lds
    v_mfma_f32_32x32x16_bf16 v[96:111], a[124:127], a[168:171], v[96:111]
    ds_read_b128 a[200:203], v18 offset:0
    buffer_load_dwordx4 v7, s[56:59], s12 offen offset:2048 lds
    v_mfma_f32_32x32x16_bf16 v[112:127], a[124:127], a[172:175], v[112:127]
    ds_read_b128 a[204:207], v18 offset:4096
    ds_read_b128 a[140:143], v255 offset:0
    buffer_load_dwordx4 v8, s[56:59], s12 offen offset:3072 lds
    s_waitcnt lgkmcnt(6)
    v_mfma_f32_32x32x16_bf16 v[96:111], a[128:131], a[176:179], v[96:111]
    s_add_u32 m0, s82, 65536
    ds_read_b128 a[160:163], v15 offset:8192
    buffer_load_dwordx4 v209, s[68:71], s40 offen offset:0 nt lds
    s_add_u32 s40, s40, s41
    s_waitcnt vmcnt(12)
    v_xor_b32 v214, v213, v26
    v_bitop3_b32 v215, v217, v219, v26 bitop3:0x7e
    v_or_b32 v214, v214, v215
    v_mfma_f32_32x32x16_bf16 v[112:127], a[128:131], a[180:183], v[112:127]
    ds_read_b128 a[164:167], v15 offset:12288
    ds_read_b128 a[144:147], v252 offset:16384
    v_bitop3_b32 v215, v221, v223, v26 bitop3:0x7e
    v_or_b32 v214, v214, v215
    v_cmp_ne_u32 vcc, 0, v214
    s_nop 1
    s_cmp_lg_u64 vcc, 0
    s_cbranch_scc1 L_slow_4
L_ok_5:
    v_and_b32 v89, 0xffff0000, v212
    v_mfma_f32_32x32x16_bf16 v[96:111], a[132:135], a[184:187], v[96:111]
    ds_read_b128 a[168:171], v16 offset:8192
    buffer_load_dwordx4 v209, s[68:71], s40 offen offset:1024 nt lds
    s_add_u32 s40, s40, s41
    v_and_b32 v214, 0xffff, v212
    v_rcp_f32 v215, v89
    v_lshl_or_b32 v214, v214, 16, v214
    v_accvgpr_write_b32 a252, v214
    v_accvgpr_write_b32 a253, 0
    v_mfma_f32_32x32x16_bf16 v[112:127], a[132:135], a[188:191], v[112:127]
    ds_read_b128 a[172:175], v16 offset:12288
    ds_read_b128 a[148:151], v253 offset:16384
    v_accvgpr_write_b32 a254, v214
    v_accvgpr_write_b32 a255, 0
    v_mul_f32 v88, 3216550459, v215
    s_lshl_b32 s80, s3, 7
    s_add_u32 s80, s80, 161792
    v_lshrrev_b32 v210, 1, v210
    s_waitcnt lgkmcnt(6)
    v_mfma_f32_32x32x16_bf16 v[96:111], a[136:139], a[192:195], v[96:111]
    ds_read_b128 a[176:179], v17 offset:8192
    buffer_load_dwordx4 v209, s[68:71], s40 offen offset:2048 nt lds
    s_add_u32 s40, s40, s41
    v_add_u32 v210, s80, v210
    v_lshrrev_b32 v95, 5, v1
    v_lshl_add_u32 v95, v95, 6, s80
    v_mfma_f32_32x32x16_bf16 v[112:127], a[136:139], a[196:199], v[112:127]
    ds_read_b128 a[180:183], v17 offset:12288
    ds_read_b128 a[152:155], v254 offset:16384
    ds_write_b32 v210, v215
    v_mfma_f32_32x32x16_bf16 v[96:111], a[252:255], v[216:219], v[96:111]
    v_mfma_f32_32x32x16_bf16 v[96:111], a[140:143], a[200:203], v[96:111]
    ds_read_b128 a[184:187], v18 offset:8192
    buffer_load_dwordx4 v209, s[68:71], s40 offen offset:3072 nt lds
    v_mfma_f32_32x32x16_bf16 v[112:127], a[252:255], v[220:223], v[112:127]
    v_mfma_f32_32x32x16_bf16 v[112:127], a[140:143], a[204:207], v[112:127]
    s_add_u32 m0, s82, 81920
    s_add_u32 s12, s12, 221184
    ds_read_b128 a[188:191], v18 offset:12288
    ds_read_b128 a[156:159], v255 offset:16384
    buffer_load_dwordx4 v7, s[52:55], s12 offen offset:0 lds
    s_waitcnt lgkmcnt(7)
    v_mfma_f32_32x32x16_bf16 v[96:111], a[144:147], a[160:163], v[96:111]
    s_waitcnt vmcnt(14)
    s_barrier
    ds_read_b64_tr_b16 a[192:193], v9 offset:16384
    ds_read_b64_tr_b16 a[194:195], v9 offset:16896
    buffer_load_dwordx4 v8, s[52:55], s12 offen offset:1024 lds
    v_mfma_f32_32x32x16_bf16 v[112:127], a[144:147], a[164:167], v[112:127]
    ds_read_b64_tr_b16 a[196:197], v9 offset:18432
    ds_read_b64_tr_b16 a[198:199], v9 offset:18944
    buffer_load_dwordx4 v7, s[56:59], s12 offen offset:2048 lds
    v_mfma_f32_32x32x16_bf16 v[96:111], a[148:151], a[168:171], v[96:111]
    ds_read_b64_tr_b16 a[200:201], v12 offset:16384
    ds_read_b64_tr_b16 a[202:203], v12 offset:16896
    buffer_load_dwordx4 v8, s[56:59], s12 offen offset:3072 lds
    v_mfma_f32_32x32x16_bf16 v[112:127], a[148:151], a[172:175], v[112:127]
    s_add_u32 m0, s82, 49152
    s_add_u32 s12, s12, 221184
    ds_read_b64_tr_b16 a[204:205], v12 offset:18432
    ds_read_b64_tr_b16 a[206:207], v12 offset:18944
    buffer_load_dwordx4 v7, s[52:55], s12 offen offset:0 lds
    s_waitcnt lgkmcnt(8)
    v_mfma_f32_32x32x16_bf16 v[96:111], a[152:155], a[176:179], v[96:111]
    ds_read_b64_tr_b16 a[160:161], v9 offset:20480
    ds_read_b64_tr_b16 a[162:163], v9 offset:20992
    buffer_load_dwordx4 v8, s[52:55], s12 offen offset:1024 lds
    v_mfma_f32_32x32x16_bf16 v[112:127], a[152:155], a[180:183], v[112:127]
    ds_read_b64_tr_b16 a[164:165], v9 offset:22528
    ds_read_b64_tr_b16 a[166:167], v9 offset:23040
    buffer_load_dwordx4 v7, s[56:59], s12 offen offset:2048 lds
    v_mfma_f32_32x32x16_bf16 v[96:111], a[156:159], a[184:187], v[96:111]
    ds_read_b64_tr_b16 a[168:169], v12 offset:20480
    ds_read_b64_tr_b16 a[170:171], v12 offset:20992
    buffer_load_dwordx4 v8, s[56:59], s12 offen offset:3072 lds
    v_mfma_f32_32x32x16_bf16 v[112:127], a[156:159], a[188:191], v[112:127]
    s_add_u32 m0, s82, 98304
    s_add_u32 s12, s12, 221184
    ds_read_b64_tr_b16 a[172:173], v12 offset:22528
    ds_read_b64_tr_b16 a[174:175], v12 offset:23040
    buffer_load_dwordx4 v7, s[52:55], s12 offen offset:0 lds
    s_waitcnt lgkmcnt(8)
    v_mfma_f32_32x32x16_bf16 v[128:143], a[192:195], a[0:3], 0
    ds_read_b64_tr_b16 a[176:177], v9 offset:24576
    ds_read_b64_tr_b16 a[178:179], v9 offset:25088
    s_mul_i32 s66, s6, 8704
    s_add_u32 s66, s66, 25014272
    s_add_u32 s64, s46, s66
    s_addc_u32 s65, s47, 0
    s_mov_b32 s66, 160256
    s_mov_b32 s67, 0x00020000
    v_mfma_f32_32x32x16_bf16 v[144:159], a[196:199], a[0:3], 0
    ds_read_b64_tr_b16 a[180:181], v9 offset:26624
    ds_read_b64_tr_b16 a[182:183], v9 offset:27136
    s_cmp_ge_u32 s3, 2
    s_cselect_b32 s44, s1, s0
    s_and_b32 s45, s3, 1
    s_lshl_b32 s45, s45, 11
    s_add_u32 s44, s44, s45
    v_add_u32 v93, 151552, v20
    v_mfma_f32_32x32x16_bf16 v[160:175], a[200:203], a[0:3], 0
    ds_read_b64_tr_b16 a[184:185], v12 offset:24576
    ds_read_b64_tr_b16 a[186:187], v12 offset:25088
    buffer_load_dwordx4 v8, s[52:55], s12 offen offset:1024 lds
    ds_read_b128 v[64:67], v95 offset:0
    ds_read_b128 v[68:71], v95 offset:16
    v_mfma_f32_32x32x16_bf16 v[176:191], a[204:207], a[0:3], 0
    ds_read_b64_tr_b16 a[188:189], v12 offset:26624
    ds_read_b64_tr_b16 a[190:191], v12 offset:27136
    ds_read_b128 v[72:75], v95 offset:32
    ds_read_b128 v[76:79], v95 offset:48
    s_waitcnt lgkmcnt(12)
    v_mfma_f32_32x32x16_bf16 v[128:143], a[160:163], a[4:7], v[128:143]
    ds_read_b64_tr_b16 a[192:193], v9 offset:28672
    ds_read_b64_tr_b16 a[194:195], v9 offset:29184
    v_mfma_f32_32x32x16_bf16 v[144:159], a[164:167], a[4:7], v[144:159]
    ds_read_b64_tr_b16 a[196:197], v9 offset:30720
    ds_read_b64_tr_b16 a[198:199], v9 offset:31232
    v_mfma_f32_32x32x16_bf16 v[160:175], a[168:171], a[4:7], v[160:175]
    ds_read_b64_tr_b16 a[200:201], v12 offset:28672
    ds_read_b64_tr_b16 a[202:203], v12 offset:29184
    buffer_load_dwordx4 v7, s[56:59], s12 offen offset:2048 lds
    v_mfma_f32_32x32x16_bf16 v[176:191], a[172:175], a[4:7], v[176:191]
    ds_read_b64_tr_b16 a[204:205], v12 offset:30720
    ds_read_b64_tr_b16 a[206:207], v12 offset:31232
    s_waitcnt lgkmcnt(8)
    v_mul_f32 v96, v64, v96
    v_mul_f32 v112, v64, v112
    v_mul_f32 v97, v65, v97
    v_mul_f32 v113, v65, v113
    v_mfma_f32_32x32x16_bf16 v[128:143], a[176:179], a[8:11], v[128:143]
    ds_read_b64_tr_b16 a[160:161], v10 offset:49152
    ds_read_b64_tr_b16 a[162:163], v10 offset:49664
    v_mul_f32 v98, v66, v98
    v_mul_f32 v114, v66, v114
    v_mul_f32 v99, v67, v99
    v_mul_f32 v115, v67, v115
    v_mul_f32 v100, v68, v100
    v_mul_f32 v116, v68, v116
    v_mfma_f32_32x32x16_bf16 v[144:159], a[180:183], a[8:11], v[144:159]
    ds_read_b64_tr_b16 a[164:165], v10 offset:51200
    ds_read_b64_tr_b16 a[166:167], v10 offset:51712
    v_mul_f32 v101, v69, v101
    v_mul_f32 v117, v69, v117
    v_mul_f32 v102, v70, v102
    v_mul_f32 v118, v70, v118
    v_mul_f32 v103, v71, v103
    v_mul_f32 v119, v71, v119
    v_mfma_f32_32x32x16_bf16 v[160:175], a[184:187], a[8:11], v[160:175]
    ds_read_b64_tr_b16 a[168:169], v13 offset:49152
    ds_read_b64_tr_b16 a[170:171], v13 offset:49664
    buffer_load_dwordx4 v8, s[56:59], s12 offen offset:3072 lds
    v_mul_f32 v104, v72, v104
    v_mul_f32 v120, v72, v120
    v_mul_f32 v105, v73, v105
    v_mul_f32 v121, v73, v121
    v_mul_f32 v106, v74, v106
    v_mfma_f32_32x32x16_bf16 v[176:191], a[188:191], a[8:11], v[176:191]
    s_lshr_b32 m0, s82, 1
    s_add_u32 m0, m0, 151552
    ds_read_b64_tr_b16 a[172:173], v13 offset:51200
    ds_read_b64_tr_b16 a[174:175], v13 offset:51712
    buffer_load_dwordx4 v20, s[48:51], s44 offen offset:0 sc1 lds
    v_mul_f32 v122, v74, v122
    s_waitcnt lgkmcnt(8)
    v_mfma_f32_32x32x16_bf16 v[128:143], a[192:195], a[12:15], v[128:143]
    ds_read_b64_tr_b16 a[176:177], v10 offset:53248
    ds_read_b64_tr_b16 a[178:179], v10 offset:53760
    buffer_load_dwordx4 v20, s[48:51], s44 offen offset:1024 sc1 lds
    v_mul_f32 v107, v75, v107
    v_mul_f32 v123, v75, v123
    v_mul_f32 v108, v76, v108
    v_mul_f32 v124, v76, v124
    v_mul_f32 v109, v77, v109
    v_mfma_f32_32x32x16_bf16 v[144:159], a[196:199], a[12:15], v[144:159]
    ds_read_b64_tr_b16 a[180:181], v10 offset:55296
    ds_read_b64_tr_b16 a[182:183], v10 offset:55808
    s_waitcnt vmcnt(14)
    s_cmp_eq_u32 s41, 4096
    s_cbranch_scc1 L_rtc_6
    ds_read_b64_tr_b16 v[192:193], v208 offset:0
    ds_read_b64_tr_b16 v[194:195], v208 offset:1024
    ds_read_b64_tr_b16 v[196:197], v208 offset:32
    ds_read_b64_tr_b16 v[198:199], v208 offset:1056
    ds_read_b64_tr_b16 v[200:201], v208 offset:64
    ds_read_b64_tr_b16 v[202:203], v208 offset:1088
    ds_read_b64_tr_b16 v[204:205], v208 offset:96
    ds_read_b64_tr_b16 v[206:207], v208 offset:1120
    s_branch L_rtd_7
L_rtc_6:
    v_xor_b32 v199, 64, v208
    v_xor_b32 v203, 128, v208
    v_xor_b32 v207, 192, v208
    ds_read_b64 v[192:193], v208 offset:0
    ds_read_b64 v[194:195], v208 offset:8
    ds_read_b64 v[196:197], v199 offset:0
    ds_read_b64 v[198:199], v199 offset:8
    ds_read_b64 v[200:201], v203 offset:0
    ds_read_b64 v[202:203], v203 offset:8
    ds_read_b64 v[204:205], v207 offset:0
    ds_read_b64 v[206:207], v207 offset:8
L_rtd_7:
    v_mfma_f32_32x32x16_bf16 v[160:175], a[200:203], a[12:15], v[160:175]
    ds_read_b64_tr_b16 a[184:185], v13 offset:53248
    ds_read_b64_tr_b16 a[186:187], v13 offset:53760
    v_mul_f32 v125, v77, v125
    v_mul_f32 v110, v78, v110
    v_mul_f32 v126, v78, v126
    v_mul_f32 v111, v79, v111
    v_mul_f32 v127, v79, v127
    v_fma_f32 v62, v28, v96, v97
    v_mfma_f32_32x32x16_bf16 v[176:191], a[204:207], a[12:15], v[176:191]
    ds_read_b64_tr_b16 a[188:189], v13 offset:55296
    ds_read_b64_tr_b16 a[190:191], v13 offset:55808
    v_fma_f32 v63, v28, v112, v113
    v_fmac_f32 v62, v30, v112
    v_fmac_f32 v63, v29, v96
    v_fma_f32 v60, v28, v62, v98
    v_fma_f32 v61, v28, v63, v114
    s_waitcnt lgkmcnt(15)
    v_mfma_f32_32x32x16_bf16 v[128:143], a[160:163], a[16:19], v[128:143]
    ds_read_b64_tr_b16 a[192:193], v10 offset:57344
    ds_read_b64_tr_b16 a[194:195], v10 offset:57856
    v_fmac_f32 v60, v30, v63
    v_fmac_f32 v61, v29, v62
    v_fma_f32 v62, v28, v60, v99
    v_fma_f32 v63, v28, v61, v115
    v_fmac_f32 v62, v30, v61
    v_fmac_f32 v63, v29, v60
    v_mfma_f32_32x32x16_bf16 v[144:159], a[164:167], a[16:19], v[144:159]
    ds_read_b64_tr_b16 a[196:197], v10 offset:59392
    ds_read_b64_tr_b16 a[198:199], v10 offset:59904
    s_waitcnt lgkmcnt(8)
    buffer_store_dwordx4 v[192:195], v20, s[48:51], s36 offen sc1
    v_fma_f32 v60, v28, v62, v100
    v_fma_f32 v61, v28, v63, v116
    v_fmac_f32 v60, v30, v63
    v_fmac_f32 v61, v29, v62
    v_mfma_f32_32x32x16_bf16 v[160:175], a[168:171], a[16:19], v[160:175]
    s_add_u32 m0, s82, 65536
    s_add_u32 s12, s12, 221184
    ds_read_b64_tr_b16 a[200:201], v13 offset:57344
    ds_read_b64_tr_b16 a[202:203], v13 offset:57856
    buffer_load_dwordx4 v7, s[52:55], s12 offen offset:0 lds
    v_fma_f32 v62, v28, v60, v101
    v_fma_f32 v63, v28, v61, v117
    v_fmac_f32 v62, v30, v61
    v_mfma_f32_32x32x16_bf16 v[176:191], a[172:175], a[16:19], v[176:191]
    ds_read_b64_tr_b16 a[204:205], v13 offset:59392
    ds_read_b64_tr_b16 a[206:207], v13 offset:59904
    v_fmac_f32 v63, v29, v60
    v_fma_f32 v60, v28, v62, v102
    v_fma_f32 v61, v28, v63, v118
    v_fmac_f32 v60, v30, v63
    v_fmac_f32 v61, v29, v62
    s_waitcnt lgkmcnt(8)
    v_mfma_f32_32x32x16_bf16 v[128:143], a[176:179], a[20:23], v[128:143]
    ds_read_b64_tr_b16 a[160:161], v10 offset:61440
    ds_read_b64_tr_b16 a[162:163], v10 offset:61952
    v_fma_f32 v62, v28, v60, v103
    v_fma_f32 v63, v28, v61, v119
    v_fmac_f32 v62, v30, v61
    v_fmac_f32 v63, v29, v60
    v_fma_f32 v60, v28, v62, v104
    v_fma_f32 v61, v28, v63, v120
    v_mfma_f32_32x32x16_bf16 v[144:159], a[180:183], a[20:23], v[144:159]
    ds_read_b64_tr_b16 a[164:165], v10 offset:63488
    ds_read_b64_tr_b16 a[166:167], v10 offset:64000
    buffer_store_dwordx4 v[196:199], v20, s[48:51], s37 offen sc1
    v_fmac_f32 v60, v30, v63
    v_fmac_f32 v61, v29, v62
    v_fma_f32 v62, v28, v60, v105
    v_fma_f32 v63, v28, v61, v121
    v_mfma_f32_32x32x16_bf16 v[160:175], a[184:187], a[20:23], v[160:175]
    ds_read_b64_tr_b16 a[168:169], v13 offset:61440
    ds_read_b64_tr_b16 a[170:171], v13 offset:61952
    buffer_load_dwordx4 v8, s[52:55], s12 offen offset:1024 lds
    v_fmac_f32 v62, v30, v61
    v_fmac_f32 v63, v29, v60
    v_fma_f32 v60, v28, v62, v106
    v_fma_f32 v61, v28, v63, v122
    v_fmac_f32 v60, v30, v63
    v_mfma_f32_32x32x16_bf16 v[176:191], a[188:191], a[20:23], v[176:191]
    ds_read_b64_tr_b16 a[172:173], v13 offset:63488
    ds_read_b64_tr_b16 a[174:175], v13 offset:64000
    v_fmac_f32 v61, v29, v62
    v_fma_f32 v62, v28, v60, v107
    v_fma_f32 v63, v28, v61, v123
    v_fmac_f32 v62, v30, v61
    v_fmac_f32 v63, v29, v60
    s_waitcnt lgkmcnt(8)
    v_mfma_f32_32x32x16_bf16 v[128:143], a[192:195], a[24:27], v[128:143]
    s_barrier
    ds_read_b64_tr_b16 a[176:177], v9 offset:32768
    ds_read_b64_tr_b16 a[178:179], v9 offset:33280
    v_fma_f32 v60, v28, v62, v108
    v_fma_f32 v61, v28, v63, v124
    v_fmac_f32 v60, v30, v63
    v_fmac_f32 v61, v29, v62
    v_fma_f32 v62, v28, v60, v109
    v_mfma_f32_32x32x16_bf16 v[144:159], a[196:199], a[24:27], v[144:159]
    ds_read_b64_tr_b16 a[180:181], v9 offset:34816
    ds_read_b64_tr_b16 a[182:183], v9 offset:35328
    buffer_store_dwordx4 v[200:203], v20, s[48:51], s38 offen sc1
    v_fma_f32 v63, v28, v61, v125
    v_fmac_f32 v62, v30, v61
    v_fmac_f32 v63, v29, v60
    v_fma_f32 v60, v28, v62, v110
    v_mfma_f32_32x32x16_bf16 v[160:175], a[200:203], a[24:27], v[160:175]
    ds_read_b64_tr_b16 a[184:185], v12 offset:32768
    ds_read_b64_tr_b16 a[186:187], v12 offset:33280
    buffer_load_dwordx4 v7, s[56:59], s12 offen offset:2048 lds
    v_fma_f32 v61, v28, v63, v126
    v_fmac_f32 v60, v30, v63
    v_fmac_f32 v61, v29, v62
    v_fma_f32 v62, v28, v60, v111
    v_fma_f32 v63, v28, v61, v127
    v_mfma_f32_32x32x16_bf16 v[176:191], a[204:207], a[24:27], v[176:191]
    ds_read_b64_tr_b16 a[188:189], v12 offset:34816
    ds_read_b64_tr_b16 a[190:191], v12 offset:35328
    s_waitcnt vmcnt(6)
    v_fmac_f32 v62, v30, v61
    v_fmac_f32 v63, v29, v60
    s_waitcnt lgkmcnt(8)
    v_mfma_f32_32x32x16_bf16 v[128:143], a[160:163], a[28:31], v[128:143]
    ds_read_b64_tr_b16 a[192:193], v9 offset:36864
    ds_read_b64_tr_b16 a[194:195], v9 offset:37376
    ds_write_b64 v21, v[62:63] offset:0
    v_mfma_f32_32x32x16_bf16 v[144:159], a[164:167], a[28:31], v[144:159]
    ds_read_b64_tr_b16 a[196:197], v9 offset:38912
    ds_read_b64_tr_b16 a[198:199], v9 offset:39424
    buffer_store_dwordx4 v[204:207], v20, s[48:51], s39 offen sc1
    v_mfma_f32_32x32x16_bf16 v[160:175], a[168:171], a[28:31], v[160:175]
    ds_read_b64_tr_b16 a[200:201], v12 offset:36864
    ds_read_b64_tr_b16 a[202:203], v12 offset:37376
    buffer_load_dwordx4 v8, s[56:59], s12 offen offset:3072 lds
    v_mfma_f32_32x32x16_bf16 v[176:191], a[172:175], a[28:31], v[176:191]
    ds_read_b64_tr_b16 a[204:205], v12 offset:38912
    ds_read_b64_tr_b16 a[206:207], v12 offset:39424
    s_waitcnt lgkmcnt(6)
    s_barrier
    ds_read_b64 v[64:65], v22 offset:0
    ds_read_b64 v[66:67], v22 offset:256
    v_mfma_f32_32x32x16_bf16 v[128:143], a[176:179], a[32:35], v[128:143]
    ds_read_b64_tr_b16 a[160:161], v9 offset:40960
    ds_read_b64_tr_b16 a[162:163], v9 offset:41472
    ds_read_b64 v[68:69], v22 offset:512
    ds_read_b64 v[70:71], v22 offset:768
    v_mfma_f32_32x32x16_bf16 v[144:159], a[180:183], a[32:35], v[144:159]
    ds_read_b64_tr_b16 a[164:165], v9 offset:43008
    ds_read_b64_tr_b16 a[166:167], v9 offset:43520
    ds_read_b64 v[72:73], v22 offset:1024
    ds_read_b64 v[74:75], v22 offset:1280
    v_mfma_f32_32x32x16_bf16 v[160:175], a[184:187], a[32:35], v[160:175]
    s_add_u32 m0, s82, 16384
    s_add_u32 s12, s12, 221184
    ds_read_b64_tr_b16 a[168:169], v12 offset:40960
    ds_read_b64_tr_b16 a[170:171], v12 offset:41472
    buffer_load_dwordx4 v7, s[52:55], s12 offen offset:0 lds
    ds_read_b64 v[76:77], v22 offset:1536
    ds_read_b64 v[78:79], v22 offset:1792
    v_mfma_f32_32x32x16_bf16 v[176:191], a[188:191], a[32:35], v[176:191]
    ds_read_b64_tr_b16 a[172:173], v12 offset:43008
    ds_read_b64_tr_b16 a[174:175], v12 offset:43520
    s_waitcnt lgkmcnt(15)
    v_mfma_f32_32x32x16_bf16 v[128:143], a[192:195], a[36:39], v[128:143]
    ds_read_b64_tr_b16 a[176:177], v9 offset:45056
    ds_read_b64_tr_b16 a[178:179], v9 offset:45568
    v_mfma_f32_32x32x16_bf16 v[144:159], a[196:199], a[36:39], v[144:159]
    ds_read_b64_tr_b16 a[180:181], v9 offset:47104
    ds_read_b64_tr_b16 a[182:183], v9 offset:47616
    v_mfma_f32_32x32x16_bf16 v[160:175], a[200:203], a[36:39], v[160:175]
    ds_read_b64_tr_b16 a[184:185], v12 offset:45056
    ds_read_b64_tr_b16 a[186:187], v12 offset:45568
    buffer_load_dwordx4 v8, s[52:55], s12 offen offset:1024 lds
    s_waitcnt lgkmcnt(8)
    v_fmac_f32 v66, v34, v64
    v_fmac_f32 v67, v34, v65
    v_fma_f32 v66, -v35, v65, v66
    v_fmac_f32 v67, v35, v64
    v_mfma_f32_32x32x16_bf16 v[176:191], a[204:207], a[36:39], v[176:191]
    ds_read_b64_tr_b16 a[188:189], v12 offset:47104
    ds_read_b64_tr_b16 a[190:191], v12 offset:47616
    v_fmac_f32 v68, v34, v66
    v_fmac_f32 v69, v34, v67
    v_fma_f32 v68, -v35, v67, v68
    v_fmac_f32 v69, v35, v66
    v_fmac_f32 v70, v34, v68
    s_waitcnt lgkmcnt(8)
    v_mfma_f32_32x32x16_bf16 v[128:143], a[160:163], a[40:43], v[128:143]
    ds_read_b64_tr_b16 a[192:193], v11 offset:0
    ds_read_b64_tr_b16 a[194:195], v11 offset:512
    v_fmac_f32 v71, v34, v69
    v_fma_f32 v70, -v35, v69, v70
    v_fmac_f32 v71, v35, v68
    v_fmac_f32 v72, v34, v70
    v_fmac_f32 v73, v34, v71
    v_fma_f32 v72, -v35, v71, v72
    v_mfma_f32_32x32x16_bf16 v[144:159], a[164:167], a[40:43], v[144:159]
    ds_read_b64_tr_b16 a[196:197], v11 offset:2048
    ds_read_b64_tr_b16 a[198:199], v11 offset:2560
    v_fmac_f32 v73, v35, v70
    v_fmac_f32 v74, v34, v72
    v_fmac_f32 v75, v34, v73
    v_fma_f32 v74, -v35, v73, v74
    v_fmac_f32 v75, v35, v72
    v_fmac_f32 v76, v34, v74
    v_mfma_f32_32x32x16_bf16 v[160:175], a[168:171], a[40:43], v[160:175]
    ds_read_b64_tr_b16 a[200:201], v14 offset:0
    ds_read_b64_tr_b16 a[202:203], v14 offset:512
    buffer_load_dwordx4 v7, s[56:59], s12 offen offset:2048 lds
    v_fmac_f32 v77, v34, v75
    v_fma_f32 v76, -v35, v75, v76
    v_fmac_f32 v77, v35, v74
    v_fmac_f32 v78, v34, v76
    v_fmac_f32 v79, v34, v77
    v_mfma_f32_32x32x16_bf16 v[176:191], a[172:175], a[40:43], v[176:191]
    ds_read_b64_tr_b16 a[204:205], v14 offset:2048
    ds_read_b64_tr_b16 a[206:207], v14 offset:2560
    v_fma_f32 v78, -v35, v77, v78
    v_fmac_f32 v79, v35, v76
    v_and_b32 v60, s31, v78
    v_mov_b32 v61, v26
    v_and_b32 v62, s31, v79
    s_waitcnt lgkmcnt(8)
    v_mfma_f32_32x32x16_bf16 v[128:143], a[176:179], a[44:47], v[128:143]
    ds_read_b64_tr_b16 a[160:161], v11 offset:4096
    ds_read_b64_tr_b16 a[162:163], v11 offset:4608
    v_mov_b32 v63, v26
    v_mfma_f32_32x32x16_bf16 v[144:159], a[180:183], a[44:47], v[144:159]
    ds_read_b64_tr_b16 a[164:165], v11 offset:6144
    ds_read_b64_tr_b16 a[166:167], v11 offset:6656
    buffer_store_dwordx4 v[60:63], v23, s[64:67], 0 offen sc1
    v_cndmask_b32 v42, v42, v64, s[84:85]
    v_cndmask_b32 v43, v43, v65, s[84:85]
    v_cndmask_b32 v42, v42, v66, s[86:87]
    v_cndmask_b32 v43, v43, v67, s[86:87]
    v_mfma_f32_32x32x16_bf16 v[160:175], a[184:187], a[44:47], v[160:175]
    ds_read_b64_tr_b16 a[168:169], v14 offset:4096
    ds_read_b64_tr_b16 a[170:171], v14 offset:4608
    buffer_load_dwordx4 v8, s[56:59], s12 offen offset:3072 lds
    v_cndmask_b32 v42, v42, v68, s[88:89]
    v_cndmask_b32 v43, v43, v69, s[88:89]
    v_cndmask_b32 v42, v42, v70, s[90:91]
    v_cndmask_b32 v43, v43, v71, s[90:91]
    v_cndmask_b32 v42, v42, v72, s[92:93]
    v_mfma_f32_32x32x16_bf16 v[176:191], a[188:191], a[44:47], v[176:191]
    ds_read_b64_tr_b16 a[172:173], v14 offset:6144
    ds_read_b64_tr_b16 a[174:175], v14 offset:6656
    v_cndmask_b32 v43, v43, v73, s[92:93]
    v_cndmask_b32 v42, v42, v74, s[94:95]
    v_cndmask_b32 v43, v43, v75, s[94:95]
    v_cndmask_b32 v42, v42, v76, s[96:97]
    v_cndmask_b32 v43, v43, v77, s[96:97]
    s_waitcnt lgkmcnt(8)
    v_mfma_f32_32x32x16_bf16 v[128:143], a[192:195], a[48:51], v[128:143]
    ds_read_b64_tr_b16 a[176:177], v11 offset:8192
    ds_read_b64_tr_b16 a[178:179], v11 offset:8704
    s_lshl_b32 s14, s4, 1
    s_lshr_b32 s80, s3, 1
    s_add_u32 s14, s14, s80
    s_mul_i32 s14, s14, 385024
    v_mfma_f32_32x32x16_bf16 v[144:159], a[196:199], a[48:51], v[144:159]
    ds_read_b64_tr_b16 a[180:181], v11 offset:10240
    ds_read_b64_tr_b16 a[182:183], v11 offset:10752
    s_and_b32 s80, s3, 1
    s_lshl_b32 s80, s80, 11
    s_add_u32 s14, s14, s80
    s_add_u32 s14, s14, 4194304
    v_mfma_f32_32x32x16_bf16 v[160:175], a[200:203], a[48:51], v[160:175]
    s_add_u32 m0, s82, 0
    s_add_u32 s12, s12, 221184
    ds_read_b64_tr_b16 a[184:185], v14 offset:8192
    ds_read_b64_tr_b16 a[186:187], v14 offset:8704
    buffer_load_dwordx4 v7, s[52:55], s12 offen offset:0 lds
    s_and_b32 s80, s2, 1
    v_mfma_f32_32x32x16_bf16 v[176:191], a[204:207], a[48:51], v[176:191]
    ds_read_b64_tr_b16 a[188:189], v14 offset:10240
    ds_read_b64_tr_b16 a[190:191], v14 offset:10752
    s_lshl_b32 s81, s8, 1
    s_add_u32 s81, s81, s80
    s_lshl_b32 s80, s80, 2
    s_waitcnt lgkmcnt(8)
    v_mfma_f32_32x32x16_bf16 v[128:143], a[160:163], a[52:55], v[128:143]
    ds_read_b64_tr_b16 a[192:193], v11 offset:12288
    ds_read_b64_tr_b16 a[194:195], v11 offset:12800
    s_add_u32 s80, s80, s3
    s_mul_i32 s20, s9, 94
    s_add_u32 s20, s20, s80
    s_mul_i32 s20, s20, 5120
    v_mfma_f32_32x32x16_bf16 v[144:159], a[164:167], a[52:55], v[144:159]
    ds_read_b64_tr_b16 a[196:197], v11 offset:14336
    ds_read_b64_tr_b16 a[198:199], v11 offset:14848
    s_add_u32 s20, s20, 20971520
    s_lshl_b32 s80, s80, 12
    s_add_u32 s80, s80, 4194304
    s_mul_i32 s19, s81, 385024
    v_mfma_f32_32x32x16_bf16 v[160:175], a[168:171], a[52:55], v[160:175]
    ds_read_b64_tr_b16 a[200:201], v14 offset:12288
    ds_read_b64_tr_b16 a[202:203], v14 offset:12800
    buffer_load_dwordx4 v8, s[52:55], s12 offen offset:1024 lds
    s_waitcnt vmcnt(8)
    s_barrier
    buffer_store_dword v26, v92, s[76:79], 0 offen sc1
    v_mfma_f32_32x32x16_bf16 v[176:191], a[172:175], a[52:55], v[176:191]
    ds_read_b64_tr_b16 a[204:205], v14 offset:14336
    ds_read_b64_tr_b16 a[206:207], v14 offset:14848
    s_add_u32 s19, s19, s80
    s_xor_b32 s18, s81, 1
    s_mul_i32 s18, s18, 385024
    s_waitcnt lgkmcnt(8)
    v_mfma_f32_32x32x16_bf16 v[128:143], a[176:179], a[56:59], v[128:143]
    s_barrier
    ds_read_b64_tr_b16 a[160:161], v10 offset:16384
    ds_read_b64_tr_b16 a[162:163], v10 offset:16896
    ds_read_b128 a[208:211], v93 offset:0
    ds_read_b128 a[212:215], v93 offset:1024
    v_mfma_f32_32x32x16_bf16 v[144:159], a[180:183], a[56:59], v[144:159]
    ds_read_b64_tr_b16 a[164:165], v10 offset:18432
    ds_read_b64_tr_b16 a[166:167], v10 offset:18944
    ds_read_b128 a[216:219], v93 offset:2048
    ds_read_b128 a[220:223], v93 offset:3072
    v_mfma_f32_32x32x16_bf16 v[160:175], a[184:187], a[56:59], v[160:175]
    ds_read_b64_tr_b16 a[168:169], v13 offset:16384
    ds_read_b64_tr_b16 a[170:171], v13 offset:16896
    buffer_load_dwordx4 v7, s[56:59], s12 offen offset:2048 lds
    ds_read_b128 a[224:227], v93 offset:4096
    ds_read_b128 a[228:231], v93 offset:5120
    v_mfma_f32_32x32x16_bf16 v[176:191], a[188:191], a[56:59], v[176:191]
    ds_read_b64_tr_b16 a[172:173], v13 offset:18432
    ds_read_b64_tr_b16 a[174:175], v13 offset:18944
    ds_read_b128 a[232:235], v93 offset:6144
    ds_read_b128 a[236:239], v93 offset:7168
    s_waitcnt lgkmcnt(15)
    v_mfma_f32_32x32x16_bf16 v[128:143], a[192:195], a[60:63], v[128:143]
    ds_read_b64_tr_b16 a[176:177], v10 offset:20480
    ds_read_b64_tr_b16 a[178:179], v10 offset:20992
    s_add_u32 s18, s18, s80
    s_lshl_b32 s81, s81, 2
    s_add_u32 s81, s81, s3
    s_lshl_b32 s24, s81, 7
    v_mfma_f32_32x32x16_bf16 v[144:159], a[196:199], a[60:63], v[144:159]
    ds_read_b64_tr_b16 a[180:181], v10 offset:22528
    ds_read_b64_tr_b16 a[182:183], v10 offset:23040
    s_add_u32 s24, s24, 26218496
    s_mul_i32 s26, s81, 20480
    s_mul_i32 s25, s9, 160
    s_add_u32 s26, s26, s25
    v_mfma_f32_32x32x16_bf16 v[160:175], a[200:203], a[60:63], v[160:175]
    ds_read_b64_tr_b16 a[184:185], v13 offset:20480
    ds_read_b64_tr_b16 a[186:187], v13 offset:20992
    buffer_load_dwordx4 v8, s[56:59], s12 offen offset:3072 lds
    s_waitcnt lgkmcnt(6)
    s_lshl_b32 s21, s26, 1
    s_lshl_b32 s80, s2, 2
    s_add_u32 s80, s80, s3
    v_mfma_f32_32x32x16_bf16 v[176:191], a[204:207], a[60:63], v[176:191]
    ds_read_b64_tr_b16 a[188:189], v13 offset:22528
    ds_read_b64_tr_b16 a[190:191], v13 offset:23040
    s_mul_i32 s22, s80, 3584
    s_add_u32 s22, s22, 28311552
    s_xor_b32 s80, s80, 4
    v_mfma_f32_32x32x16_bf16 v[128:143], a[160:163], a[64:67], v[128:143]
    ds_read_b64_tr_b16 a[192:193], v10 offset:24576
    ds_read_b64_tr_b16 a[194:195], v10 offset:25088
    s_mul_i32 s23, s80, 3584
    s_add_u32 s23, s23, 28311552
    s_mov_b32 s28, -1
    s_mov_b32 s29, 0xfff
    v_mfma_f32_32x32x16_bf16 v[144:159], a[164:167], a[64:67], v[144:159]
    ds_read_b64_tr_b16 a[196:197], v10 offset:26624
    ds_read_b64_tr_b16 a[198:199], v10 offset:27136
    s_lshl_b32 s80, s3, 4
    s_lshr_b64 s[28:29], s[28:29], s80
    s_and_b32 s28, s28, 0xffff
    v_mul_f32 v3, v31, v96
    v_mfma_f32_32x32x16_bf16 v[160:175], a[168:171], a[64:67], v[160:175]
    s_add_u32 m0, s82, 114688
    ds_read_b64_tr_b16 a[200:201], v13 offset:24576
    ds_read_b64_tr_b16 a[202:203], v13 offset:25088
    buffer_load_dwordx4 v7, s[52:55], s13 offen offset:0 lds
    v_fmac_f32 v3, v32, v112
    v_mfma_f32_32x32x16_bf16 v[176:191], a[172:175], a[64:67], v[176:191]
    ds_read_b64_tr_b16 a[204:205], v13 offset:26624
    ds_read_b64_tr_b16 a[206:207], v13 offset:27136
    v_mul_f32 v112, v33, v112
    v_fmac_f32 v112, v32, v96
    v_mul_f32 v96, v31, v97
    s_waitcnt lgkmcnt(8)
    v_mfma_f32_32x32x16_bf16 v[128:143], a[176:179], a[68:71], v[128:143]
    ds_read_b64_tr_b16 a[160:161], v10 offset:28672
    ds_read_b64_tr_b16 a[162:163], v10 offset:29184
    v_fmac_f32 v96, v32, v113
    v_mul_f32 v113, v33, v113
    v_fmac_f32 v113, v32, v97
    v_mul_f32 v97, v31, v98
    v_mfma_f32_32x32x16_bf16 v[144:159], a[180:183], a[68:71], v[144:159]
    ds_read_b64_tr_b16 a[164:165], v10 offset:30720
    ds_read_b64_tr_b16 a[166:167], v10 offset:31232
    v_fmac_f32 v97, v32, v114
    v_mul_f32 v114, v33, v114
    v_fmac_f32 v114, v32, v98
    v_mul_f32 v98, v31, v99
    v_mfma_f32_32x32x16_bf16 v[160:175], a[184:187], a[68:71], v[160:175]
    ds_read_b64_tr_b16 a[168:169], v13 offset:28672
    ds_read_b64_tr_b16 a[170:171], v13 offset:29184
    buffer_load_dwordx4 v8, s[52:55], s13 offen offset:1024 lds
    v_fmac_f32 v98, v32, v115
    v_mul_f32 v115, v33, v115
    v_fmac_f32 v115, v32, v99
    v_mfma_f32_32x32x16_bf16 v[176:191], a[188:191], a[68:71], v[176:191]
    ds_read_b64_tr_b16 a[172:173], v13 offset:30720
    ds_read_b64_tr_b16 a[174:175], v13 offset:31232
    v_mul_f32 v99, v31, v100
    v_fmac_f32 v99, v32, v116
    v_mul_f32 v116, v33, v116
    s_waitcnt lgkmcnt(8)
    v_mfma_f32_32x32x16_bf16 v[128:143], a[192:195], a[72:75], v[128:143]
    ds_read_b64_tr_b16 a[176:177], v9 offset:49152
    ds_read_b64_tr_b16 a[178:179], v9 offset:49664
    v_fmac_f32 v116, v32, v100
    v_mul_f32 v100, v31, v101
    v_fmac_f32 v100, v32, v117
    v_mul_f32 v117, v33, v117
    v_mfma_f32_32x32x16_bf16 v[144:159], a[196:199], a[72:75], v[144:159]
    ds_read_b64_tr_b16 a[180:181], v9 offset:51200
    ds_read_b64_tr_b16 a[182:183], v9 offset:51712
    v_fmac_f32 v117, v32, v101
    v_mul_f32 v101, v31, v102
    v_fmac_f32 v101, v32, v118
    v_mul_f32 v118, v33, v118
    v_mfma_f32_32x32x16_bf16 v[160:175], a[200:203], a[72:75], v[160:175]
    ds_read_b64_tr_b16 a[184:185], v12 offset:49152
    ds_read_b64_tr_b16 a[186:187], v12 offset:49664
    buffer_load_dwordx4 v7, s[56:59], s13 offen offset:2048 lds
    v_fmac_f32 v118, v32, v102
    v_mul_f32 v102, v31, v103
    v_fmac_f32 v102, v32, v119
    v_mfma_f32_32x32x16_bf16 v[176:191], a[204:207], a[72:75], v[176:191]
    ds_read_b64_tr_b16 a[188:189], v12 offset:51200
    ds_read_b64_tr_b16 a[190:191], v12 offset:51712
    v_mul_f32 v119, v33, v119
    v_fmac_f32 v119, v32, v103
    v_mul_f32 v103, v31, v104
    s_waitcnt lgkmcnt(8)
    v_mfma_f32_32x32x16_bf16 v[128:143], a[160:163], a[76:79], v[128:143]
    ds_read_b64_tr_b16 a[192:193], v9 offset:53248
    ds_read_b64_tr_b16 a[194:195], v9 offset:53760
    v_fmac_f32 v103, v32, v120
    v_mul_f32 v120, v33, v120
    v_fmac_f32 v120, v32, v104
    v_mul_f32 v104, v31, v105
    v_mfma_f32_32x32x16_bf16 v[144:159], a[164:167], a[76:79], v[144:159]
    ds_read_b64_tr_b16 a[196:197], v9 offset:55296
    ds_read_b64_tr_b16 a[198:199], v9 offset:55808
    v_fmac_f32 v104, v32, v121
    v_mul_f32 v121, v33, v121
    v_fmac_f32 v121, v32, v105
    v_mul_f32 v105, v31, v106
    v_mfma_f32_32x32x16_bf16 v[160:175], a[168:171], a[76:79], v[160:175]
    ds_read_b64_tr_b16 a[200:201], v12 offset:53248
    ds_read_b64_tr_b16 a[202:203], v12 offset:53760
    buffer_load_dwordx4 v8, s[56:59], s13 offen offset:3072 lds
    v_fmac_f32 v105, v32, v122
    v_mul_f32 v122, v33, v122
    v_fmac_f32 v122, v32, v106
    v_mfma_f32_32x32x16_bf16 v[176:191], a[172:175], a[76:79], v[176:191]
    ds_read_b64_tr_b16 a[204:205], v12 offset:55296
    ds_read_b64_tr_b16 a[206:207], v12 offset:55808
    v_mul_f32 v106, v31, v107
    v_fmac_f32 v106, v32, v123
    v_mul_f32 v123, v33, v123
    s_waitcnt lgkmcnt(8)
    v_mfma_f32_32x32x16_bf16 v[128:143], a[176:179], a[80:83], v[128:143]
    ds_read_b64_tr_b16 a[160:161], v9 offset:57344
    ds_read_b64_tr_b16 a[162:163], v9 offset:57856
    v_fmac_f32 v123, v32, v107
    v_mul_f32 v107, v31, v108
    v_fmac_f32 v107, v32, v124
    v_mul_f32 v124, v33, v124
    v_mfma_f32_32x32x16_bf16 v[144:159], a[180:183], a[80:83], v[144:159]
    ds_read_b64_tr_b16 a[164:165], v9 offset:59392
    ds_read_b64_tr_b16 a[166:167], v9 offset:59904
    v_fmac_f32 v124, v32, v108
    v_mul_f32 v108, v31, v109
    v_fmac_f32 v108, v32, v125
    v_mul_f32 v125, v33, v125
    v_mfma_f32_32x32x16_bf16 v[160:175], a[184:187], a[80:83], v[160:175]
    s_add_u32 m0, s82, 32768
    s_add_u32 s13, s13, 221184
    ds_read_b64_tr_b16 a[168:169], v12 offset:57344
    ds_read_b64_tr_b16 a[170:171], v12 offset:57856
    buffer_load_dwordx4 v7, s[52:55], s13 offen offset:0 lds
    v_fmac_f32 v125, v32, v109
    s_barrier
    v_mfma_f32_32x32x16_bf16 v[176:191], a[188:191], a[80:83], v[176:191]
    ds_read_b64_tr_b16 a[172:173], v12 offset:59392
    ds_read_b64_tr_b16 a[174:175], v12 offset:59904
    s_lshr_b32 s80, s82, 1
    s_add_u32 s80, s80, 151552
    v_mov_b32 v60, 0
    s_waitcnt lgkmcnt(8)
    v_mfma_f32_32x32x16_bf16 v[128:143], a[192:195], a[84:87], v[128:143]
    ds_read_b64_tr_b16 a[176:177], v9 offset:61440
    ds_read_b64_tr_b16 a[178:179], v9 offset:61952
    v_mov_b32 v61, v26
    v_lshlrev_b32 v64, 3, v1
    v_add_u32 v64, 159744, v64
    v_mfma_f32_32x32x16_bf16 v[144:159], a[196:199], a[84:87], v[144:159]
    ds_read_b64_tr_b16 a[180:181], v9 offset:63488
    ds_read_b64_tr_b16 a[182:183], v9 offset:64000
    ds_write_b64 v64, v[60:61]
    v_mul_f32 v109, v31, v110
    v_mfma_f32_32x32x16_bf16 v[160:175], a[200:203], a[84:87], v[160:175]
    ds_read_b64_tr_b16 a[184:185], v12 offset:61440
    ds_read_b64_tr_b16 a[186:187], v12 offset:61952
    buffer_load_dwordx4 v8, s[52:55], s13 offen offset:1024 lds
    v_fmac_f32 v109, v32, v126
    v_mul_f32 v126, v33, v126
    v_fmac_f32 v126, v32, v110
    v_mfma_f32_32x32x16_bf16 v[176:191], a[204:207], a[84:87], v[176:191]
    ds_read_b64_tr_b16 a[188:189], v12 offset:63488
    ds_read_b64_tr_b16 a[190:191], v12 offset:64000
    v_mul_f32 v110, v31, v111
    v_fmac_f32 v110, v32, v127
    v_mul_f32 v127, v33, v127
    s_waitcnt lgkmcnt(9)
    v_mfma_f32_32x32x16_bf16 v[128:143], a[160:163], a[88:91], v[128:143]
    s_waitcnt vmcnt(16)
    s_barrier
    ds_read_b64_tr_b16 a[192:193], v10 offset:32768
    ds_read_b64_tr_b16 a[194:195], v10 offset:33280
    v_fmac_f32 v127, v32, v111
    v_accvgpr_read_b32 v93, a209
    v_mfma_f32_32x32x16_bf16 v[144:159], a[164:167], a[88:91], v[144:159]
    ds_read_b64_tr_b16 a[196:197], v10 offset:34816
    ds_read_b64_tr_b16 a[198:199], v10 offset:35328
    v_accvgpr_read_b32 v6, a211
    v_bitop3_b32 v4, v93, v6, v26 bitop3:0x7e
    v_accvgpr_read_b32 v93, a213
    v_accvgpr_read_b32 v6, a215
    v_mfma_f32_32x32x16_bf16 v[160:175], a[168:171], a[88:91], v[160:175]
    ds_read_b64_tr_b16 a[200:201], v13 offset:32768
    ds_read_b64_tr_b16 a[202:203], v13 offset:33280
    buffer_load_dwordx4 v7, s[56:59], s13 offen offset:2048 lds
    v_bitop3_b32 v93, v93, v6, v26 bitop3:0x7e
    v_or_b32 v4, v4, v93
    v_accvgpr_read_b32 v93, a217
    v_mfma_f32_32x32x16_bf16 v[176:191], a[172:175], a[88:91], v[176:191]
    ds_read_b64_tr_b16 a[204:205], v13 offset:34816
    ds_read_b64_tr_b16 a[206:207], v13 offset:35328
    v_accvgpr_read_b32 v6, a219
    v_bitop3_b32 v93, v93, v6, v26 bitop3:0x7e
    v_or_b32 v4, v4, v93
    s_waitcnt lgkmcnt(8)
    v_mfma_f32_32x32x16_bf16 v[128:143], a[176:179], a[92:95], v[128:143]
    ds_read_b64_tr_b16 a[160:161], v10 offset:36864
    ds_read_b64_tr_b16 a[162:163], v10 offset:37376
    v_accvgpr_read_b32 v93, a221
    v_accvgpr_read_b32 v6, a223
    v_bitop3_b32 v93, v93, v6, v26 bitop3:0x7e
    v_or_b32 v4, v4, v93
    v_mfma_f32_32x32x16_bf16 v[144:159], a[180:183], a[92:95], v[144:159]
    ds_read_b64_tr_b16 a[164:165], v10 offset:38912
    ds_read_b64_tr_b16 a[166:167], v10 offset:39424
    v_cmp_ne_u32 vcc, 0, v4
    s_nop 1
    s_cmp_lg_u64 vcc, 0
    s_cbranch_scc1 L_slow_8
L_ok_9:
    v_mfma_f32_32x32x16_bf16 v[160:175], a[184:187], a[92:95], v[160:175]
    ds_read_b64_tr_b16 a[168:169], v13 offset:36864
    ds_read_b64_tr_b16 a[170:171], v13 offset:37376
    buffer_load_dwordx4 v8, s[56:59], s13 offen offset:3072 lds
    v_mfma_f32_32x32x16_bf16 v[128:143], a[208:211], a[252:255], v[128:143]
    v_mfma_f32_32x32x16_bf16 v[176:191], a[188:191], a[92:95], v[176:191]
    s_lshr_b32 m0, s82, 1
    s_add_u32 m0, m0, 151552
    ds_read_b64_tr_b16 a[172:173], v13 offset:38912
    ds_read_b64_tr_b16 a[174:175], v13 offset:39424
    buffer_load_dwordx4 v20, s[64:67], s80 offen offset:0 sc1 lds
    s_waitcnt lgkmcnt(8)
    v_mfma_f32_32x32x16_bf16 v[128:143], a[192:195], a[96:99], v[128:143]
    ds_read_b64_tr_b16 a[176:177], v10 offset:40960
    ds_read_b64_tr_b16 a[178:179], v10 offset:41472
    buffer_load_dwordx4 v20, s[64:67], s80 offen offset:1024 sc1 lds
    v_mfma_f32_32x32x16_bf16 v[144:159], a[212:215], a[252:255], v[144:159]
    v_mfma_f32_32x32x16_bf16 v[144:159], a[196:199], a[96:99], v[144:159]
    ds_read_b64_tr_b16 a[180:181], v10 offset:43008
    ds_read_b64_tr_b16 a[182:183], v10 offset:43520
    v_mfma_f32_32x32x16_bf16 v[160:175], a[216:219], a[252:255], v[160:175]
    v_mfma_f32_32x32x16_bf16 v[160:175], a[200:203], a[96:99], v[160:175]
    s_add_u32 m0, s82, 81920
    s_add_u32 s13, s13, 221184
    ds_read_b64_tr_b16 a[184:185], v13 offset:40960
    ds_read_b64_tr_b16 a[186:187], v13 offset:41472
    buffer_load_dwordx4 v7, s[52:55], s13 offen offset:0 lds
    v_mfma_f32_32x32x16_bf16 v[176:191], a[220:223], a[252:255], v[176:191]
    v_mfma_f32_32x32x16_bf16 v[176:191], a[204:207], a[96:99], v[176:191]
    ds_read_b64_tr_b16 a[188:189], v13 offset:43008
    ds_read_b64_tr_b16 a[190:191], v13 offset:43520
    s_waitcnt lgkmcnt(8)
    v_mfma_f32_32x32x16_bf16 v[128:143], a[160:163], a[100:103], v[128:143]
    ds_read_b64_tr_b16 a[192:193], v10 offset:45056
    ds_read_b64_tr_b16 a[194:195], v10 offset:45568
    v_mfma_f32_32x32x16_bf16 v[144:159], a[164:167], a[100:103], v[144:159]
    ds_read_b64_tr_b16 a[196:197], v10 offset:47104
    ds_read_b64_tr_b16 a[198:199], v10 offset:47616
    v_mfma_f32_32x32x16_bf16 v[160:175], a[168:171], a[100:103], v[160:175]
    ds_read_b64_tr_b16 a[200:201], v13 offset:45056
    ds_read_b64_tr_b16 a[202:203], v13 offset:45568
    buffer_load_dwordx4 v8, s[52:55], s13 offen offset:1024 lds
    v_mfma_f32_32x32x16_bf16 v[176:191], a[172:175], a[100:103], v[176:191]
    ds_read_b64_tr_b16 a[204:205], v13 offset:47104
    ds_read_b64_tr_b16 a[206:207], v13 offset:47616
    buffer_load_dword v90, v91, s[76:79], 0 offen offset:0 sc1
    s_waitcnt lgkmcnt(8)
    v_mfma_f32_32x32x16_bf16 v[128:143], a[176:179], a[104:107], v[128:143]
    ds_read_b64_tr_b16 a[160:161], v10 offset:0
    ds_read_b64_tr_b16 a[162:163], v10 offset:512
    v_mfma_f32_32x32x16_bf16 v[144:159], a[180:183], a[104:107], v[144:159]
    ds_read_b64_tr_b16 a[164:165], v10 offset:2048
    ds_read_b64_tr_b16 a[166:167], v10 offset:2560
    v_mfma_f32_32x32x16_bf16 v[160:175], a[184:187], a[104:107], v[160:175]
    ds_read_b64_tr_b16 a[168:169], v13 offset:0
    ds_read_b64_tr_b16 a[170:171], v13 offset:512
    buffer_load_dwordx4 v7, s[56:59], s13 offen offset:2048 lds
    v_mfma_f32_32x32x16_bf16 v[176:191], a[188:191], a[104:107], v[176:191]
    ds_read_b64_tr_b16 a[172:173], v13 offset:2048
    ds_read_b64_tr_b16 a[174:175], v13 offset:2560
    s_waitcnt lgkmcnt(8)
    v_mfma_f32_32x32x16_bf16 v[128:143], a[192:195], a[108:111], v[128:143]
    ds_read_b64_tr_b16 a[176:177], v10 offset:4096
    ds_read_b64_tr_b16 a[178:179], v10 offset:4608
    s_waitcnt vmcnt(4)
    s_barrier
    ds_read_b128 v[64:67], v80
    v_mfma_f32_32x32x16_bf16 v[144:159], a[196:199], a[108:111], v[144:159]
    ds_read_b64_tr_b16 a[180:181], v10 offset:6144
    ds_read_b64_tr_b16 a[182:183], v10 offset:6656
    ds_read_b128 v[68:71], v81
    ds_read_b128 v[72:75], v82
    v_mfma_f32_32x32x16_bf16 v[160:175], a[200:203], a[108:111], v[160:175]
    ds_read_b64_tr_b16 a[184:185], v13 offset:4096
    ds_read_b64_tr_b16 a[186:187], v13 offset:4608
    buffer_load_dwordx4 v8, s[56:59], s13 offen offset:3072 lds
    ds_read_b128 v[76:79], v83
    ds_read_b128 v[44:47], v84
    v_mfma_f32_32x32x16_bf16 v[176:191], a[204:207], a[108:111], v[176:191]
    ds_read_b64_tr_b16 a[188:189], v13 offset:6144
    ds_read_b64_tr_b16 a[190:191], v13 offset:6656
    ds_read_b128 v[48:51], v85
    ds_read_b128 v[52:55], v86
    s_waitcnt lgkmcnt(15)
    v_mfma_f32_32x32x16_bf16 v[128:143], a[160:163], a[112:115], v[128:143]
    ds_read_b64_tr_b16 a[192:193], v10 offset:8192
    ds_read_b64_tr_b16 a[194:195], v10 offset:8704
    ds_read_b128 v[56:59], v87
    v_mfma_f32_32x32x16_bf16 v[144:159], a[164:167], a[112:115], v[144:159]
    ds_read_b64_tr_b16 a[196:197], v10 offset:10240
    ds_read_b64_tr_b16 a[198:199], v10 offset:10752
    v_mfma_f32_32x32x16_bf16 v[160:175], a[168:171], a[112:115], v[160:175]
    s_add_u32 m0, s82, 131072
    s_add_u32 s13, s13, 221184
    ds_read_b64_tr_b16 a[200:201], v13 offset:8192
    ds_read_b64_tr_b16 a[202:203], v13 offset:8704
    buffer_load_dwordx4 v7, s[52:55], s13 offen offset:0 lds
    v_mfma_f32_32x32x16_bf16 v[176:191], a[172:175], a[112:115], v[176:191]
    ds_read_b64_tr_b16 a[204:205], v13 offset:10240
    ds_read_b64_tr_b16 a[206:207], v13 offset:10752
    s_waitcnt lgkmcnt(11)
    v_mfma_f32_32x32x16_bf16 v[128:143], a[176:179], a[116:119], v[128:143]
    ds_read_b64_tr_b16 a[160:161], v10 offset:12288
    ds_read_b64_tr_b16 a[162:163], v10 offset:12800
    s_waitcnt lgkmcnt(8)
    v_bitop3_b32 v65, v65, v67, v26 bitop3:0x7e
    v_bitop3_b32 v69, v69, v71, v26 bitop3:0x7e
    v_bitop3_b32 v73, v73, v75, v26 bitop3:0x7e
    v_mfma_f32_32x32x16_bf16 v[144:159], a[180:183], a[116:119], v[144:159]
    ds_read_b64_tr_b16 a[164:165], v10 offset:14336
    ds_read_b64_tr_b16 a[166:167], v10 offset:14848
    v_bitop3_b32 v77, v77, v79, v26 bitop3:0x7e
    v_bitop3_b32 v45, v45, v47, v26 bitop3:0x7e
    v_bitop3_b32 v49, v49, v51, v26 bitop3:0x7e
    v_bitop3_b32 v53, v53, v55, v26 bitop3:0x7e
    v_bitop3_b32 v57, v57, v59, v26 bitop3:0x7e
    v_mfma_f32_32x32x16_bf16 v[160:175], a[184:187], a[116:119], v[160:175]
    ds_read_b64_tr_b16 a[168:169], v13 offset:12288
    ds_read_b64_tr_b16 a[170:171], v13 offset:12800
    buffer_load_dwordx4 v8, s[52:55], s13 offen offset:1024 lds
    v_or3_b32 v65, v65, v69, v73
    v_or3_b32 v77, v77, v45, v49
    v_or3_b32 v65, v65, v53, v57
    v_or_b32 v65, v65, v77
    v_mfma_f32_32x32x16_bf16 v[176:191], a[188:191], a[116:119], v[176:191]
    ds_read_b64_tr_b16 a[172:173], v13 offset:14336
    ds_read_b64_tr_b16 a[174:175], v13 offset:14848
    v_cmp_ne_u32 vcc, 0, v65
    s_nop 1
    s_cmp_lg_u64 vcc, 0
    s_cbranch_scc1 L_slow_10
L_ok_11:
    s_waitcnt lgkmcnt(8)
    v_mfma_f32_32x32x16_bf16 v[128:143], a[192:195], a[120:123], v[128:143]
    s_barrier
    ds_read_b64_tr_b16 a[176:177], v9 offset:16384
    ds_read_b64_tr_b16 a[178:179], v9 offset:16896
    v_fmac_f32 v52, v38, v56
    v_fmac_f32 v54, v38, v58
    v_fma_f32 v52, -v39, v58, v52
    v_fmac_f32 v54, v39, v56
    v_mfma_f32_32x32x16_bf16 v[144:159], a[196:199], a[120:123], v[144:159]
    ds_read_b64_tr_b16 a[180:181], v9 offset:18432
    ds_read_b64_tr_b16 a[182:183], v9 offset:18944
    v_fmac_f32 v48, v38, v52
    v_fmac_f32 v50, v38, v54
    v_fma_f32 v48, -v39, v54, v48
    v_fmac_f32 v50, v39, v52
    v_fmac_f32 v44, v38, v48
    v_mfma_f32_32x32x16_bf16 v[160:175], a[200:203], a[120:123], v[160:175]
    ds_read_b64_tr_b16 a[184:185], v12 offset:16384
    ds_read_b64_tr_b16 a[186:187], v12 offset:16896
    buffer_load_dwordx4 v7, s[56:59], s13 offen offset:2048 lds
    v_fmac_f32 v46, v38, v50
    v_fma_f32 v44, -v39, v50, v44
    v_fmac_f32 v46, v39, v48
    v_fmac_f32 v76, v38, v44
    v_mfma_f32_32x32x16_bf16 v[176:191], a[204:207], a[120:123], v[176:191]
    ds_read_b64_tr_b16 a[188:189], v12 offset:18432
    ds_read_b64_tr_b16 a[190:191], v12 offset:18944
    v_fmac_f32 v78, v38, v46
    v_fma_f32 v76, -v39, v46, v76
    v_fmac_f32 v78, v39, v44
    v_fmac_f32 v72, v38, v76
    s_waitcnt lgkmcnt(8)
    v_mfma_f32_32x32x16_bf16 v[128:143], a[160:163], a[124:127], v[128:143]
    ds_read_b64_tr_b16 a[192:193], v9 offset:20480
    ds_read_b64_tr_b16 a[194:195], v9 offset:20992
    v_fmac_f32 v74, v38, v78
    v_fma_f32 v72, -v39, v78, v72
    v_fmac_f32 v74, v39, v76
    v_fmac_f32 v68, v38, v72
    v_fmac_f32 v70, v38, v74
    v_mfma_f32_32x32x16_bf16 v[144:159], a[164:167], a[124:127], v[144:159]
    ds_read_b64_tr_b16 a[196:197], v9 offset:22528
    ds_read_b64_tr_b16 a[198:199], v9 offset:23040
    v_fma_f32 v68, -v39, v74, v68
    v_fmac_f32 v70, v39, v72
    v_fmac_f32 v64, v38, v68
    v_fmac_f32 v66, v38, v70
    v_fma_f32 v64, -v39, v70, v64
    v_mfma_f32_32x32x16_bf16 v[160:175], a[168:171], a[124:127], v[160:175]
    ds_read_b64_tr_b16 a[200:201], v12 offset:20480
    ds_read_b64_tr_b16 a[202:203], v12 offset:20992
    buffer_load_dwordx4 v8, s[56:59], s13 offen offset:3072 lds
    v_fmac_f32 v66, v39, v68
    v_mov_b32 v68, v64
    v_mov_b32 v70, v66
    s_lshl_b32 s80, s6, 13
    v_mfma_f32_32x32x16_bf16 v[176:191], a[172:175], a[124:127], v[176:191]
    ds_read_b64_tr_b16 a[204:205], v12 offset:22528
    ds_read_b64_tr_b16 a[206:207], v12 offset:23040
    s_add_u32 s80, s80, s14
    v_permlane32_swap_b32 v64, v68
    v_permlane32_swap_b32 v66, v70
    s_add_u32 s80, s80, 0
    s_waitcnt lgkmcnt(8)
    v_mfma_f32_32x32x16_bf16 v[128:143], a[176:179], a[128:131], v[128:143]
    ds_read_b64_tr_b16 a[160:161], v9 offset:24576
    ds_read_b64_tr_b16 a[162:163], v9 offset:25088
    s_add_u32 s81, s80, 4096
    v_fmac_f32 v64, v36, v68
    v_fmac_f32 v66, v36, v70
    v_fma_f32 v64, -v37, v70, v64
    v_fmac_f32 v66, v37, v68
    v_mfma_f32_32x32x16_bf16 v[144:159], a[180:183], a[128:131], v[144:159]
    ds_read_b64_tr_b16 a[164:165], v9 offset:26624
    ds_read_b64_tr_b16 a[166:167], v9 offset:27136
    v_fmac_f32 v42, v40, v64
    v_fmac_f32 v43, v40, v66
    v_fma_f32 v42, -v41, v66, v42
    v_fmac_f32 v43, v41, v64
    v_mul_f32 v64, v31, v42
    v_mfma_f32_32x32x16_bf16 v[160:175], a[184:187], a[128:131], v[160:175]
    s_add_u32 m0, s82, 98304
    s_add_u32 s13, s13, 221184
    ds_read_b64_tr_b16 a[168:169], v12 offset:24576
    ds_read_b64_tr_b16 a[170:171], v12 offset:25088
    buffer_load_dwordx4 v7, s[52:55], s13 offen offset:0 lds
    v_mul_f32 v65, v32, v42
    v_fmac_f32 v64, v32, v43
    v_mfma_f32_32x32x16_bf16 v[176:191], a[188:191], a[128:131], v[176:191]
    ds_read_b64_tr_b16 a[172:173], v12 offset:26624
    ds_read_b64_tr_b16 a[174:175], v12 offset:27136
    v_fmac_f32 v65, v33, v43
    v_fmac_f32 v3, v28, v64
    v_fmac_f32 v112, v28, v65
    v_fmac_f32 v3, v29, v65
    s_waitcnt lgkmcnt(8)
    v_mfma_f32_32x32x16_bf16 v[128:143], a[192:195], a[132:135], v[128:143]
    ds_read_b64_tr_b16 a[176:177], v9 offset:28672
    ds_read_b64_tr_b16 a[178:179], v9 offset:29184
    v_fmac_f32 v112, v30, v64
    v_fmac_f32 v96, v28, v3
    v_fmac_f32 v113, v28, v112
    v_fmac_f32 v96, v29, v112
    v_fmac_f32 v113, v30, v3
    v_mfma_f32_32x32x16_bf16 v[144:159], a[196:199], a[132:135], v[144:159]
    ds_read_b64_tr_b16 a[180:181], v9 offset:30720
    ds_read_b64_tr_b16 a[182:183], v9 offset:31232
    s_waitcnt vmcnt(7)
    v_cmp_ne_u32 vcc, v90, v26
    s_nop 1
    s_cmp_lg_u64 vcc, 0
    s_cbranch_scc1 L_slow_12
L_ok_13:
    s_barrier
    buffer_store_dword v26, v94, s[48:51], 0 offen sc1
    v_mfma_f32_32x32x16_bf16 v[160:175], a[200:203], a[132:135], v[160:175]
    ds_read_b64_tr_b16 a[184:185], v12 offset:28672
    ds_read_b64_tr_b16 a[186:187], v12 offset:29184
    buffer_load_dwordx4 v8, s[52:55], s13 offen offset:1024 lds
    v_fmac_f32 v97, v28, v96
    v_fmac_f32 v114, v28, v113
    v_fmac_f32 v97, v29, v113
    v_fmac_f32 v114, v30, v96
    v_mfma_f32_32x32x16_bf16 v[176:191], a[204:207], a[132:135], v[176:191]
    ds_read_b64_tr_b16 a[188:189], v12 offset:30720
    ds_read_b64_tr_b16 a[190:191], v12 offset:31232
    v_fmac_f32 v98, v28, v97
    v_fmac_f32 v115, v28, v114
    v_fmac_f32 v98, v29, v114
    v_fmac_f32 v115, v30, v97
    s_waitcnt lgkmcnt(8)
    v_mfma_f32_32x32x16_bf16 v[128:143], a[160:163], a[136:139], v[128:143]
    s_add_u32 s45, s20, 0
    ds_read_b64_tr_b16 a[192:193], v9 offset:0
    ds_read_b64_tr_b16 a[194:195], v9 offset:512
    buffer_load_dwordx4 a[240:243], v20, s[48:51], s45 offen offset:0 sc1
    v_fmac_f32 v99, v28, v98
    v_fmac_f32 v116, v28, v115
    v_fmac_f32 v99, v29, v115
    v_mfma_f32_32x32x16_bf16 v[144:159], a[164:167], a[136:139], v[144:159]
    ds_read_b64_tr_b16 a[196:197], v9 offset:2048
    ds_read_b64_tr_b16 a[198:199], v9 offset:2560
    v_fmac_f32 v116, v30, v98
    v_fmac_f32 v100, v28, v99
    v_fmac_f32 v117, v28, v116
    v_fmac_f32 v100, v29, v116
    v_fmac_f32 v117, v30, v99
    v_mfma_f32_32x32x16_bf16 v[160:175], a[168:171], a[136:139], v[160:175]
    ds_read_b64_tr_b16 a[200:201], v12 offset:0
    ds_read_b64_tr_b16 a[202:203], v12 offset:512
    buffer_load_dwordx4 v7, s[56:59], s13 offen offset:2048 lds
    v_fmac_f32 v101, v28, v100
    v_fmac_f32 v118, v28, v117
    v_fmac_f32 v101, v29, v117
    v_fmac_f32 v118, v30, v100
    v_mfma_f32_32x32x16_bf16 v[176:191], a[172:175], a[136:139], v[176:191]
    ds_read_b64_tr_b16 a[204:205], v12 offset:2048
    ds_read_b64_tr_b16 a[206:207], v12 offset:2560
    v_fmac_f32 v102, v28, v101
    v_fmac_f32 v119, v28, v118
    v_fmac_f32 v102, v29, v118
    v_fmac_f32 v119, v30, v101
    s_waitcnt lgkmcnt(8)
    v_mfma_f32_32x32x16_bf16 v[128:143], a[176:179], a[140:143], v[128:143]
    ds_read_b64_tr_b16 a[160:161], v9 offset:4096
    ds_read_b64_tr_b16 a[162:163], v9 offset:4608
    buffer_load_dwordx4 a[244:247], v20, s[48:51], s45 offen offset:1024 sc1
    v_fmac_f32 v103, v28, v102
    v_fmac_f32 v120, v28, v119
    v_fmac_f32 v103, v29, v119
    v_fmac_f32 v120, v30, v102
    v_mfma_f32_32x32x16_bf16 v[144:159], a[180:183], a[140:143], v[144:159]
    ds_read_b64_tr_b16 a[164:165], v9 offset:6144
    ds_read_b64_tr_b16 a[166:167], v9 offset:6656
    v_fmac_f32 v104, v28, v103
    v_fmac_f32 v121, v28, v120
    v_fmac_f32 v104, v29, v120
    v_fmac_f32 v121, v30, v103
    v_fmac_f32 v105, v28, v104
    v_mfma_f32_32x32x16_bf16 v[160:175], a[184:187], a[140:143], v[160:175]
    ds_read_b64_tr_b16 a[168:169], v12 offset:4096
    ds_read_b64_tr_b16 a[170:171], v12 offset:4608
    buffer_load_dwordx4 v8, s[56:59], s13 offen offset:3072 lds
    v_fmac_f32 v122, v28, v121
    v_fmac_f32 v105, v29, v121
    v_fmac_f32 v122, v30, v104
    v_fmac_f32 v106, v28, v105
    v_mfma_f32_32x32x16_bf16 v[176:191], a[188:191], a[140:143], v[176:191]
    ds_read_b64_tr_b16 a[172:173], v12 offset:6144
    ds_read_b64_tr_b16 a[174:175], v12 offset:6656
    v_fmac_f32 v123, v28, v122
    v_fmac_f32 v106, v29, v122
    v_fmac_f32 v123, v30, v105
    v_fmac_f32 v107, v28, v106
    s_waitcnt lgkmcnt(8)
    v_mfma_f32_32x32x16_bf16 v[128:143], a[192:195], a[144:147], v[128:143]
    ds_read_b64_tr_b16 a[176:177], v9 offset:8192
    ds_read_b64_tr_b16 a[178:179], v9 offset:8704
    buffer_load_dwordx4 a[248:251], v20, s[48:51], s45 offen offset:2048 sc1
    v_fmac_f32 v124, v28, v123
    v_fmac_f32 v107, v29, v123
    v_fmac_f32 v124, v30, v106
    v_fmac_f32 v108, v28, v107
    v_mfma_f32_32x32x16_bf16 v[144:159], a[196:199], a[144:147], v[144:159]
    ds_read_b64_tr_b16 a[180:181], v9 offset:10240
    ds_read_b64_tr_b16 a[182:183], v9 offset:10752
    v_fmac_f32 v125, v28, v124
    v_fmac_f32 v108, v29, v124
    v_fmac_f32 v125, v30, v107
    v_fmac_f32 v109, v28, v108
    v_fmac_f32 v126, v28, v125
    v_mfma_f32_32x32x16_bf16 v[160:175], a[200:203], a[144:147], v[160:175]
    s_add_u32 m0, s82, 49152
    s_add_u32 s13, s13, 221184
    ds_read_b64_tr_b16 a[184:185], v12 offset:8192
    ds_read_b64_tr_b16 a[186:187], v12 offset:8704
    buffer_load_dwordx4 v7, s[52:55], s13 offen offset:0 lds
    v_fmac_f32 v109, v29, v125
    v_fmac_f32 v126, v30, v108
    v_mfma_f32_32x32x16_bf16 v[176:191], a[204:207], a[144:147], v[176:191]
    ds_read_b64_tr_b16 a[188:189], v12 offset:10240
    ds_read_b64_tr_b16 a[190:191], v12 offset:10752
    v_fmac_f32 v110, v28, v109
    v_fmac_f32 v127, v28, v126
    v_fmac_f32 v110, v29, v126
    v_fmac_f32 v127, v30, v109
    s_waitcnt lgkmcnt(8)
    v_mfma_f32_32x32x16_bf16 v[128:143], a[160:163], a[148:151], v[128:143]
    ds_read_b64_tr_b16 a[192:193], v9 offset:12288
    ds_read_b64_tr_b16 a[194:195], v9 offset:12800
    buffer_load_dwordx4 a[208:211], v20, s[48:51], s45 offen offset:3072 sc1
    v_cvt_pk_bf16_f32 v64, v3, v96
    v_cvt_pk_bf16_f32 v65, v97, v98
    v_mfma_f32_32x32x16_bf16 v[144:159], a[164:167], a[148:151], v[144:159]
    ds_read_b64_tr_b16 a[196:197], v9 offset:14336
    ds_read_b64_tr_b16 a[198:199], v9 offset:14848
    ds_write_b64 v24, v[64:65] offset:0
    v_cvt_pk_bf16_f32 v66, v99, v100
    v_cvt_pk_bf16_f32 v67, v101, v102
    v_mfma_f32_32x32x16_bf16 v[160:175], a[168:171], a[148:151], v[160:175]
    ds_read_b64_tr_b16 a[200:201], v12 offset:12288
    ds_read_b64_tr_b16 a[202:203], v12 offset:12800
    buffer_load_dwordx4 v8, s[52:55], s13 offen offset:1024 lds
    ds_write_b64 v24, v[66:67] offset:8
    v_cvt_pk_bf16_f32 v68, v103, v104
    v_mfma_f32_32x32x16_bf16 v[176:191], a[172:175], a[148:151], v[176:191]
    ds_read_b64_tr_b16 a[204:205], v12 offset:14336
    ds_read_b64_tr_b16 a[206:207], v12 offset:14848
    v_cvt_pk_bf16_f32 v69, v105, v106
    s_waitcnt lgkmcnt(10)
    v_mfma_f32_32x32x16_bf16 v[128:143], a[176:179], a[152:155], v[128:143]
    s_barrier
    s_add_u32 s45, s20, 4096
    ds_read_b64_tr_b16 a[160:161], v10 offset:49152
    ds_read_b64_tr_b16 a[162:163], v10 offset:49664
    buffer_load_dwordx4 a[212:215], v20, s[48:51], s45 offen offset:0 sc1
    ds_write_b64 v24, v[68:69] offset:16
    v_mfma_f32_32x32x16_bf16 v[144:159], a[180:183], a[152:155], v[144:159]
    ds_read_b64_tr_b16 a[164:165], v10 offset:51200
    ds_read_b64_tr_b16 a[166:167], v10 offset:51712
    v_cvt_pk_bf16_f32 v70, v107, v108
    v_cvt_pk_bf16_f32 v71, v109, v110
    v_mfma_f32_32x32x16_bf16 v[160:175], a[184:187], a[152:155], v[160:175]
    ds_read_b64_tr_b16 a[168:169], v13 offset:49152
    ds_read_b64_tr_b16 a[170:171], v13 offset:49664
    buffer_load_dwordx4 v7, s[56:59], s13 offen offset:2048 lds
    ds_write_b64 v24, v[70:71] offset:24
    ds_read_b64_tr_b16 v[44:45], v25 offset:0
    v_mfma_f32_32x32x16_bf16 v[176:191], a[188:191], a[152:155], v[176:191]
    ds_read_b64_tr_b16 a[172:173], v13 offset:51200
    ds_read_b64_tr_b16 a[174:175], v13 offset:51712
    ds_read_b64_tr_b16 v[46:47], v25 offset:320
    s_waitcnt lgkmcnt(12)
    v_mfma_f32_32x32x16_bf16 v[128:143], a[192:195], a[156:159], v[128:143]
    s_add_u32 s45, s20, 40960
    ds_read_b64_tr_b16 a[176:177], v10 offset:53248
    ds_read_b64_tr_b16 a[178:179], v10 offset:53760
    buffer_load_dwordx4 a[216:219], v20, s[48:51], s45 offen offset:0 sc1
    ds_read_b64_tr_b16 v[48:49], v25 offset:32
    ds_read_b64_tr_b16 v[50:51], v25 offset:352
    v_mfma_f32_32x32x16_bf16 v[144:159], a[196:199], a[156:159], v[144:159]
    ds_read_b64_tr_b16 a[180:181], v10 offset:55296
    ds_read_b64_tr_b16 a[182:183], v10 offset:55808
    v_cvt_pk_bf16_f32 v72, v112, v113
    v_cvt_pk_bf16_f32 v73, v114, v115
    v_mfma_f32_32x32x16_bf16 v[160:175], a[200:203], a[156:159], v[160:175]
    ds_read_b64_tr_b16 a[184:185], v13 offset:53248
    ds_read_b64_tr_b16 a[186:187], v13 offset:53760
    buffer_load_dwordx4 v8, s[56:59], s13 offen offset:3072 lds
    ds_write_b64 v24, v[72:73] offset:0
    v_cvt_pk_bf16_f32 v74, v116, v117
    v_mfma_f32_32x32x16_bf16 v[176:191], a[204:207], a[156:159], v[176:191]
    ds_read_b64_tr_b16 a[188:189], v13 offset:55296
    ds_read_b64_tr_b16 a[190:191], v13 offset:55808
    v_cvt_pk_bf16_f32 v75, v118, v119
    s_waitcnt lgkmcnt(12)
    v_mfma_f32_32x32x16_bf16 v[192:207], a[160:163], a[0:3], 0
    ds_read_b64_tr_b16 a[192:193], v10 offset:57344
    ds_read_b64_tr_b16 a[194:195], v10 offset:57856
    buffer_load_dwordx4 a[220:223], v20, s[48:51], s45 offen offset:1024 sc1
    ds_write_b64 v24, v[74:75] offset:8
    v_cvt_pk_bf16_f32 v76, v120, v121
    v_mfma_f32_32x32x16_bf16 v[208:223], a[164:167], a[0:3], 0
    ds_read_b64_tr_b16 a[196:197], v10 offset:59392
    ds_read_b64_tr_b16 a[198:199], v10 offset:59904
    v_cvt_pk_bf16_f32 v77, v122, v123
    v_mfma_f32_32x32x16_bf16 v[224:239], a[168:171], a[0:3], 0
    s_add_u32 m0, s82, 65536
    s_add_u32 s13, s13, 221184
    ds_read_b64_tr_b16 a[200:201], v13 offset:57344
    ds_read_b64_tr_b16 a[202:203], v13 offset:57856
    buffer_load_dwordx4 v7, s[52:55], s13 offen offset:0 lds
    ds_write_b64 v24, v[76:77] offset:16
    v_mfma_f32_32x32x16_bf16 v[240:255], a[172:175], a[0:3], 0
    ds_read_b64_tr_b16 a[204:205], v13 offset:59392
    ds_read_b64_tr_b16 a[206:207], v13 offset:59904
    v_cvt_pk_bf16_f32 v78, v124, v125
    v_cvt_pk_bf16_f32 v79, v126, v127
    s_waitcnt lgkmcnt(10)
    v_mfma_f32_32x32x16_bf16 v[192:207], a[176:179], a[4:7], v[192:207]
    ds_read_b64_tr_b16 a[160:161], v10 offset:61440
    ds_read_b64_tr_b16 a[162:163], v10 offset:61952
    buffer_load_dwordx4 a[0:3], v20, s[48:51], s45 offen offset:2048 sc1
    ds_write_b64 v24, v[78:79] offset:24
    ds_read_b64_tr_b16 v[52:53], v25 offset:0
    v_mfma_f32_32x32x16_bf16 v[208:223], a[180:183], a[4:7], v[208:223]
    ds_read_b64_tr_b16 a[164:165], v10 offset:63488
    ds_read_b64_tr_b16 a[166:167], v10 offset:64000
    ds_read_b64_tr_b16 v[54:55], v25 offset:320
    v_mfma_f32_32x32x16_bf16 v[224:239], a[184:187], a[4:7], v[224:239]
    ds_read_b64_tr_b16 a[168:169], v13 offset:61440
    ds_read_b64_tr_b16 a[170:171], v13 offset:61952
    buffer_load_dwordx4 v8, s[52:55], s13 offen offset:1024 lds
    ds_read_b64_tr_b16 v[56:57], v25 offset:32
    ds_read_b64_tr_b16 v[58:59], v25 offset:352
    v_mfma_f32_32x32x16_bf16 v[240:255], a[188:191], a[4:7], v[240:255]
    ds_read_b64_tr_b16 a[172:173], v13 offset:63488
    ds_read_b64_tr_b16 a[174:175], v13 offset:64000
    s_waitcnt lgkmcnt(13)
    v_mfma_f32_32x32x16_bf16 v[192:207], a[192:195], a[8:11], v[192:207]
    ds_read_b64_tr_b16 a[176:177], v9 offset:32768
    ds_read_b64_tr_b16 a[178:179], v9 offset:33280
    buffer_load_dwordx4 a[4:7], v20, s[48:51], s45 offen offset:3072 sc1
    v_mfma_f32_32x32x16_bf16 v[208:223], a[196:199], a[8:11], v[208:223]
    ds_read_b64_tr_b16 a[180:181], v9 offset:34816
    ds_read_b64_tr_b16 a[182:183], v9 offset:35328
    v_mfma_f32_32x32x16_bf16 v[224:239], a[200:203], a[8:11], v[224:239]
    ds_read_b64_tr_b16 a[184:185], v12 offset:32768
    ds_read_b64_tr_b16 a[186:187], v12 offset:33280
    buffer_load_dwordx4 v7, s[56:59], s13 offen offset:2048 lds
    v_mfma_f32_32x32x16_bf16 v[240:255], a[204:207], a[8:11], v[240:255]
    ds_read_b64_tr_b16 a[188:189], v12 offset:34816
    ds_read_b64_tr_b16 a[190:191], v12 offset:35328
    s_waitcnt lgkmcnt(8)
    v_mfma_f32_32x32x16_bf16 v[192:207], a[160:163], a[12:15], v[192:207]
    s_add_u32 s45, s20, 45056
    ds_read_b64_tr_b16 a[192:193], v9 offset:36864
    ds_read_b64_tr_b16 a[194:195], v9 offset:37376
    buffer_load_dwordx4 a[8:11], v20, s[48:51], s45 offen offset:0 sc1
    v_mfma_f32_32x32x16_bf16 v[208:223], a[164:167], a[12:15], v[208:223]
    ds_read_b64_tr_b16 a[196:197], v9 offset:38912
    ds_read_b64_tr_b16 a[198:199], v9 offset:39424
    buffer_store_dwordx4 v[44:47], v20, s[72:75], s80 offen offset:0 sc1
    v_mfma_f32_32x32x16_bf16 v[224:239], a[168:171], a[12:15], v[224:239]
    ds_read_b64_tr_b16 a[200:201], v12 offset:36864
    ds_read_b64_tr_b16 a[202:203], v12 offset:37376
    buffer_load_dwordx4 v8, s[56:59], s13 offen offset:3072 lds
    v_mfma_f32_32x32x16_bf16 v[240:255], a[172:175], a[12:15], v[240:255]
    ds_read_b64_tr_b16 a[204:205], v12 offset:38912
    ds_read_b64_tr_b16 a[206:207], v12 offset:39424
    buffer_store_dwordx4 v[48:51], v20, s[72:75], s80 offen offset:1024 sc1
    s_waitcnt lgkmcnt(8)
    v_mfma_f32_32x32x16_bf16 v[192:207], a[176:179], a[16:19], v[192:207]
    ds_read_b64_tr_b16 a[160:161], v9 offset:40960
    ds_read_b64_tr_b16 a[162:163], v9 offset:41472
    buffer_store_dwordx4 v[52:55], v20, s[72:75], s81 offen offset:0 sc1
    v_mfma_f32_32x32x16_bf16 v[208:223], a[180:183], a[16:19], v[208:223]
    ds_read_b64_tr_b16 a[164:165], v9 offset:43008
    ds_read_b64_tr_b16 a[166:167], v9 offset:43520
    buffer_store_dwordx4 v[56:59], v20, s[72:75], s81 offen offset:1024 sc1
    v_mfma_f32_32x32x16_bf16 v[224:239], a[184:187], a[16:19], v[224:239]
    s_add_u32 m0, s82, 16384
    s_add_u32 s13, s13, 221184
    ds_read_b64_tr_b16 a[168:169], v12 offset:40960
    ds_read_b64_tr_b16 a[170:171], v12 offset:41472
    buffer_load_dwordx4 v7, s[52:55], s13 offen offset:0 lds
    v_mfma_f32_32x32x16_bf16 v[240:255], a[188:191], a[16:19], v[240:255]
    ds_read_b64_tr_b16 a[172:173], v12 offset:43008
    ds_read_b64_tr_b16 a[174:175], v12 offset:43520
    s_waitcnt lgkmcnt(8)
    v_mfma_f32_32x32x16_bf16 v[192:207], a[192:195], a[20:23], v[192:207]
    ds_read_b64_tr_b16 a[176:177], v9 offset:45056
    ds_read_b64_tr_b16 a[178:179], v9 offset:45568
    v_mfma_f32_32x32x16_bf16 v[208:223], a[196:199], a[20:23], v[208:223]
    ds_read_b64_tr_b16 a[180:181], v9 offset:47104
    ds_read_b64_tr_b16 a[182:183], v9 offset:47616
    v_mfma_f32_32x32x16_bf16 v[224:239], a[200:203], a[20:23], v[224:239]
    ds_read_b64_tr_b16 a[184:185], v12 offset:45056
    ds_read_b64_tr_b16 a[186:187], v12 offset:45568
    buffer_load_dwordx4 v8, s[52:55], s13 offen offset:1024 lds
    s_lshl_b32 s83, s5, 13
    s_add_u32 s83, s83, s14
    s_add_u32 s83, s83, 81920
    v_mul_f32 v128, v88, v128
    v_mfma_f32_32x32x16_bf16 v[240:255], a[204:207], a[20:23], v[240:255]
    ds_read_b64_tr_b16 a[188:189], v12 offset:47104
    ds_read_b64_tr_b16 a[190:191], v12 offset:47616
    v_mul_f32 v129, v88, v129
    v_exp_f32 v128, v128
    v_mul_f32 v130, v88, v130
    s_waitcnt lgkmcnt(8)
    v_mfma_f32_32x32x16_bf16 v[192:207], a[160:163], a[24:27], v[192:207]
    s_waitcnt vmcnt(29)
    s_barrier
    s_add_u32 s45, s20, 81920
    ds_read_b64_tr_b16 a[192:193], v10 offset:16384
    ds_read_b64_tr_b16 a[194:195], v10 offset:16896
    buffer_load_dwordx4 a[12:15], v20, s[48:51], s45 offen offset:0 sc1
    v_mfma_f32_32x32x16_bf16 v[208:223], a[164:167], a[24:27], v[208:223]
    ds_read_b64_tr_b16 a[196:197], v10 offset:18432
    ds_read_b64_tr_b16 a[198:199], v10 offset:18944
    v_exp_f32 v129, v129
    v_fma_f32 v128, v128, v89, v89
    v_mul_f32 v131, v88, v131
    v_mfma_f32_32x32x16_bf16 v[224:239], a[168:171], a[24:27], v[224:239]
    ds_read_b64_tr_b16 a[200:201], v13 offset:16384
    ds_read_b64_tr_b16 a[202:203], v13 offset:16896
    buffer_load_dwordx4 v7, s[56:59], s13 offen offset:2048 lds
    v_exp_f32 v130, v130
    v_fma_f32 v129, v129, v89, v89
    v_mfma_f32_32x32x16_bf16 v[240:255], a[172:175], a[24:27], v[240:255]
    ds_read_b64_tr_b16 a[204:205], v13 offset:18432
    ds_read_b64_tr_b16 a[206:207], v13 offset:18944
    v_rcp_f32 v128, v128
    v_mul_f32 v132, v88, v132
    s_waitcnt lgkmcnt(8)
    v_mfma_f32_32x32x16_bf16 v[192:207], a[176:179], a[28:31], v[192:207]
    ds_read_b64_tr_b16 a[160:161], v10 offset:20480
    ds_read_b64_tr_b16 a[162:163], v10 offset:20992
    buffer_load_dwordx4 v[68:71], v20, s[48:51], s45 offen offset:1024 sc1
    v_exp_f32 v131, v131
    v_fma_f32 v130, v130, v89, v89
    v_mfma_f32_32x32x16_bf16 v[208:223], a[180:183], a[28:31], v[208:223]
    ds_read_b64_tr_b16 a[164:165], v10 offset:22528
    ds_read_b64_tr_b16 a[166:167], v10 offset:23040
    v_rcp_f32 v129, v129
    v_mul_f32 v128, v128, v144
    v_mul_f32 v133, v88, v133
    v_mfma_f32_32x32x16_bf16 v[224:239], a[184:187], a[28:31], v[224:239]
    ds_read_b64_tr_b16 a[168:169], v13 offset:20480
    ds_read_b64_tr_b16 a[170:171], v13 offset:20992
    buffer_load_dwordx4 v8, s[56:59], s13 offen offset:3072 lds
    v_exp_f32 v132, v132
    v_fma_f32 v131, v131, v89, v89
    v_mfma_f32_32x32x16_bf16 v[240:255], a[188:191], a[28:31], v[240:255]
    ds_read_b64_tr_b16 a[172:173], v13 offset:22528
    ds_read_b64_tr_b16 a[174:175], v13 offset:23040
    v_rcp_f32 v130, v130
    v_mul_f32 v129, v129, v145
    v_cvt_pk_bf16_f32 v144, v128, v129
    s_waitcnt lgkmcnt(8)
    v_mfma_f32_32x32x16_bf16 v[192:207], a[192:195], a[32:35], v[192:207]
    ds_read_b64_tr_b16 a[176:177], v10 offset:24576
    ds_read_b64_tr_b16 a[178:179], v10 offset:25088
    buffer_load_dwordx4 v[72:75], v20, s[48:51], s45 offen offset:2048 sc1
    v_mul_f32 v134, v88, v134
    v_exp_f32 v133, v133
    v_fma_f32 v132, v132, v89, v89
    v_mfma_f32_32x32x16_bf16 v[208:223], a[196:199], a[32:35], v[208:223]
    ds_read_b64_tr_b16 a[180:181], v10 offset:26624
    ds_read_b64_tr_b16 a[182:183], v10 offset:27136
    v_rcp_f32 v131, v131
    v_mul_f32 v130, v130, v146
    v_mul_f32 v135, v88, v135
    v_mfma_f32_32x32x16_bf16 v[224:239], a[200:203], a[32:35], v[224:239]
    s_add_u32 m0, s82, 114688
    s_add_u32 s13, s13, 221184
    ds_read_b64_tr_b16 a[184:185], v13 offset:24576
    ds_read_b64_tr_b16 a[186:187], v13 offset:25088
    buffer_load_dwordx4 v7, s[52:55], s13 offen offset:0 lds
    v_exp_f32 v134, v134
    v_mfma_f32_32x32x16_bf16 v[240:255], a[204:207], a[32:35], v[240:255]
    ds_read_b64_tr_b16 a[188:189], v13 offset:26624
    ds_read_b64_tr_b16 a[190:191], v13 offset:27136
    v_fma_f32 v133, v133, v89, v89
    v_rcp_f32 v132, v132
    v_mul_f32 v131, v131, v147
    s_waitcnt lgkmcnt(8)
    v_mfma_f32_32x32x16_bf16 v[192:207], a[160:163], a[36:39], v[192:207]
    ds_read_b64_tr_b16 a[192:193], v10 offset:28672
    ds_read_b64_tr_b16 a[194:195], v10 offset:29184
    buffer_load_dwordx4 v[76:79], v20, s[48:51], s45 offen offset:3072 sc1
    v_cvt_pk_bf16_f32 v145, v130, v131
    v_mul_f32 v136, v88, v136
    v_exp_f32 v135, v135
    v_mfma_f32_32x32x16_bf16 v[208:223], a[164:167], a[36:39], v[208:223]
    ds_read_b64_tr_b16 a[196:197], v10 offset:30720
    ds_read_b64_tr_b16 a[198:199], v10 offset:31232
    v_fma_f32 v134, v134, v89, v89
    v_rcp_f32 v133, v133
    v_mul_f32 v132, v132, v148
    v_mul_f32 v137, v88, v137
    v_mfma_f32_32x32x16_bf16 v[224:239], a[168:171], a[36:39], v[224:239]
    ds_read_b64_tr_b16 a[200:201], v13 offset:28672
    ds_read_b64_tr_b16 a[202:203], v13 offset:29184
    buffer_load_dwordx4 v8, s[52:55], s13 offen offset:1024 lds
    v_exp_f32 v136, v136
    v_fma_f32 v135, v135, v89, v89
    v_mfma_f32_32x32x16_bf16 v[240:255], a[172:175], a[36:39], v[240:255]
    ds_read_b64_tr_b16 a[204:205], v13 offset:30720
    ds_read_b64_tr_b16 a[206:207], v13 offset:31232
    v_rcp_f32 v134, v134
    v_mul_f32 v133, v133, v149
    v_cvt_pk_bf16_f32 v146, v132, v133
    s_waitcnt lgkmcnt(8)
    v_mfma_f32_32x32x16_bf16 v[192:207], a[176:179], a[40:43], v[192:207]
    s_add_u32 s45, s20, 86016
    ds_read_b64_tr_b16 a[160:161], v11 offset:0
    ds_read_b64_tr_b16 a[162:163], v11 offset:512
    buffer_load_dwordx4 v[80:83], v20, s[48:51], s45 offen offset:0 sc1
    v_mul_f32 v138, v88, v138
    v_exp_f32 v137, v137
    v_mfma_f32_32x32x16_bf16 v[208:223], a[180:183], a[40:43], v[208:223]
    ds_read_b64_tr_b16 a[164:165], v11 offset:2048
    ds_read_b64_tr_b16 a[166:167], v11 offset:2560
    v_fma_f32 v136, v136, v89, v89
    v_rcp_f32 v135, v135
    v_mul_f32 v134, v134, v150
    v_mul_f32 v139, v88, v139
    v_mfma_f32_32x32x16_bf16 v[224:239], a[184:187], a[40:43], v[224:239]
    ds_read_b64_tr_b16 a[168:169], v14 offset:0
    ds_read_b64_tr_b16 a[170:171], v14 offset:512
    buffer_load_dwordx4 v7, s[56:59], s13 offen offset:2048 lds
    v_exp_f32 v138, v138
    v_fma_f32 v137, v137, v89, v89
    v_mfma_f32_32x32x16_bf16 v[240:255], a[188:191], a[40:43], v[240:255]
    ds_read_b64_tr_b16 a[172:173], v14 offset:2048
    ds_read_b64_tr_b16 a[174:175], v14 offset:2560
    v_rcp_f32 v136, v136
    v_mul_f32 v135, v135, v151
    v_cvt_pk_bf16_f32 v147, v134, v135
    s_waitcnt lgkmcnt(8)
    v_mfma_f32_32x32x16_bf16 v[192:207], a[192:195], a[44:47], v[192:207]
    ds_read_b64_tr_b16 a[176:177], v11 offset:4096
    ds_read_b64_tr_b16 a[178:179], v11 offset:4608
    buffer_store_dwordx4 v[144:147], v19, s[48:51], s83 offen offset:0 sc1
    v_mul_f32 v140, v88, v140
    v_exp_f32 v139, v139
    v_mfma_f32_32x32x16_bf16 v[208:223], a[196:199], a[44:47], v[208:223]
    ds_read_b64_tr_b16 a[180:181], v11 offset:6144
    ds_read_b64_tr_b16 a[182:183], v11 offset:6656
    v_fma_f32 v138, v138, v89, v89
    v_rcp_f32 v137, v137
    v_mul_f32 v136, v136, v152
    v_mul_f32 v141, v88, v141
    v_mfma_f32_32x32x16_bf16 v[224:239], a[200:203], a[44:47], v[224:239]
    ds_read_b64_tr_b16 a[184:185], v14 offset:4096
    ds_read_b64_tr_b16 a[186:187], v14 offset:4608
    buffer_load_dwordx4 v8, s[56:59], s13 offen offset:3072 lds
    s_waitcnt vmcnt(14)
    buffer_store_dword v26, v27, s[76:79], 0 offen offset:128 sc1
    v_mfma_f32_32x32x16_bf16 v[240:255], a[204:207], a[44:47], v[240:255]
    ds_read_b64_tr_b16 a[188:189], v14 offset:6144
    ds_read_b64_tr_b16 a[190:191], v14 offset:6656
    v_exp_f32 v140, v140
    v_fma_f32 v139, v139, v89, v89
    s_waitcnt lgkmcnt(8)
    v_mfma_f32_32x32x16_bf16 v[192:207], a[160:163], a[48:51], v[192:207]
    s_add_u32 s45, s20, 122880
    ds_read_b64_tr_b16 a[192:193], v11 offset:8192
    ds_read_b64_tr_b16 a[194:195], v11 offset:8704
    buffer_load_dwordx4 v[84:87], v20, s[48:51], s45 offen offset:0 sc1
    v_rcp_f32 v138, v138
    v_mul_f32 v137, v137, v153
    v_mfma_f32_32x32x16_bf16 v[208:223], a[164:167], a[48:51], v[208:223]
    ds_read_b64_tr_b16 a[196:197], v11 offset:10240
    ds_read_b64_tr_b16 a[198:199], v11 offset:10752
    v_cvt_pk_bf16_f32 v152, v136, v137
    v_mul_f32 v142, v88, v142
    v_exp_f32 v141, v141
    v_fma_f32 v140, v140, v89, v89
    v_mfma_f32_32x32x16_bf16 v[224:239], a[168:171], a[48:51], v[224:239]
    s_add_u32 m0, s82, 0
    s_add_u32 s13, s13, 221184
    ds_read_b64_tr_b16 a[200:201], v14 offset:8192
    ds_read_b64_tr_b16 a[202:203], v14 offset:8704
    buffer_load_dwordx4 v7, s[52:55], s13 offen offset:0 lds
    v_rcp_f32 v139, v139
    v_mfma_f32_32x32x16_bf16 v[240:255], a[172:175], a[48:51], v[240:255]
    ds_read_b64_tr_b16 a[204:205], v14 offset:10240
    ds_read_b64_tr_b16 a[206:207], v14 offset:10752
    v_mul_f32 v138, v138, v154
    v_mul_f32 v143, v88, v143
    v_exp_f32 v142, v142
    s_waitcnt lgkmcnt(8)
    v_mfma_f32_32x32x16_bf16 v[192:207], a[176:179], a[52:55], v[192:207]
    ds_read_b64_tr_b16 a[160:161], v11 offset:12288
    ds_read_b64_tr_b16 a[162:163], v11 offset:12800
    buffer_load_dwordx4 a[16:19], v20, s[48:51], s45 offen offset:1024 sc1
    v_fma_f32 v141, v141, v89, v89
    v_rcp_f32 v140, v140
    v_mul_f32 v139, v139, v155
    v_mfma_f32_32x32x16_bf16 v[208:223], a[180:183], a[52:55], v[208:223]
    ds_read_b64_tr_b16 a[164:165], v11 offset:14336
    ds_read_b64_tr_b16 a[166:167], v11 offset:14848
    v_cvt_pk_bf16_f32 v153, v138, v139
    v_mul_f32 v160, v88, v160
    v_exp_f32 v143, v143
    v_fma_f32 v142, v142, v89, v89
    v_mfma_f32_32x32x16_bf16 v[224:239], a[184:187], a[52:55], v[224:239]
    ds_read_b64_tr_b16 a[168:169], v14 offset:12288
    ds_read_b64_tr_b16 a[170:171], v14 offset:12800
    buffer_load_dwordx4 v8, s[52:55], s13 offen offset:1024 lds
    v_rcp_f32 v141, v141
    v_mul_f32 v140, v140, v156
    v_mul_f32 v161, v88, v161
    v_mfma_f32_32x32x16_bf16 v[240:255], a[188:191], a[52:55], v[240:255]
    ds_read_b64_tr_b16 a[172:173], v14 offset:14336
    ds_read_b64_tr_b16 a[174:175], v14 offset:14848
    v_exp_f32 v160, v160
    v_fma_f32 v143, v143, v89, v89
    s_waitcnt lgkmcnt(8)
    v_mfma_f32_32x32x16_bf16 v[192:207], a[192:195], a[56:59], v[192:207]
    s_barrier
    ds_read_b64_tr_b16 a[176:177], v10 offset:32768
    ds_read_b64_tr_b16 a[178:179], v10 offset:33280
    buffer_load_dwordx4 a[20:23], v20, s[48:51], s45 offen offset:2048 sc1
    v_rcp_f32 v142, v142
    v_mul_f32 v141, v141, v157
    v_mfma_f32_32x32x16_bf16 v[208:223], a[196:199], a[56:59], v[208:223]
    ds_read_b64_tr_b16 a[180:181], v10 offset:34816
    ds_read_b64_tr_b16 a[182:183], v10 offset:35328
    v_cvt_pk_bf16_f32 v154, v140, v141
    v_mul_f32 v162, v88, v162
    v_exp_f32 v161, v161
    v_fma_f32 v160, v160, v89, v89
    v_mfma_f32_32x32x16_bf16 v[224:239], a[200:203], a[56:59], v[224:239]
    ds_read_b64_tr_b16 a[184:185], v13 offset:32768
    ds_read_b64_tr_b16 a[186:187], v13 offset:33280
    buffer_load_dwordx4 v7, s[56:59], s13 offen offset:2048 lds
    v_rcp_f32 v143, v143
    v_mul_f32 v142, v142, v158
    v_mul_f32 v163, v88, v163
    v_mfma_f32_32x32x16_bf16 v[240:255], a[204:207], a[56:59], v[240:255]
    ds_read_b64_tr_b16 a[188:189], v13 offset:34816
    ds_read_b64_tr_b16 a[190:191], v13 offset:35328
    v_exp_f32 v162, v162
    v_fma_f32 v161, v161, v89, v89
    s_waitcnt lgkmcnt(8)
    v_mfma_f32_32x32x16_bf16 v[192:207], a[160:163], a[60:63], v[192:207]
    ds_read_b64_tr_b16 a[192:193], v10 offset:36864
    ds_read_b64_tr_b16 a[194:195], v10 offset:37376
    buffer_load_dwordx4 a[24:27], v20, s[48:51], s45 offen offset:3072 sc1
    v_rcp_f32 v160, v160
    v_mul_f32 v143, v143, v159
    v_cvt_pk_bf16_f32 v155, v142, v143
    v_mfma_f32_32x32x16_bf16 v[208:223], a[164:167], a[60:63], v[208:223]
    ds_read_b64_tr_b16 a[196:197], v10 offset:38912
    ds_read_b64_tr_b16 a[198:199], v10 offset:39424
    buffer_store_dwordx4 v[152:155], v19, s[48:51], s83 offen offset:512 sc1
    s_add_u32 s83, s83, 4096
    v_mul_f32 v164, v88, v164
    v_mfma_f32_32x32x16_bf16 v[224:239], a[168:171], a[60:63], v[224:239]
    ds_read_b64_tr_b16 a[200:201], v13 offset:36864
    ds_read_b64_tr_b16 a[202:203], v13 offset:37376
    buffer_load_dwordx4 v8, s[56:59], s13 offen offset:3072 lds
    v_exp_f32 v163, v163
    v_fma_f32 v162, v162, v89, v89
    v_mfma_f32_32x32x16_bf16 v[240:255], a[172:175], a[60:63], v[240:255]
    ds_read_b64_tr_b16 a[204:205], v13 offset:38912
    ds_read_b64_tr_b16 a[206:207], v13 offset:39424
    v_rcp_f32 v161, v161
    v_mul_f32 v160, v160, v176
    v_mul_f32 v165, v88, v165
    s_waitcnt lgkmcnt(8)
    v_mfma_f32_32x32x16_bf16 v[192:207], a[176:179], a[64:67], v[192:207]
    s_add_u32 s45, s20, 126976
    ds_read_b64_tr_b16 a[160:161], v10 offset:40960
    ds_read_b64_tr_b16 a[162:163], v10 offset:41472
    buffer_load_dwordx4 a[28:31], v20, s[48:51], s45 offen offset:0 sc1
    v_exp_f32 v164, v164
    v_fma_f32 v163, v163, v89, v89
    v_mfma_f32_32x32x16_bf16 v[208:223], a[180:183], a[64:67], v[208:223]
    ds_read_b64_tr_b16 a[164:165], v10 offset:43008
    ds_read_b64_tr_b16 a[166:167], v10 offset:43520
    v_rcp_f32 v162, v162
    v_mul_f32 v161, v161, v177
    v_cvt_pk_bf16_f32 v176, v160, v161
    v_mul_f32 v166, v88, v166
    v_mfma_f32_32x32x16_bf16 v[224:239], a[184:187], a[64:67], v[224:239]
    s_add_u32 s45, s20, 163840
    ds_read_b64_tr_b16 a[168:169], v13 offset:40960
    ds_read_b64_tr_b16 a[170:171], v13 offset:41472
    buffer_load_dwordx4 a[32:35], v20, s[48:51], s45 offen offset:0 sc1
    v_exp_f32 v165, v165
    v_fma_f32 v164, v164, v89, v89
    v_mfma_f32_32x32x16_bf16 v[240:255], a[188:191], a[64:67], v[240:255]
    ds_read_b64_tr_b16 a[172:173], v13 offset:43008
    ds_read_b64_tr_b16 a[174:175], v13 offset:43520
    v_rcp_f32 v163, v163
    v_mul_f32 v162, v162, v178
    v_mul_f32 v167, v88, v167
    s_waitcnt lgkmcnt(8)
    v_mfma_f32_32x32x16_bf16 v[192:207], a[192:195], a[68:71], v[192:207]
    ds_read_b64_tr_b16 a[176:177], v10 offset:45056
    ds_read_b64_tr_b16 a[178:179], v10 offset:45568
    buffer_load_dwordx4 a[36:39], v20, s[48:51], s45 offen offset:1024 sc1
    v_exp_f32 v166, v166
    v_fma_f32 v165, v165, v89, v89
    v_mfma_f32_32x32x16_bf16 v[208:223], a[196:199], a[68:71], v[208:223]
    ds_read_b64_tr_b16 a[180:181], v10 offset:47104
    ds_read_b64_tr_b16 a[182:183], v10 offset:47616
    v_rcp_f32 v164, v164
    v_mul_f32 v163, v163, v179
    v_cvt_pk_bf16_f32 v177, v162, v163
    v_mul_f32 v168, v88, v168
    v_mfma_f32_32x32x16_bf16 v[224:239], a[200:203], a[68:71], v[224:239]
    ds_read_b64_tr_b16 a[184:185], v13 offset:45056
    ds_read_b64_tr_b16 a[186:187], v13 offset:45568
    buffer_load_dwordx4 a[40:43], v20, s[48:51], s45 offen offset:2048 sc1
    v_exp_f32 v167, v167
    v_fma_f32 v166, v166, v89, v89
    v_mfma_f32_32x32x16_bf16 v[240:255], a[204:207], a[68:71], v[240:255]
    ds_read_b64_tr_b16 a[188:189], v13 offset:47104
    ds_read_b64_tr_b16 a[190:191], v13 offset:47616
    v_rcp_f32 v165, v165
    v_mul_f32 v164, v164, v180
    v_mul_f32 v169, v88, v169
    s_waitcnt lgkmcnt(8)
    v_mfma_f32_32x32x16_bf16 v[192:207], a[160:163], a[72:75], v[192:207]
    ds_read_b64_tr_b16 a[192:193], v9 offset:49152
    ds_read_b64_tr_b16 a[194:195], v9 offset:49664
    buffer_load_dwordx4 a[44:47], v20, s[48:51], s45 offen offset:3072 sc1
    v_exp_f32 v168, v168
    v_fma_f32 v167, v167, v89, v89
    v_mfma_f32_32x32x16_bf16 v[208:223], a[164:167], a[72:75], v[208:223]
    ds_read_b64_tr_b16 a[196:197], v9 offset:51200
    ds_read_b64_tr_b16 a[198:199], v9 offset:51712
    v_rcp_f32 v166, v166
    v_mul_f32 v165, v165, v181
    v_cvt_pk_bf16_f32 v178, v164, v165
    v_mul_f32 v170, v88, v170
    v_mfma_f32_32x32x16_bf16 v[224:239], a[168:171], a[72:75], v[224:239]
    s_add_u32 s45, s20, 167936
    ds_read_b64_tr_b16 a[200:201], v12 offset:49152
    ds_read_b64_tr_b16 a[202:203], v12 offset:49664
    buffer_load_dwordx4 a[48:51], v20, s[48:51], s45 offen offset:0 sc1
    v_exp_f32 v169, v169
    v_fma_f32 v168, v168, v89, v89
    v_mfma_f32_32x32x16_bf16 v[240:255], a[172:175], a[72:75], v[240:255]
    ds_read_b64_tr_b16 a[204:205], v12 offset:51200
    ds_read_b64_tr_b16 a[206:207], v12 offset:51712
    v_rcp_f32 v167, v167
    v_mul_f32 v166, v166, v182
    v_mul_f32 v171, v88, v171
    s_waitcnt lgkmcnt(8)
    v_mfma_f32_32x32x16_bf16 v[192:207], a[176:179], a[76:79], v[192:207]
    s_add_u32 s45, s20, 204800
    ds_read_b64_tr_b16 a[160:161], v9 offset:53248
    ds_read_b64_tr_b16 a[162:163], v9 offset:53760
    buffer_load_dwordx4 a[52:55], v20, s[48:51], s45 offen offset:0 sc1
    v_exp_f32 v170, v170
    v_fma_f32 v169, v169, v89, v89
    v_mfma_f32_32x32x16_bf16 v[208:223], a[180:183], a[76:79], v[208:223]
    ds_read_b64_tr_b16 a[164:165], v9 offset:55296
    ds_read_b64_tr_b16 a[166:167], v9 offset:55808
    v_rcp_f32 v168, v168
    v_mul_f32 v167, v167, v183
    v_cvt_pk_bf16_f32 v179, v166, v167
    v_mfma_f32_32x32x16_bf16 v[224:239], a[184:187], a[76:79], v[224:239]
    ds_read_b64_tr_b16 a[168:169], v12 offset:53248
    ds_read_b64_tr_b16 a[170:171], v12 offset:53760
    buffer_store_dwordx4 v[176:179], v19, s[48:51], s83 offen offset:0 sc1
    v_mul_f32 v172, v88, v172
    v_exp_f32 v171, v171
    v_mfma_f32_32x32x16_bf16 v[240:255], a[188:191], a[76:79], v[240:255]
    ds_read_b64_tr_b16 a[172:173], v12 offset:55296
    ds_read_b64_tr_b16 a[174:175], v12 offset:55808
    v_fma_f32 v170, v170, v89, v89
    v_rcp_f32 v169, v169
    v_mul_f32 v168, v168, v184
    s_waitcnt lgkmcnt(8)
    v_mfma_f32_32x32x16_bf16 v[192:207], a[192:195], a[80:83], v[192:207]
    ds_read_b64_tr_b16 a[176:177], v9 offset:57344
    ds_read_b64_tr_b16 a[178:179], v9 offset:57856
    buffer_load_dwordx4 a[56:59], v20, s[48:51], s45 offen offset:1024 sc1
    v_mul_f32 v173, v88, v173
    v_exp_f32 v172, v172
    v_fma_f32 v171, v171, v89, v89
    v_mfma_f32_32x32x16_bf16 v[208:223], a[196:199], a[80:83], v[208:223]
    ds_read_b64_tr_b16 a[180:181], v9 offset:59392
    ds_read_b64_tr_b16 a[182:183], v9 offset:59904
    v_rcp_f32 v170, v170
    v_mul_f32 v169, v169, v185
    v_cvt_pk_bf16_f32 v184, v168, v169
    v_mul_f32 v174, v88, v174
    v_mfma_f32_32x32x16_bf16 v[224:239], a[200:203], a[80:83], v[224:239]
    ds_read_b64_tr_b16 a[184:185], v12 offset:57344
    ds_read_b64_tr_b16 a[186:187], v12 offset:57856
    buffer_load_dwordx4 a[60:63], v20, s[48:51], s45 offen offset:2048 sc1
    v_exp_f32 v173, v173
    v_fma_f32 v172, v172, v89, v89
    v_mfma_f32_32x32x16_bf16 v[240:255], a[204:207], a[80:83], v[240:255]
    ds_read_b64_tr_b16 a[188:189], v12 offset:59392
    ds_read_b64_tr_b16 a[190:191], v12 offset:59904
    v_rcp_f32 v171, v171
    v_mul_f32 v170, v170, v186
    v_mul_f32 v175, v88, v175
    s_waitcnt lgkmcnt(8)
    v_mfma_f32_32x32x16_bf16 v[192:207], a[160:163], a[84:87], v[192:207]
    ds_read_b64_tr_b16 a[192:193], v9 offset:61440
    ds_read_b64_tr_b16 a[194:195], v9 offset:61952
    buffer_load_dwordx4 a[64:67], v20, s[48:51], s45 offen offset:3072 sc1
    v_exp_f32 v174, v174
    v_fma_f32 v173, v173, v89, v89
    v_mfma_f32_32x32x16_bf16 v[208:223], a[164:167], a[84:87], v[208:223]
    ds_read_b64_tr_b16 a[196:197], v9 offset:63488
    ds_read_b64_tr_b16 a[198:199], v9 offset:64000
    buffer_load_dword v5, v2, s[76:79], 0 offen offset:128 sc1
    v_rcp_f32 v172, v172
    v_mul_f32 v171, v171, v187
    v_mfma_f32_32x32x16_bf16 v[224:239], a[168:171], a[84:87], v[224:239]
    ds_read_b64_tr_b16 a[200:201], v12 offset:61440
    ds_read_b64_tr_b16 a[202:203], v12 offset:61952
    v_cvt_pk_bf16_f32 v185, v170, v171
    v_exp_f32 v175, v175
    v_fma_f32 v174, v174, v89, v89
    v_mfma_f32_32x32x16_bf16 v[240:255], a[172:175], a[84:87], v[240:255]
    ds_read_b64_tr_b16 a[204:205], v12 offset:63488
    ds_read_b64_tr_b16 a[206:207], v12 offset:64000
    v_rcp_f32 v173, v173
    v_mul_f32 v172, v172, v188
    v_fma_f32 v175, v175, v89, v89
    s_waitcnt lgkmcnt(8)
    v_mfma_f32_32x32x16_bf16 v[192:207], a[176:179], a[88:91], v[192:207]
    s_waitcnt vmcnt(30)
    s_barrier
    s_add_u32 s45, s20, 208896
    ds_read_b64_tr_b16 a[160:161], v10 offset:0
    ds_read_b64_tr_b16 a[162:163], v10 offset:512
    buffer_load_dwordx4 a[68:71], v20, s[48:51], s45 offen offset:0 sc1
    v_mfma_f32_32x32x16_bf16 v[208:223], a[180:183], a[88:91], v[208:223]
    ds_read_b64_tr_b16 a[164:165], v10 offset:2048
    ds_read_b64_tr_b16 a[166:167], v10 offset:2560
    v_rcp_f32 v174, v174
    v_mul_f32 v173, v173, v189
    v_cvt_pk_bf16_f32 v186, v172, v173
    v_mfma_f32_32x32x16_bf16 v[224:239], a[184:187], a[88:91], v[224:239]
    s_add_u32 s45, s20, 245760
    ds_read_b64_tr_b16 a[168:169], v13 offset:0
    ds_read_b64_tr_b16 a[170:171], v13 offset:512
    buffer_load_dwordx4 a[72:75], v20, s[48:51], s45 offen offset:0 sc1
    v_rcp_f32 v175, v175
    s_nop 0
    v_mfma_f32_32x32x16_bf16 v[240:255], a[188:191], a[88:91], v[240:255]
    ds_read_b64_tr_b16 a[172:173], v13 offset:2048
    ds_read_b64_tr_b16 a[174:175], v13 offset:2560
    v_mul_f32 v174, v174, v190
    s_nop 0
    v_mul_f32 v175, v175, v191
    v_cvt_pk_bf16_f32 v187, v174, v175
    s_waitcnt lgkmcnt(8)
    v_mfma_f32_32x32x16_bf16 v[192:207], a[192:195], a[92:95], v[192:207]
    ds_read_b64_tr_b16 a[176:177], v10 offset:4096
    ds_read_b64_tr_b16 a[178:179], v10 offset:4608
    buffer_store_dwordx4 v[184:187], v19, s[48:51], s83 offen offset:512 sc1
    v_and_b32 v17, 15, v1
    v_mul_u32_u24 v17, 320, v17
    v_lshrrev_b32 v121, 4, v1
    v_mfma_f32_32x32x16_bf16 v[208:223], a[196:199], a[92:95], v[208:223]
    ds_read_b64_tr_b16 a[180:181], v10 offset:6144
    ds_read_b64_tr_b16 a[182:183], v10 offset:6656
    v_bfe_u32 v120, v1, 1, 2
    v_xor_b32 v121, v121, v120
    v_lshl_add_u32 v17, v121, 4, v17
    s_mul_i32 s80, s3, 20480
    v_add_u32 v17, s80, v17
    v_mfma_f32_32x32x16_bf16 v[224:239], a[200:203], a[92:95], v[224:239]
    ds_read_b64_tr_b16 a[184:185], v13 offset:4096
    ds_read_b64_tr_b16 a[186:187], v13 offset:4608
    buffer_load_dwordx4 a[76:79], v20, s[48:51], s45 offen offset:1024 sc1
    v_lshrrev_b32 v116, 2, v1
    v_and_b32 v117, 3, v1
    v_lshlrev_b32 v118, 3, v117
    v_mul_u32_u24 v119, 1280, v116
    v_mfma_f32_32x32x16_bf16 v[240:255], a[204:207], a[92:95], v[240:255]
    ds_read_b64_tr_b16 a[188:189], v13 offset:6144
    ds_read_b64_tr_b16 a[190:191], v13 offset:6656
    v_add_u32 v119, v119, v118
    v_lshlrev_b32 v120, 3, v116
    v_lshlrev_b32 v16, 1, v119
    v_bfe_u32 v121, v1, 3, 2
    s_waitcnt lgkmcnt(8)
    v_mfma_f32_32x32x16_bf16 v[192:207], a[160:163], a[96:99], v[192:207]
    ds_read_b64_tr_b16 a[192:193], v10 offset:8192
    ds_read_b64_tr_b16 a[194:195], v10 offset:8704
    buffer_load_dwordx4 a[80:83], v20, s[48:51], s45 offen offset:2048 sc1
    v_xor_b32 v121, v121, v117
    v_mul_u32_u24 v15, 320, v116
    v_lshl_add_u32 v15, v121, 4, v15
    s_mul_i32 s81, s3, 5120
    v_mfma_f32_32x32x16_bf16 v[208:223], a[164:167], a[96:99], v[208:223]
    ds_read_b64_tr_b16 a[196:197], v10 offset:10240
    ds_read_b64_tr_b16 a[198:199], v10 offset:10752
    v_add_u32 v15, s81, v15
    v_lshlrev_b32 v18, 3, v1
    s_mov_b32 s64, s16
    s_mov_b32 s65, s17
    s_mov_b32 s66, 2621440
    v_mfma_f32_32x32x16_bf16 v[224:239], a[168:171], a[96:99], v[224:239]
    ds_read_b64_tr_b16 a[200:201], v13 offset:8192
    ds_read_b64_tr_b16 a[202:203], v13 offset:8704
    buffer_load_dwordx4 a[84:87], v20, s[48:51], s45 offen offset:3072 sc1
    s_mov_b32 s67, 0x00020000
    s_mov_b32 s60, s32
    s_mov_b32 s61, s33
    s_mov_b32 s62, 1280
    v_mfma_f32_32x32x16_bf16 v[240:255], a[172:175], a[96:99], v[240:255]
    ds_read_b64_tr_b16 a[204:205], v13 offset:10240
    ds_read_b64_tr_b16 a[206:207], v13 offset:10752
    s_mov_b32 s63, 0x00020000
    buffer_load_dword v21, v120, s[48:51], s24 offen sc1
    s_waitcnt lgkmcnt(8)
    v_mfma_f32_32x32x16_bf16 v[192:207], a[176:179], a[100:103], v[192:207]
    ds_read_b64_tr_b16 a[160:161], v10 offset:12288
    ds_read_b64_tr_b16 a[162:163], v10 offset:12800
    buffer_load_dwordx2 v[48:49], v119, s[64:67], s26 offen offset:0
    v_mfma_f32_32x32x16_bf16 v[208:223], a[180:183], a[100:103], v[208:223]
    ds_read_b64_tr_b16 a[164:165], v10 offset:14336
    ds_read_b64_tr_b16 a[166:167], v10 offset:14848
    buffer_load_dwordx2 v[50:51], v118, s[60:63], s25 offen offset:0
    v_mfma_f32_32x32x16_bf16 v[224:239], a[184:187], a[100:103], v[224:239]
    ds_read_b64_tr_b16 a[168:169], v13 offset:12288
    ds_read_b64_tr_b16 a[170:171], v13 offset:12800
    buffer_load_dwordx2 v[52:53], v119, s[64:67], s26 offen offset:32
    v_mfma_f32_32x32x16_bf16 v[240:255], a[188:191], a[100:103], v[240:255]
    ds_read_b64_tr_b16 a[172:173], v13 offset:14336
    ds_read_b64_tr_b16 a[174:175], v13 offset:14848
    buffer_load_dwordx2 v[54:55], v118, s[60:63], s25 offen offset:32
    s_waitcnt lgkmcnt(8)
    v_mfma_f32_32x32x16_bf16 v[192:207], a[192:195], a[104:107], v[192:207]
    ds_read_b64_tr_b16 a[176:177], v9 offset:16384
    ds_read_b64_tr_b16 a[178:179], v9 offset:16896
    buffer_load_dwordx2 v[56:57], v119, s[64:67], s26 offen offset:64
    v_mfma_f32_32x32x16_bf16 v[208:223], a[196:199], a[104:107], v[208:223]
    ds_read_b64_tr_b16 a[180:181], v9 offset:18432
    ds_read_b64_tr_b16 a[182:183], v9 offset:18944
    s_waitcnt vmcnt(12)
    v_cmp_ne_u32 vcc, v5, v26
    s_nop 1
    s_and_b32 s34, vcc_lo, s28
    s_cbranch_scc1 L_slow_14
L_ok_15:
    s_barrier
    v_mfma_f32_32x32x16_bf16 v[224:239], a[200:203], a[104:107], v[224:239]
    ds_read_b64_tr_b16 a[184:185], v12 offset:16384
    ds_read_b64_tr_b16 a[186:187], v12 offset:16896
    buffer_load_dwordx2 v[58:59], v118, s[60:63], s25 offen offset:64
    v_mfma_f32_32x32x16_bf16 v[240:255], a[204:207], a[104:107], v[240:255]
    ds_read_b64_tr_b16 a[188:189], v12 offset:18432
    ds_read_b64_tr_b16 a[190:191], v12 offset:18944
    buffer_load_dwordx2 v[60:61], v119, s[64:67], s26 offen offset:96
    s_waitcnt lgkmcnt(8)
    v_mfma_f32_32x32x16_bf16 v[192:207], a[160:163], a[108:111], v[192:207]
    ds_read_b64_tr_b16 a[192:193], v9 offset:20480
    ds_read_b64_tr_b16 a[194:195], v9 offset:20992
    buffer_load_dwordx2 v[62:63], v118, s[60:63], s25 offen offset:96
    v_mfma_f32_32x32x16_bf16 v[208:223], a[164:167], a[108:111], v[208:223]
    ds_read_b64_tr_b16 a[196:197], v9 offset:22528
    ds_read_b64_tr_b16 a[198:199], v9 offset:23040
    buffer_load_dwordx2 v[64:65], v119, s[64:67], s26 offen offset:128
    v_mfma_f32_32x32x16_bf16 v[224:239], a[168:171], a[108:111], v[224:239]
    ds_read_b64_tr_b16 a[200:201], v12 offset:20480
    ds_read_b64_tr_b16 a[202:203], v12 offset:20992
    buffer_load_dwordx2 v[66:67], v118, s[60:63], s25 offen offset:128
    v_mfma_f32_32x32x16_bf16 v[240:255], a[172:175], a[108:111], v[240:255]
    ds_read_b64_tr_b16 a[204:205], v12 offset:22528
    ds_read_b64_tr_b16 a[206:207], v12 offset:23040
    v_accvgpr_read_b32 v93, a225
    v_accvgpr_read_b32 v6, a227
    v_bitop3_b32 v4, v93, v6, v26 bitop3:0x7e
    v_accvgpr_read_b32 v93, a229
    s_waitcnt lgkmcnt(8)
    v_mfma_f32_32x32x16_bf16 v[192:207], a[176:179], a[112:115], v[192:207]
    s_add_u32 s44, s18, 0
    ds_read_b64_tr_b16 a[160:161], v9 offset:24576
    ds_read_b64_tr_b16 a[162:163], v9 offset:25088
    buffer_load_dwordx4 a[88:91], v20, s[48:51], s44 offen offset:0 sc1
    v_accvgpr_read_b32 v6, a231
    v_bitop3_b32 v93, v93, v6, v26 bitop3:0x7e
    v_or_b32 v4, v4, v93
    v_mfma_f32_32x32x16_bf16 v[208:223], a[180:183], a[112:115], v[208:223]
    ds_read_b64_tr_b16 a[164:165], v9 offset:26624
    ds_read_b64_tr_b16 a[166:167], v9 offset:27136
    v_accvgpr_read_b32 v93, a233
    v_accvgpr_read_b32 v6, a235
    v_bitop3_b32 v93, v93, v6, v26 bitop3:0x7e
    v_or_b32 v4, v4, v93
    v_accvgpr_read_b32 v93, a237
    v_mfma_f32_32x32x16_bf16 v[224:239], a[184:187], a[112:115], v[224:239]
    ds_read_b64_tr_b16 a[168:169], v12 offset:24576
    ds_read_b64_tr_b16 a[170:171], v12 offset:25088
    buffer_load_dwordx4 a[92:95], v20, s[48:51], s44 offen offset:1024 sc1
    v_accvgpr_read_b32 v6, a239
    v_bitop3_b32 v93, v93, v6, v26 bitop3:0x7e
    v_or_b32 v4, v4, v93
    v_mfma_f32_32x32x16_bf16 v[240:255], a[188:191], a[112:115], v[240:255]
    ds_read_b64_tr_b16 a[172:173], v12 offset:26624
    ds_read_b64_tr_b16 a[174:175], v12 offset:27136
    v_cmp_ne_u32 vcc, 0, v4
    s_nop 1
    s_cmp_lg_u64 vcc, 0
    s_cbranch_scc1 L_slow_16
L_ok_17:
    s_waitcnt lgkmcnt(8)
    v_mfma_f32_32x32x16_bf16 v[192:207], a[192:195], a[116:119], v[192:207]
    ds_read_b64_tr_b16 a[176:177], v9 offset:28672
    ds_read_b64_tr_b16 a[178:179], v9 offset:29184
    buffer_load_dwordx4 a[96:99], v20, s[48:51], s44 offen offset:2048 sc1
    v_mfma_f32_32x32x16_bf16 v[192:207], a[224:227], a[252:255], v[192:207]
    v_mfma_f32_32x32x16_bf16 v[208:223], a[196:199], a[116:119], v[208:223]
    ds_read_b64_tr_b16 a[180:181], v9 offset:30720
    ds_read_b64_tr_b16 a[182:183], v9 offset:31232
    v_mfma_f32_32x32x16_bf16 v[208:223], a[228:231], a[252:255], v[208:223]
    v_mfma_f32_32x32x16_bf16 v[224:239], a[200:203], a[116:119], v[224:239]
    ds_read_b64_tr_b16 a[184:185], v12 offset:28672
    ds_read_b64_tr_b16 a[186:187], v12 offset:29184
    buffer_load_dwordx4 a[100:103], v20, s[48:51], s44 offen offset:3072 sc1
    v_mfma_f32_32x32x16_bf16 v[224:239], a[232:235], a[252:255], v[224:239]
    v_mfma_f32_32x32x16_bf16 v[240:255], a[204:207], a[116:119], v[240:255]
    ds_read_b64_tr_b16 a[188:189], v12 offset:30720
    ds_read_b64_tr_b16 a[190:191], v12 offset:31232
    v_mfma_f32_32x32x16_bf16 v[240:255], a[236:239], a[252:255], v[240:255]
    s_waitcnt lgkmcnt(8)
    v_mfma_f32_32x32x16_bf16 v[192:207], a[160:163], a[120:123], v[192:207]
    s_barrier
    s_add_u32 s44, s18, 32768
    ds_read_b64_tr_b16 a[192:193], v10 offset:49152
    ds_read_b64_tr_b16 a[194:195], v10 offset:49664
    buffer_load_dwordx4 a[104:107], v20, s[48:51], s44 offen offset:0 sc1
    s_waitcnt vmcnt(19)
    buffer_store_dword v26, v27, s[76:79], 0 offen offset:256 sc1
    v_mfma_f32_32x32x16_bf16 v[208:223], a[164:167], a[120:123], v[208:223]
    ds_read_b64_tr_b16 a[196:197], v10 offset:51200
    ds_read_b64_tr_b16 a[198:199], v10 offset:51712
    v_mfma_f32_32x32x16_bf16 v[224:239], a[168:171], a[120:123], v[224:239]
    ds_read_b64_tr_b16 a[200:201], v13 offset:49152
    ds_read_b64_tr_b16 a[202:203], v13 offset:49664
    buffer_load_dwordx4 a[108:111], v20, s[48:51], s44 offen offset:1024 sc1
    v_mfma_f32_32x32x16_bf16 v[240:255], a[172:175], a[120:123], v[240:255]
    ds_read_b64_tr_b16 a[204:205], v13 offset:51200
    ds_read_b64_tr_b16 a[206:207], v13 offset:51712
    s_waitcnt lgkmcnt(8)
    v_mfma_f32_32x32x16_bf16 v[192:207], a[176:179], a[124:127], v[192:207]
    ds_read_b64_tr_b16 a[160:161], v10 offset:53248
    ds_read_b64_tr_b16 a[162:163], v10 offset:53760
    buffer_load_dwordx4 a[112:115], v20, s[48:51], s44 offen offset:2048 sc1
    v_mfma_f32_32x32x16_bf16 v[208:223], a[180:183], a[124:127], v[208:223]
    ds_read_b64_tr_b16 a[164:165], v10 offset:55296
    ds_read_b64_tr_b16 a[166:167], v10 offset:55808
    v_mfma_f32_32x32x16_bf16 v[224:239], a[184:187], a[124:127], v[224:239]
    ds_read_b64_tr_b16 a[168:169], v13 offset:53248
    ds_read_b64_tr_b16 a[170:171], v13 offset:53760
    buffer_load_dwordx4 a[116:119], v20, s[48:51], s44 offen offset:3072 sc1
    v_mfma_f32_32x32x16_bf16 v[240:255], a[188:191], a[124:127], v[240:255]
    ds_read_b64_tr_b16 a[172:173], v13 offset:55296
    ds_read_b64_tr_b16 a[174:175], v13 offset:55808
    s_waitcnt lgkmcnt(8)
    v_mfma_f32_32x32x16_bf16 v[192:207], a[192:195], a[128:131], v[192:207]
    s_add_u32 s44, s19, 0
    ds_read_b64_tr_b16 a[176:177], v10 offset:57344
    ds_read_b64_tr_b16 a[178:179], v10 offset:57856
    buffer_load_dwordx4 a[224:227], v20, s[48:51], s44 offen offset:0 sc1
    v_mfma_f32_32x32x16_bf16 v[208:223], a[196:199], a[128:131], v[208:223]
    ds_read_b64_tr_b16 a[180:181], v10 offset:59392
    ds_read_b64_tr_b16 a[182:183], v10 offset:59904
    v_mfma_f32_32x32x16_bf16 v[224:239], a[200:203], a[128:131], v[224:239]
    ds_read_b64_tr_b16 a[184:185], v13 offset:57344
    ds_read_b64_tr_b16 a[186:187], v13 offset:57856
    buffer_load_dwordx4 a[228:231], v20, s[48:51], s44 offen offset:1024 sc1
    v_mfma_f32_32x32x16_bf16 v[240:255], a[204:207], a[128:131], v[240:255]
    ds_read_b64_tr_b16 a[188:189], v13 offset:59392
    ds_read_b64_tr_b16 a[190:191], v13 offset:59904
    s_waitcnt lgkmcnt(8)
    v_mfma_f32_32x32x16_bf16 v[192:207], a[160:163], a[132:135], v[192:207]
    ds_read_b64_tr_b16 a[192:193], v10 offset:61440
    ds_read_b64_tr_b16 a[194:195], v10 offset:61952
    buffer_load_dwordx4 a[232:235], v20, s[48:51], s44 offen offset:2048 sc1
    v_mfma_f32_32x32x16_bf16 v[208:223], a[164:167], a[132:135], v[208:223]
    ds_read_b64_tr_b16 a[196:197], v10 offset:63488
    ds_read_b64_tr_b16 a[198:199], v10 offset:64000
    v_mfma_f32_32x32x16_bf16 v[224:239], a[168:171], a[132:135], v[224:239]
    ds_read_b64_tr_b16 a[200:201], v13 offset:61440
    ds_read_b64_tr_b16 a[202:203], v13 offset:61952
    buffer_load_dwordx4 a[236:239], v20, s[48:51], s44 offen offset:3072 sc1
    v_mfma_f32_32x32x16_bf16 v[240:255], a[172:175], a[132:135], v[240:255]
    ds_read_b64_tr_b16 a[204:205], v13 offset:63488
    ds_read_b64_tr_b16 a[206:207], v13 offset:64000
    s_waitcnt lgkmcnt(8)
    v_mfma_f32_32x32x16_bf16 v[192:207], a[176:179], a[136:139], v[192:207]
    s_add_u32 s44, s19, 32768
    ds_read_b64_tr_b16 a[160:161], v9 offset:0
    ds_read_b64_tr_b16 a[162:163], v9 offset:512
    buffer_load_dwordx4 a[252:255], v20, s[48:51], s44 offen offset:0 sc1
    v_mfma_f32_32x32x16_bf16 v[208:223], a[180:183], a[136:139], v[208:223]
    ds_read_b64_tr_b16 a[164:165], v9 offset:2048
    ds_read_b64_tr_b16 a[166:167], v9 offset:2560
    v_mfma_f32_32x32x16_bf16 v[224:239], a[184:187], a[136:139], v[224:239]
    ds_read_b64_tr_b16 a[168:169], v12 offset:0
    ds_read_b64_tr_b16 a[170:171], v12 offset:512
    buffer_load_dwordx4 a[120:123], v20, s[48:51], s44 offen offset:1024 sc1
    v_mfma_f32_32x32x16_bf16 v[240:255], a[188:191], a[136:139], v[240:255]
    ds_read_b64_tr_b16 a[172:173], v12 offset:2048
    ds_read_b64_tr_b16 a[174:175], v12 offset:2560
    s_waitcnt lgkmcnt(8)
    v_mfma_f32_32x32x16_bf16 v[192:207], a[192:195], a[140:143], v[192:207]
    ds_read_b64_tr_b16 a[176:177], v9 offset:4096
    ds_read_b64_tr_b16 a[178:179], v9 offset:4608
    buffer_load_dwordx4 a[124:127], v20, s[48:51], s44 offen offset:2048 sc1
    v_mfma_f32_32x32x16_bf16 v[208:223], a[196:199], a[140:143], v[208:223]
    ds_read_b64_tr_b16 a[180:181], v9 offset:6144
    ds_read_b64_tr_b16 a[182:183], v9 offset:6656
    v_mfma_f32_32x32x16_bf16 v[224:239], a[200:203], a[140:143], v[224:239]
    ds_read_b64_tr_b16 a[184:185], v12 offset:4096
    ds_read_b64_tr_b16 a[186:187], v12 offset:4608
    buffer_load_dwordx4 a[128:131], v20, s[48:51], s44 offen offset:3072 sc1
    v_mfma_f32_32x32x16_bf16 v[240:255], a[204:207], a[140:143], v[240:255]
    ds_read_b64_tr_b16 a[188:189], v12 offset:6144
    ds_read_b64_tr_b16 a[190:191], v12 offset:6656
    s_waitcnt lgkmcnt(8)
    v_mfma_f32_32x32x16_bf16 v[192:207], a[160:163], a[144:147], v[192:207]
    s_add_u32 s45, s20, 249856
    ds_read_b64_tr_b16 a[192:193], v9 offset:8192
    ds_read_b64_tr_b16 a[194:195], v9 offset:8704
    buffer_load_dwordx4 a[132:135], v20, s[48:51], s45 offen offset:0 sc1
    v_mfma_f32_32x32x16_bf16 v[208:223], a[164:167], a[144:147], v[208:223]
    ds_read_b64_tr_b16 a[196:197], v9 offset:10240
    ds_read_b64_tr_b16 a[198:199], v9 offset:10752
    v_mfma_f32_32x32x16_bf16 v[224:239], a[168:171], a[144:147], v[224:239]
    s_add_u32 s45, s20, 286720
    ds_read_b64_tr_b16 a[200:201], v12 offset:8192
    ds_read_b64_tr_b16 a[202:203], v12 offset:8704
    buffer_load_dwordx4 a[136:139], v20, s[48:51], s45 offen offset:0 sc1
    v_mfma_f32_32x32x16_bf16 v[240:255], a[172:175], a[144:147], v[240:255]
    ds_read_b64_tr_b16 a[204:205], v12 offset:10240
    ds_read_b64_tr_b16 a[206:207], v12 offset:10752
    s_waitcnt lgkmcnt(8)
    v_mfma_f32_32x32x16_bf16 v[192:207], a[176:179], a[148:151], v[192:207]
    ds_read_b64_tr_b16 a[160:161], v9 offset:12288
    ds_read_b64_tr_b16 a[162:163], v9 offset:12800
    buffer_load_dwordx4 a[140:143], v20, s[48:51], s45 offen offset:1024 sc1
    v_mfma_f32_32x32x16_bf16 v[208:223], a[180:183], a[148:151], v[208:223]
    ds_read_b64_tr_b16 a[164:165], v9 offset:14336
    ds_read_b64_tr_b16 a[166:167], v9 offset:14848
    v_mfma_f32_32x32x16_bf16 v[224:239], a[184:187], a[148:151], v[224:239]
    ds_read_b64_tr_b16 a[168:169], v12 offset:12288
    ds_read_b64_tr_b16 a[170:171], v12 offset:12800
    buffer_load_dwordx4 a[144:147], v20, s[48:51], s45 offen offset:2048 sc1
    v_mfma_f32_32x32x16_bf16 v[240:255], a[188:191], a[148:151], v[240:255]
    ds_read_b64_tr_b16 a[172:173], v12 offset:14336
    ds_read_b64_tr_b16 a[174:175], v12 offset:14848
    s_waitcnt lgkmcnt(8)
    v_mfma_f32_32x32x16_bf16 v[192:207], a[192:195], a[152:155], v[192:207]
    buffer_load_dwordx4 a[148:151], v20, s[48:51], s45 offen offset:3072 sc1
    v_mfma_f32_32x32x16_bf16 v[208:223], a[196:199], a[152:155], v[208:223]
    v_mfma_f32_32x32x16_bf16 v[224:239], a[200:203], a[152:155], v[224:239]
    v_mfma_f32_32x32x16_bf16 v[240:255], a[204:207], a[152:155], v[240:255]
    s_waitcnt lgkmcnt(0)
    s_add_u32 s45, s20, 290816
    v_mfma_f32_32x32x16_bf16 v[192:207], a[160:163], a[156:159], v[192:207]
    buffer_load_dwordx4 a[152:155], v20, s[48:51], s45 offen offset:0 sc1
    v_mfma_f32_32x32x16_bf16 v[208:223], a[164:167], a[156:159], v[208:223]
    v_mfma_f32_32x32x16_bf16 v[224:239], a[168:171], a[156:159], v[224:239]
    v_mfma_f32_32x32x16_bf16 v[240:255], a[172:175], a[156:159], v[240:255]
    s_nop 7
    s_nop 3
    s_lshl_b32 s83, s5, 13
    s_add_u32 s83, s83, s14
    s_add_u32 s83, s83, 294912
    v_pk_mul_f32 v[192:193], v[192:193], v[88:89] op_sel_hi:[1,0]
    v_pk_mul_f32 v[194:195], v[194:195], v[88:89] op_sel_hi:[1,0]
    v_exp_f32 v192, v192
    v_exp_f32 v193, v193
    v_pk_mul_f32 v[196:197], v[196:197], v[88:89] op_sel_hi:[1,0]
    v_exp_f32 v194, v194
    v_exp_f32 v195, v195
    v_pk_fma_f32 v[192:193], v[192:193], v[88:89], v[88:89] op_sel:[0,1,1]
    v_pk_mul_f32 v[198:199], v[198:199], v[88:89] op_sel_hi:[1,0]
    s_add_u32 s45, s20, 327680
    buffer_load_dwordx4 a[156:159], v20, s[48:51], s45 offen offset:0 sc1
    v_exp_f32 v196, v196
    v_exp_f32 v197, v197
    v_pk_fma_f32 v[194:195], v[194:195], v[88:89], v[88:89] op_sel:[0,1,1]
    v_rcp_f32 v192, v192
    v_rcp_f32 v193, v193
    v_pk_mul_f32 v[200:201], v[200:201], v[88:89] op_sel_hi:[1,0]
    v_exp_f32 v198, v198
    v_exp_f32 v199, v199
    v_pk_fma_f32 v[196:197], v[196:197], v[88:89], v[88:89] op_sel:[0,1,1]
    v_rcp_f32 v194, v194
    buffer_load_dwordx4 a[160:163], v20, s[48:51], s45 offen offset:1024 sc1
    v_rcp_f32 v195, v195
    v_pk_mul_f32 v[192:193], v[192:193], v[208:209]
    v_cvt_pk_bf16_f32 v208, v192, v193
    v_pk_mul_f32 v[202:203], v[202:203], v[88:89] op_sel_hi:[1,0]
    v_exp_f32 v200, v200
    v_exp_f32 v201, v201
    v_pk_fma_f32 v[198:199], v[198:199], v[88:89], v[88:89] op_sel:[0,1,1]
    v_rcp_f32 v196, v196
    v_rcp_f32 v197, v197
    v_pk_mul_f32 v[194:195], v[194:195], v[210:211]
    v_cvt_pk_bf16_f32 v209, v194, v195
    buffer_load_dwordx4 a[164:167], v20, s[48:51], s45 offen offset:2048 sc1
    v_pk_mul_f32 v[204:205], v[204:205], v[88:89] op_sel_hi:[1,0]
    v_exp_f32 v202, v202
    v_exp_f32 v203, v203
    v_pk_fma_f32 v[200:201], v[200:201], v[88:89], v[88:89] op_sel:[0,1,1]
    v_rcp_f32 v198, v198
    v_rcp_f32 v199, v199
    v_pk_mul_f32 v[196:197], v[196:197], v[212:213]
    v_cvt_pk_bf16_f32 v210, v196, v197
    v_pk_mul_f32 v[206:207], v[206:207], v[88:89] op_sel_hi:[1,0]
    v_exp_f32 v204, v204
    v_exp_f32 v205, v205
    buffer_load_dwordx4 a[168:171], v20, s[48:51], s45 offen offset:3072 sc1
    v_pk_fma_f32 v[202:203], v[202:203], v[88:89], v[88:89] op_sel:[0,1,1]
    v_rcp_f32 v200, v200
    v_rcp_f32 v201, v201
    v_pk_mul_f32 v[198:199], v[198:199], v[214:215]
    v_cvt_pk_bf16_f32 v211, v198, v199
    buffer_store_dwordx4 v[208:211], v19, s[48:51], s83 offen offset:0 sc1
    v_pk_mul_f32 v[224:225], v[224:225], v[88:89] op_sel_hi:[1,0]
    v_exp_f32 v206, v206
    v_exp_f32 v207, v207
    v_pk_fma_f32 v[204:205], v[204:205], v[88:89], v[88:89] op_sel:[0,1,1]
    v_rcp_f32 v202, v202
    s_add_u32 s45, s20, 331776
    buffer_load_dwordx4 a[172:175], v20, s[48:51], s45 offen offset:0 sc1
    v_rcp_f32 v203, v203
    v_pk_mul_f32 v[200:201], v[200:201], v[216:217]
    v_cvt_pk_bf16_f32 v216, v200, v201
    v_pk_mul_f32 v[226:227], v[226:227], v[88:89] op_sel_hi:[1,0]
    v_exp_f32 v224, v224
    v_exp_f32 v225, v225
    v_pk_fma_f32 v[206:207], v[206:207], v[88:89], v[88:89] op_sel:[0,1,1]
    v_rcp_f32 v204, v204
    v_rcp_f32 v205, v205
    v_pk_mul_f32 v[202:203], v[202:203], v[218:219]
    v_cvt_pk_bf16_f32 v217, v202, v203
    s_add_u32 s45, s20, 368640
    buffer_load_dwordx4 a[176:179], v20, s[48:51], s45 offen offset:0 sc1
    v_pk_mul_f32 v[228:229], v[228:229], v[88:89] op_sel_hi:[1,0]
    v_exp_f32 v226, v226
    v_exp_f32 v227, v227
    v_pk_fma_f32 v[224:225], v[224:225], v[88:89], v[88:89] op_sel:[0,1,1]
    v_rcp_f32 v206, v206
    v_rcp_f32 v207, v207
    v_pk_mul_f32 v[204:205], v[204:205], v[220:221]
    v_cvt_pk_bf16_f32 v218, v204, v205
    v_pk_mul_f32 v[230:231], v[230:231], v[88:89] op_sel_hi:[1,0]
    v_exp_f32 v228, v228
    v_exp_f32 v229, v229
    buffer_load_dwordx4 a[180:183], v20, s[48:51], s45 offen offset:1024 sc1
    v_pk_fma_f32 v[226:227], v[226:227], v[88:89], v[88:89] op_sel:[0,1,1]
    v_rcp_f32 v224, v224
    v_rcp_f32 v225, v225
    v_pk_mul_f32 v[206:207], v[206:207], v[222:223]
    v_cvt_pk_bf16_f32 v219, v206, v207
    buffer_store_dwordx4 v[216:219], v19, s[48:51], s83 offen offset:512 sc1
    s_add_u32 s83, s83, 4096
    v_pk_mul_f32 v[232:233], v[232:233], v[88:89] op_sel_hi:[1,0]
    v_exp_f32 v230, v230
    buffer_load_dword v5, v2, s[76:79], 0 offen offset:256 sc1
    v_exp_f32 v231, v231
    v_pk_fma_f32 v[228:229], v[228:229], v[88:89], v[88:89] op_sel:[0,1,1]
    buffer_load_dwordx4 a[184:187], v20, s[48:51], s45 offen offset:2048 sc1
    v_rcp_f32 v226, v226
    v_rcp_f32 v227, v227
    v_pk_mul_f32 v[224:225], v[224:225], v[240:241]
    v_cvt_pk_bf16_f32 v240, v224, v225
    v_pk_mul_f32 v[234:235], v[234:235], v[88:89] op_sel_hi:[1,0]
    v_exp_f32 v232, v232
    v_exp_f32 v233, v233
    v_pk_fma_f32 v[230:231], v[230:231], v[88:89], v[88:89] op_sel:[0,1,1]
    v_rcp_f32 v228, v228
    v_rcp_f32 v229, v229
    buffer_load_dwordx4 a[188:191], v20, s[48:51], s45 offen offset:3072 sc1
    v_pk_mul_f32 v[226:227], v[226:227], v[242:243]
    v_cvt_pk_bf16_f32 v241, v226, v227
    v_pk_mul_f32 v[236:237], v[236:237], v[88:89] op_sel_hi:[1,0]
    v_exp_f32 v234, v234
    v_exp_f32 v235, v235
    v_pk_fma_f32 v[232:233], v[232:233], v[88:89], v[88:89] op_sel:[0,1,1]
    v_rcp_f32 v230, v230
    v_rcp_f32 v231, v231
    v_pk_mul_f32 v[228:229], v[228:229], v[244:245]
    v_cvt_pk_bf16_f32 v242, v228, v229
    v_pk_mul_f32 v[238:239], v[238:239], v[88:89] op_sel_hi:[1,0]
    v_exp_f32 v236, v236
    s_add_u32 s45, s20, 372736
    buffer_load_dwordx4 a[192:195], v20, s[48:51], s45 offen offset:0 sc1
    v_exp_f32 v237, v237
    v_pk_fma_f32 v[234:235], v[234:235], v[88:89], v[88:89] op_sel:[0,1,1]
    v_rcp_f32 v232, v232
    v_rcp_f32 v233, v233
    v_pk_mul_f32 v[230:231], v[230:231], v[246:247]
    v_cvt_pk_bf16_f32 v243, v230, v231
    buffer_store_dwordx4 v[240:243], v19, s[48:51], s83 offen offset:0 sc1
    v_exp_f32 v238, v238
    v_exp_f32 v239, v239
    v_pk_fma_f32 v[236:237], v[236:237], v[88:89], v[88:89] op_sel:[0,1,1]
    s_add_u32 s45, s20, 409600
    buffer_load_dwordx4 a[196:199], v20, s[48:51], s45 offen offset:0 sc1
    v_rcp_f32 v234, v234
    v_rcp_f32 v235, v235
    v_pk_mul_f32 v[232:233], v[232:233], v[248:249]
    v_cvt_pk_bf16_f32 v248, v232, v233
    v_pk_fma_f32 v[238:239], v[238:239], v[88:89], v[88:89] op_sel:[0,1,1]
    v_rcp_f32 v236, v236
    v_rcp_f32 v237, v237
    v_pk_mul_f32 v[234:235], v[234:235], v[250:251]
    v_cvt_pk_bf16_f32 v249, v234, v235
    v_rcp_f32 v238, v238
    v_rcp_f32 v239, v239
    buffer_load_dwordx4 a[200:203], v20, s[48:51], s45 offen offset:1024 sc1
    s_nop 0
    v_pk_mul_f32 v[236:237], v[236:237], v[252:253]
    v_cvt_pk_bf16_f32 v250, v236, v237
    s_nop 0
    v_pk_mul_f32 v[238:239], v[238:239], v[254:255]
    v_cvt_pk_bf16_f32 v251, v238, v239
    buffer_store_dwordx4 v[248:251], v19, s[48:51], s83 offen offset:512 sc1
    s_mov_b32 s52, s42
    s_mov_b32 s53, s43
    s_mov_b32 s54, 5242880
    s_mov_b32 s55, 0x00020000
    buffer_load_dwordx4 a[204:207], v20, s[48:51], s45 offen offset:2048 sc1
    buffer_load_dwordx4 v[88:91], v20, s[48:51], s45 offen offset:3072 sc1
    s_waitcnt vmcnt(38)
    v_mfma_f32_16x16x32_bf16 v[96:99], a[240:243], a[88:91], 0
    v_and_b32 v22, 0xffff0000, v21
    v_mfma_f32_16x16x32_bf16 v[100:103], a[244:247], a[88:91], 0
    v_rcp_f32 v22, v22
    v_mfma_f32_16x16x32_bf16 v[104:107], a[248:251], a[88:91], 0
    v_lshlrev_b32 v21, 16, v21
    v_mul_f32 v21, v21, v22
    s_add_u32 s45, s20, 413696
    v_mfma_f32_16x16x32_bf16 v[108:111], a[208:211], a[88:91], 0
    buffer_load_dwordx4 v[92:95], v20, s[48:51], s45 offen offset:0 sc1
    v_mfma_f32_16x16x32_bf16 v[112:115], a[212:215], a[88:91], 0
    v_lshlrev_b32 v28, 16, v48
    v_lshlrev_b32 v23, 16, v50
    v_mfma_f32_16x16x32_bf16 v[116:119], a[240:243], a[92:95], 0
    v_fma_f32 v24, v28, v22, v21
    v_fmac_f32 v28, v24, v23
    v_mfma_f32_16x16x32_bf16 v[120:123], a[244:247], a[92:95], 0
    v_and_b32 v29, 0xffff0000, v48
    v_and_b32 v23, 0xffff0000, v50
    s_add_u32 s45, s20, 450560
    s_add_u32 s45, s45, s99
    v_mfma_f32_16x16x32_bf16 v[124:127], a[248:251], a[92:95], 0
    buffer_load_dwordx4 a[88:91], v20, s[48:51], s45 offen offset:0 sc1
    v_mfma_f32_16x16x32_bf16 v[128:131], a[208:211], a[92:95], 0
    v_fma_f32 v24, v29, v22, v21
    v_fmac_f32 v29, v24, v23
    v_mfma_f32_16x16x32_bf16 v[132:135], a[212:215], a[92:95], 0
    v_lshlrev_b32 v30, 16, v49
    v_lshlrev_b32 v23, 16, v51
    v_mfma_f32_16x16x32_bf16 v[136:139], a[240:243], a[96:99], 0
    v_fma_f32 v24, v30, v22, v21
    v_fmac_f32 v30, v24, v23
    v_mfma_f32_16x16x32_bf16 v[140:143], a[244:247], a[96:99], 0
    s_waitcnt vmcnt(11)
    v_cmp_ne_u32 vcc, v5, v26
    s_nop 1
    s_and_b32 s34, vcc_lo, 0xffff
    s_cbranch_scc1 L_slow_18
L_ok_19:
    s_barrier
    s_add_u32 s44, s18, 65536
    buffer_load_dwordx4 a[92:95], v20, s[48:51], s44 offen offset:0 sc1
    v_mfma_f32_16x16x32_bf16 v[144:147], a[248:251], a[96:99], 0
    v_and_b32 v31, 0xffff0000, v49
    v_and_b32 v23, 0xffff0000, v51
    v_mfma_f32_16x16x32_bf16 v[148:151], a[208:211], a[96:99], 0
    v_fma_f32 v24, v31, v22, v21
    v_fmac_f32 v31, v24, v23
    v_mfma_f32_16x16x32_bf16 v[152:155], a[212:215], a[96:99], 0
    v_lshlrev_b32 v32, 16, v52
    v_lshlrev_b32 v23, 16, v54
    v_mfma_f32_16x16x32_bf16 v[156:159], a[240:243], a[100:103], 0
    buffer_load_dwordx4 a[96:99], v20, s[48:51], s44 offen offset:1024 sc1
    v_mfma_f32_16x16x32_bf16 v[160:163], a[244:247], a[100:103], 0
    v_fma_f32 v24, v32, v22, v21
    v_fmac_f32 v32, v24, v23
    v_mfma_f32_16x16x32_bf16 v[164:167], a[248:251], a[100:103], 0
    v_and_b32 v33, 0xffff0000, v52
    v_and_b32 v23, 0xffff0000, v54
    v_mfma_f32_16x16x32_bf16 v[168:171], a[208:211], a[100:103], 0
    v_fma_f32 v24, v33, v22, v21
    v_fmac_f32 v33, v24, v23
    v_mfma_f32_16x16x32_bf16 v[172:175], a[212:215], a[100:103], 0
    v_lshlrev_b32 v34, 16, v53
    v_lshlrev_b32 v23, 16, v55
    v_mfma_f32_16x16x32_bf16 v[96:99], a[216:219], a[104:107], v[96:99]
    v_fma_f32 v24, v34, v22, v21
    v_fmac_f32 v34, v24, v23
    v_mfma_f32_16x16x32_bf16 v[100:103], a[220:223], a[104:107], v[100:103]
    v_and_b32 v35, 0xffff0000, v53
    v_and_b32 v23, 0xffff0000, v55
    v_mfma_f32_16x16x32_bf16 v[104:107], a[0:3], a[104:107], v[104:107]
    v_fma_f32 v24, v35, v22, v21
    v_fmac_f32 v35, v24, v23
    v_mfma_f32_16x16x32_bf16 v[108:111], a[4:7], a[104:107], v[108:111]
    buffer_load_dwordx4 a[100:103], v20, s[48:51], s44 offen offset:2048 sc1
    v_mfma_f32_16x16x32_bf16 v[112:115], a[8:11], a[104:107], v[112:115]
    v_lshlrev_b32 v36, 16, v56
    v_lshlrev_b32 v23, 16, v58
    v_mfma_f32_16x16x32_bf16 v[116:119], a[216:219], a[108:111], v[116:119]
    v_fma_f32 v24, v36, v22, v21
    v_fmac_f32 v36, v24, v23
    v_mfma_f32_16x16x32_bf16 v[120:123], a[220:223], a[108:111], v[120:123]
    v_and_b32 v37, 0xffff0000, v56
    v_and_b32 v23, 0xffff0000, v58
    v_mfma_f32_16x16x32_bf16 v[124:127], a[0:3], a[108:111], v[124:127]
    buffer_load_dwordx4 a[104:107], v20, s[48:51], s44 offen offset:3072 sc1
    v_mfma_f32_16x16x32_bf16 v[128:131], a[4:7], a[108:111], v[128:131]
    v_fma_f32 v24, v37, v22, v21
    v_fmac_f32 v37, v24, v23
    v_mfma_f32_16x16x32_bf16 v[132:135], a[8:11], a[108:111], v[132:135]
    v_lshlrev_b32 v38, 16, v57
    v_lshlrev_b32 v23, 16, v59
    v_mfma_f32_16x16x32_bf16 v[136:139], a[216:219], a[112:115], v[136:139]
    s_waitcnt vmcnt(8)
    buffer_store_dword v26, v27, s[76:79], 0 offen offset:384 sc1
    s_add_u32 s44, s18, 98304
    v_mfma_f32_16x16x32_bf16 v[140:143], a[220:223], a[112:115], v[140:143]
    buffer_load_dwordx4 a[108:111], v20, s[48:51], s44 offen offset:0 sc1
    v_mfma_f32_16x16x32_bf16 v[144:147], a[0:3], a[112:115], v[144:147]
    v_fma_f32 v24, v38, v22, v21
    v_fmac_f32 v38, v24, v23
    v_mfma_f32_16x16x32_bf16 v[148:151], a[4:7], a[112:115], v[148:151]
    v_and_b32 v39, 0xffff0000, v57
    v_and_b32 v23, 0xffff0000, v59
    v_mfma_f32_16x16x32_bf16 v[152:155], a[8:11], a[112:115], v[152:155]
    v_fma_f32 v24, v39, v22, v21
    v_fmac_f32 v39, v24, v23
    v_mfma_f32_16x16x32_bf16 v[156:159], a[216:219], a[116:119], v[156:159]
    buffer_load_dwordx4 a[112:115], v20, s[48:51], s44 offen offset:1024 sc1
    v_mfma_f32_16x16x32_bf16 v[160:163], a[220:223], a[116:119], v[160:163]
    v_lshlrev_b32 v40, 16, v60
    v_lshlrev_b32 v23, 16, v62
    v_mfma_f32_16x16x32_bf16 v[164:167], a[0:3], a[116:119], v[164:167]
    v_fma_f32 v24, v40, v22, v21
    v_fmac_f32 v40, v24, v23
    v_mfma_f32_16x16x32_bf16 v[168:171], a[4:7], a[116:119], v[168:171]
    v_and_b32 v41, 0xffff0000, v60
    v_and_b32 v23, 0xffff0000, v62
    v_mfma_f32_16x16x32_bf16 v[172:175], a[8:11], a[116:119], v[172:175]
    v_fma_f32 v24, v41, v22, v21
    v_fmac_f32 v41, v24, v23
    v_mfma_f32_16x16x32_bf16 v[176:179], a[240:243], a[224:227], 0
    v_lshlrev_b32 v42, 16, v61
    v_lshlrev_b32 v23, 16, v63
    v_mfma_f32_16x16x32_bf16 v[180:183], a[244:247], a[224:227], 0
    v_fma_f32 v24, v42, v22, v21
    v_fmac_f32 v42, v24, v23
    v_mfma_f32_16x16x32_bf16 v[184:187], a[248:251], a[224:227], 0
    v_and_b32 v43, 0xffff0000, v61
    v_and_b32 v23, 0xffff0000, v63
    v_mfma_f32_16x16x32_bf16 v[188:191], a[208:211], a[224:227], 0
    buffer_load_dwordx4 a[116:119], v20, s[48:51], s44 offen offset:2048 sc1
    v_mfma_f32_16x16x32_bf16 v[192:195], a[212:215], a[224:227], 0
    v_fma_f32 v24, v43, v22, v21
    v_fmac_f32 v43, v24, v23
    v_mfma_f32_16x16x32_bf16 v[196:199], a[240:243], a[228:231], 0
    v_lshlrev_b32 v44, 16, v64
    v_lshlrev_b32 v23, 16, v66
    v_mfma_f32_16x16x32_bf16 v[200:203], a[244:247], a[228:231], 0
    v_fma_f32 v24, v44, v22, v21
    v_fmac_f32 v44, v24, v23
    v_mfma_f32_16x16x32_bf16 v[204:207], a[248:251], a[228:231], 0
    buffer_load_dwordx4 a[224:227], v20, s[48:51], s44 offen offset:3072 sc1
    v_mfma_f32_16x16x32_bf16 v[208:211], a[208:211], a[228:231], 0
    v_and_b32 v45, 0xffff0000, v64
    v_and_b32 v23, 0xffff0000, v66
    v_mfma_f32_16x16x32_bf16 v[212:215], a[212:215], a[228:231], 0
    v_fma_f32 v24, v45, v22, v21
    v_fmac_f32 v45, v24, v23
    v_mfma_f32_16x16x32_bf16 v[216:219], a[240:243], a[232:235], 0
    v_lshlrev_b32 v46, 16, v65
    v_lshlrev_b32 v23, 16, v67
    s_add_u32 s44, s18, 131072
    v_mfma_f32_16x16x32_bf16 v[220:223], a[244:247], a[232:235], 0
    buffer_load_dwordx4 a[228:231], v20, s[48:51], s44 offen offset:0 sc1
    v_mfma_f32_16x16x32_bf16 v[224:227], a[248:251], a[232:235], 0
    v_fma_f32 v24, v46, v22, v21
    v_fmac_f32 v46, v24, v23
    v_mfma_f32_16x16x32_bf16 v[228:231], a[208:211], a[232:235], 0
    v_and_b32 v47, 0xffff0000, v65
    v_and_b32 v23, 0xffff0000, v67
    v_mfma_f32_16x16x32_bf16 v[232:235], a[212:215], a[232:235], 0
    v_fma_f32 v24, v47, v22, v21
    v_fmac_f32 v47, v24, v23
    v_mfma_f32_16x16x32_bf16 v[236:239], a[240:243], a[236:239], 0
    buffer_load_dwordx4 v[48:51], v20, s[48:51], s44 offen offset:1024 sc1
    v_mfma_f32_16x16x32_bf16 v[240:243], a[244:247], a[236:239], 0
    v_mfma_f32_16x16x32_bf16 v[244:247], a[248:251], a[236:239], 0
    v_mfma_f32_16x16x32_bf16 v[248:251], a[208:211], a[236:239], 0
    v_mfma_f32_16x16x32_bf16 v[252:255], a[212:215], a[236:239], 0
    buffer_load_dwordx4 v[52:55], v20, s[48:51], s44 offen offset:2048 sc1
    v_mfma_f32_16x16x32_bf16 v[176:179], a[216:219], a[252:255], v[176:179]
    v_mfma_f32_16x16x32_bf16 v[180:183], a[220:223], a[252:255], v[180:183]
    v_mfma_f32_16x16x32_bf16 v[184:187], a[0:3], a[252:255], v[184:187]
    v_mfma_f32_16x16x32_bf16 v[188:191], a[4:7], a[252:255], v[188:191]
    buffer_load_dwordx4 v[56:59], v20, s[48:51], s44 offen offset:3072 sc1
    v_mfma_f32_16x16x32_bf16 v[192:195], a[8:11], a[252:255], v[192:195]
    v_mfma_f32_16x16x32_bf16 v[196:199], a[216:219], a[120:123], v[196:199]
    v_mfma_f32_16x16x32_bf16 v[200:203], a[220:223], a[120:123], v[200:203]
    s_add_u32 s44, s18, 163840
    v_mfma_f32_16x16x32_bf16 v[204:207], a[0:3], a[120:123], v[204:207]
    buffer_load_dwordx4 v[60:63], v20, s[48:51], s44 offen offset:0 sc1
    v_mfma_f32_16x16x32_bf16 v[208:211], a[4:7], a[120:123], v[208:211]
    v_mfma_f32_16x16x32_bf16 v[212:215], a[8:11], a[120:123], v[212:215]
    v_mfma_f32_16x16x32_bf16 v[216:219], a[216:219], a[124:127], v[216:219]
    v_mfma_f32_16x16x32_bf16 v[220:223], a[220:223], a[124:127], v[220:223]
    buffer_load_dwordx4 v[64:67], v20, s[48:51], s44 offen offset:1024 sc1
    v_mfma_f32_16x16x32_bf16 v[224:227], a[0:3], a[124:127], v[224:227]
    v_mfma_f32_16x16x32_bf16 v[228:231], a[4:7], a[124:127], v[228:231]
    v_mfma_f32_16x16x32_bf16 v[232:235], a[8:11], a[124:127], v[232:235]
    v_mfma_f32_16x16x32_bf16 v[236:239], a[216:219], a[128:131], v[236:239]
    buffer_load_dwordx4 a[232:235], v20, s[48:51], s44 offen offset:2048 sc1
    v_mfma_f32_16x16x32_bf16 v[240:243], a[220:223], a[128:131], v[240:243]
    v_mfma_f32_16x16x32_bf16 v[244:247], a[0:3], a[128:131], v[244:247]
    v_mfma_f32_16x16x32_bf16 v[248:251], a[4:7], a[128:131], v[248:251]
    v_mfma_f32_16x16x32_bf16 v[252:255], a[8:11], a[128:131], v[252:255]
    buffer_load_dwordx4 a[236:239], v20, s[48:51], s44 offen offset:3072 sc1
    s_waitcnt vmcnt(13)
    v_mfma_f32_16x16x32_bf16 v[96:99], a[12:15], a[92:95], v[96:99]
    v_mfma_f32_16x16x32_bf16 v[100:103], v[68:71], a[92:95], v[100:103]
    v_mfma_f32_16x16x32_bf16 v[104:107], v[72:75], a[92:95], v[104:107]
    s_add_u32 s44, s18, 196608
    v_mfma_f32_16x16x32_bf16 v[108:111], v[76:79], a[92:95], v[108:111]
    buffer_load_dwordx4 a[240:243], v20, s[48:51], s44 offen offset:0 sc1
    v_mfma_f32_16x16x32_bf16 v[112:115], v[80:83], a[92:95], v[112:115]
    v_mfma_f32_16x16x32_bf16 v[116:119], a[12:15], a[96:99], v[116:119]
    v_mfma_f32_16x16x32_bf16 v[120:123], v[68:71], a[96:99], v[120:123]
    v_mfma_f32_16x16x32_bf16 v[124:127], v[72:75], a[96:99], v[124:127]
    buffer_load_dwordx4 a[244:247], v20, s[48:51], s44 offen offset:1024 sc1
    v_mfma_f32_16x16x32_bf16 v[128:131], v[76:79], a[96:99], v[128:131]
    v_mfma_f32_16x16x32_bf16 v[132:135], v[80:83], a[96:99], v[132:135]
    v_mfma_f32_16x16x32_bf16 v[136:139], a[12:15], a[100:103], v[136:139]
    v_mfma_f32_16x16x32_bf16 v[140:143], v[68:71], a[100:103], v[140:143]
    buffer_load_dwordx4 a[248:251], v20, s[48:51], s44 offen offset:2048 sc1
    v_mfma_f32_16x16x32_bf16 v[144:147], v[72:75], a[100:103], v[144:147]
    v_mfma_f32_16x16x32_bf16 v[148:151], v[76:79], a[100:103], v[148:151]
    v_mfma_f32_16x16x32_bf16 v[152:155], v[80:83], a[100:103], v[152:155]
    v_mfma_f32_16x16x32_bf16 v[156:159], a[12:15], a[104:107], v[156:159]
    buffer_load_dwordx4 a[208:211], v20, s[48:51], s44 offen offset:3072 sc1
    v_mfma_f32_16x16x32_bf16 v[160:163], v[68:71], a[104:107], v[160:163]
    v_mfma_f32_16x16x32_bf16 v[164:167], v[72:75], a[104:107], v[164:167]
    v_mfma_f32_16x16x32_bf16 v[168:171], v[76:79], a[104:107], v[168:171]
    s_add_u32 s44, s19, 65536
    v_mfma_f32_16x16x32_bf16 v[172:175], v[80:83], a[104:107], v[172:175]
    buffer_load_dwordx4 a[212:215], v20, s[48:51], s44 offen offset:0 sc1
    s_waitcnt vmcnt(13)
    v_mfma_f32_16x16x32_bf16 v[96:99], v[84:87], a[108:111], v[96:99]
    v_mfma_f32_16x16x32_bf16 v[100:103], a[16:19], a[108:111], v[100:103]
    v_mfma_f32_16x16x32_bf16 v[104:107], a[20:23], a[108:111], v[104:107]
    v_mfma_f32_16x16x32_bf16 v[108:111], a[24:27], a[108:111], v[108:111]
    buffer_load_dwordx4 a[252:255], v20, s[48:51], s44 offen offset:1024 sc1
    v_mfma_f32_16x16x32_bf16 v[112:115], a[28:31], a[108:111], v[112:115]
    v_mfma_f32_16x16x32_bf16 v[116:119], v[84:87], a[112:115], v[116:119]
    v_mfma_f32_16x16x32_bf16 v[120:123], a[16:19], a[112:115], v[120:123]
    v_mfma_f32_16x16x32_bf16 v[124:127], a[20:23], a[112:115], v[124:127]
    buffer_load_dwordx4 a[120:123], v20, s[48:51], s44 offen offset:2048 sc1
    v_mfma_f32_16x16x32_bf16 v[128:131], a[24:27], a[112:115], v[128:131]
    v_mfma_f32_16x16x32_bf16 v[132:135], a[28:31], a[112:115], v[132:135]
    v_mfma_f32_16x16x32_bf16 v[136:139], v[84:87], a[116:119], v[136:139]
    v_mfma_f32_16x16x32_bf16 v[140:143], a[16:19], a[116:119], v[140:143]
    buffer_load_dwordx4 a[124:127], v20, s[48:51], s44 offen offset:3072 sc1
    v_mfma_f32_16x16x32_bf16 v[144:147], a[20:23], a[116:119], v[144:147]
    v_mfma_f32_16x16x32_bf16 v[148:151], a[24:27], a[116:119], v[148:151]
    v_mfma_f32_16x16x32_bf16 v[152:155], a[28:31], a[116:119], v[152:155]
    v_mfma_f32_16x16x32_bf16 v[156:159], v[84:87], a[224:227], v[156:159]
    buffer_load_dwordx4 a[128:131], v20, s[48:51], s45 offen offset:1024 sc1
    v_mfma_f32_16x16x32_bf16 v[160:163], a[16:19], a[224:227], v[160:163]
    v_mfma_f32_16x16x32_bf16 v[164:167], a[20:23], a[224:227], v[164:167]
    v_mfma_f32_16x16x32_bf16 v[168:171], a[24:27], a[224:227], v[168:171]
    v_mfma_f32_16x16x32_bf16 v[172:175], a[28:31], a[224:227], v[172:175]
    buffer_load_dword v5, v2, s[76:79], 0 offen offset:384 sc1
    s_waitcnt vmcnt(14)
    v_mfma_f32_16x16x32_bf16 v[96:99], a[32:35], a[228:231], v[96:99]
    v_mfma_f32_16x16x32_bf16 v[100:103], a[36:39], a[228:231], v[100:103]
    v_mfma_f32_16x16x32_bf16 v[104:107], a[40:43], a[228:231], v[104:107]
    v_mfma_f32_16x16x32_bf16 v[108:111], a[44:47], a[228:231], v[108:111]
    buffer_load_dwordx4 a[216:219], v20, s[48:51], s45 offen offset:2048 sc1
    v_mfma_f32_16x16x32_bf16 v[112:115], a[48:51], a[228:231], v[112:115]
    v_mfma_f32_16x16x32_bf16 v[116:119], a[32:35], v[48:51], v[116:119]
    v_mfma_f32_16x16x32_bf16 v[120:123], a[36:39], v[48:51], v[120:123]
    v_mfma_f32_16x16x32_bf16 v[124:127], a[40:43], v[48:51], v[124:127]
    buffer_load_dwordx4 a[220:223], v20, s[48:51], s45 offen offset:3072 sc1
    v_mfma_f32_16x16x32_bf16 v[128:131], a[44:47], v[48:51], v[128:131]
    v_mfma_f32_16x16x32_bf16 v[132:135], a[48:51], v[48:51], v[132:135]
    v_mfma_f32_16x16x32_bf16 v[136:139], a[32:35], v[52:55], v[136:139]
    s_add_u32 s45, s20, 454656
    s_add_u32 s45, s45, s99
    v_mfma_f32_16x16x32_bf16 v[140:143], a[36:39], v[52:55], v[140:143]
    buffer_load_dwordx4 a[0:3], v20, s[48:51], s45 offen offset:0 sc1
    v_mfma_f32_16x16x32_bf16 v[144:147], a[40:43], v[52:55], v[144:147]
    v_mfma_f32_16x16x32_bf16 v[148:151], a[44:47], v[52:55], v[148:151]
    v_mfma_f32_16x16x32_bf16 v[152:155], a[48:51], v[52:55], v[152:155]
    s_add_u32 s44, s19, 98304
    v_mfma_f32_16x16x32_bf16 v[156:159], a[32:35], v[56:59], v[156:159]
    buffer_load_dwordx4 a[4:7], v20, s[48:51], s44 offen offset:0 sc1
    v_mfma_f32_16x16x32_bf16 v[160:163], a[36:39], v[56:59], v[160:163]
    v_mfma_f32_16x16x32_bf16 v[164:167], a[40:43], v[56:59], v[164:167]
    v_mfma_f32_16x16x32_bf16 v[168:171], a[44:47], v[56:59], v[168:171]
    v_mfma_f32_16x16x32_bf16 v[172:175], a[48:51], v[56:59], v[172:175]
    buffer_load_dwordx4 a[8:11], v20, s[48:51], s44 offen offset:1024 sc1
    s_waitcnt vmcnt(15)
    v_mfma_f32_16x16x32_bf16 v[96:99], a[52:55], v[60:63], v[96:99]
    v_mfma_f32_16x16x32_bf16 v[100:103], a[56:59], v[60:63], v[100:103]
    v_mfma_f32_16x16x32_bf16 v[104:107], a[60:63], v[60:63], v[104:107]
    v_mfma_f32_16x16x32_bf16 v[108:111], a[64:67], v[60:63], v[108:111]
    buffer_load_dwordx4 a[92:95], v20, s[48:51], s44 offen offset:2048 sc1
    v_mfma_f32_16x16x32_bf16 v[112:115], a[68:71], v[60:63], v[112:115]
    v_mfma_f32_16x16x32_bf16 v[116:119], a[52:55], v[64:67], v[116:119]
    v_mfma_f32_16x16x32_bf16 v[120:123], a[56:59], v[64:67], v[120:123]
    v_mfma_f32_16x16x32_bf16 v[124:127], a[60:63], v[64:67], v[124:127]
    buffer_load_dwordx4 a[96:99], v20, s[48:51], s44 offen offset:3072 sc1
    v_mfma_f32_16x16x32_bf16 v[128:131], a[64:67], v[64:67], v[128:131]
    v_mfma_f32_16x16x32_bf16 v[132:135], a[68:71], v[64:67], v[132:135]
    v_mfma_f32_16x16x32_bf16 v[136:139], a[52:55], a[232:235], v[136:139]
    v_mfma_f32_16x16x32_bf16 v[140:143], a[56:59], a[232:235], v[140:143]
    s_waitcnt vmcnt(7)
    v_cmp_ne_u32 vcc, v5, v26
    s_nop 1
    s_and_b32 s34, vcc_lo, 0xffff
    s_cbranch_scc1 L_slow_20
L_ok_21:
    s_barrier
    s_add_u32 s44, s18, 229376
    buffer_load_dwordx4 a[100:103], v20, s[48:51], s44 offen offset:0 sc1
    v_mfma_f32_16x16x32_bf16 v[144:147], a[60:63], a[232:235], v[144:147]
    v_mfma_f32_16x16x32_bf16 v[148:151], a[64:67], a[232:235], v[148:151]
    v_mfma_f32_16x16x32_bf16 v[152:155], a[68:71], a[232:235], v[152:155]
    v_mfma_f32_16x16x32_bf16 v[156:159], a[52:55], a[236:239], v[156:159]
    buffer_load_dwordx4 a[104:107], v20, s[48:51], s44 offen offset:1024 sc1
    v_mfma_f32_16x16x32_bf16 v[160:163], a[56:59], a[236:239], v[160:163]
    v_mfma_f32_16x16x32_bf16 v[164:167], a[60:63], a[236:239], v[164:167]
    v_mfma_f32_16x16x32_bf16 v[168:171], a[64:67], a[236:239], v[168:171]
    v_mfma_f32_16x16x32_bf16 v[172:175], a[68:71], a[236:239], v[172:175]
    buffer_load_dwordx4 a[108:111], v20, s[48:51], s44 offen offset:2048 sc1
    v_mfma_f32_16x16x32_bf16 v[96:99], a[72:75], a[240:243], v[96:99]
    v_mfma_f32_16x16x32_bf16 v[100:103], a[76:79], a[240:243], v[100:103]
    v_mfma_f32_16x16x32_bf16 v[104:107], a[80:83], a[240:243], v[104:107]
    v_mfma_f32_16x16x32_bf16 v[108:111], a[84:87], a[240:243], v[108:111]
    buffer_load_dwordx4 a[112:115], v20, s[48:51], s44 offen offset:3072 sc1
    v_mfma_f32_16x16x32_bf16 v[112:115], a[132:135], a[240:243], v[112:115]
    v_mfma_f32_16x16x32_bf16 v[116:119], a[72:75], a[244:247], v[116:119]
    v_mfma_f32_16x16x32_bf16 v[120:123], a[76:79], a[244:247], v[120:123]
    s_add_u32 s44, s18, 262144
    v_mfma_f32_16x16x32_bf16 v[124:127], a[80:83], a[244:247], v[124:127]
    buffer_load_dwordx4 a[116:119], v20, s[48:51], s44 offen offset:0 sc1
    v_mfma_f32_16x16x32_bf16 v[128:131], a[84:87], a[244:247], v[128:131]
    v_mfma_f32_16x16x32_bf16 v[132:135], a[132:135], a[244:247], v[132:135]
    v_mfma_f32_16x16x32_bf16 v[136:139], a[72:75], a[248:251], v[136:139]
    v_mfma_f32_16x16x32_bf16 v[140:143], a[76:79], a[248:251], v[140:143]
    buffer_load_dwordx4 a[224:227], v20, s[48:51], s44 offen offset:1024 sc1
    v_mfma_f32_16x16x32_bf16 v[144:147], a[80:83], a[248:251], v[144:147]
    v_mfma_f32_16x16x32_bf16 v[148:151], a[84:87], a[248:251], v[148:151]
    v_mfma_f32_16x16x32_bf16 v[152:155], a[132:135], a[248:251], v[152:155]
    v_mfma_f32_16x16x32_bf16 v[156:159], a[72:75], a[208:211], v[156:159]
    buffer_load_dwordx4 a[228:231], v20, s[48:51], s44 offen offset:2048 sc1
    v_mfma_f32_16x16x32_bf16 v[160:163], a[76:79], a[208:211], v[160:163]
    v_mfma_f32_16x16x32_bf16 v[164:167], a[80:83], a[208:211], v[164:167]
    v_mfma_f32_16x16x32_bf16 v[168:171], a[84:87], a[208:211], v[168:171]
    v_mfma_f32_16x16x32_bf16 v[172:175], a[132:135], a[208:211], v[172:175]
    buffer_load_dwordx4 v[48:51], v20, s[48:51], s44 offen offset:3072 sc1
    v_mfma_f32_16x16x32_bf16 v[176:179], a[12:15], a[212:215], v[176:179]
    v_mfma_f32_16x16x32_bf16 v[180:183], v[68:71], a[212:215], v[180:183]
    v_mfma_f32_16x16x32_bf16 v[184:187], v[72:75], a[212:215], v[184:187]
    s_add_u32 s44, s18, 294912
    v_mfma_f32_16x16x32_bf16 v[188:191], v[76:79], a[212:215], v[188:191]
    buffer_load_dwordx4 v[52:55], v20, s[48:51], s44 offen offset:0 sc1
    v_mfma_f32_16x16x32_bf16 v[192:195], v[80:83], a[212:215], v[192:195]
    v_mfma_f32_16x16x32_bf16 v[196:199], a[12:15], a[252:255], v[196:199]
    v_mfma_f32_16x16x32_bf16 v[200:203], v[68:71], a[252:255], v[200:203]
    s_add_u32 s44, s18, 327680
    v_mfma_f32_16x16x32_bf16 v[204:207], v[72:75], a[252:255], v[204:207]
    buffer_load_dwordx4 v[56:59], v20, s[48:51], s44 offen offset:0 sc1
    v_mfma_f32_16x16x32_bf16 v[208:211], v[76:79], a[252:255], v[208:211]
    v_mfma_f32_16x16x32_bf16 v[212:215], v[80:83], a[252:255], v[212:215]
    v_mfma_f32_16x16x32_bf16 v[216:219], a[12:15], a[120:123], v[216:219]
    s_add_u32 s44, s18, 360448
    s_add_u32 s44, s44, s99
    v_mfma_f32_16x16x32_bf16 v[220:223], v[68:71], a[120:123], v[220:223]
    buffer_load_dwordx4 v[60:63], v20, s[48:51], s44 offen offset:0 sc1
    v_mfma_f32_16x16x32_bf16 v[224:227], v[72:75], a[120:123], v[224:227]
    v_mfma_f32_16x16x32_bf16 v[228:231], v[76:79], a[120:123], v[228:231]
    v_mfma_f32_16x16x32_bf16 v[232:235], v[80:83], a[120:123], v[232:235]
    s_add_u32 s44, s18, 294912
    v_mfma_f32_16x16x32_bf16 v[236:239], a[12:15], a[124:127], v[236:239]
    buffer_load_dwordx4 v[64:67], v20, s[48:51], s44 offen offset:1024 sc1
    v_mfma_f32_16x16x32_bf16 v[240:243], v[68:71], a[124:127], v[240:243]
    v_mfma_f32_16x16x32_bf16 v[244:247], v[72:75], a[124:127], v[244:247]
    v_mfma_f32_16x16x32_bf16 v[248:251], v[76:79], a[124:127], v[248:251]
    s_add_u32 s44, s18, 327680
    v_mfma_f32_16x16x32_bf16 v[252:255], v[80:83], a[124:127], v[252:255]
    buffer_load_dwordx4 a[232:235], v20, s[48:51], s44 offen offset:1024 sc1
    s_waitcnt vmcnt(9)
    v_mfma_f32_16x16x32_bf16 v[96:99], a[136:139], a[100:103], v[96:99]
    v_mfma_f32_16x16x32_bf16 v[100:103], a[140:143], a[100:103], v[100:103]
    v_mfma_f32_16x16x32_bf16 v[104:107], a[144:147], a[100:103], v[104:107]
    s_add_u32 s44, s18, 360448
    s_add_u32 s44, s44, s99
    v_mfma_f32_16x16x32_bf16 v[108:111], a[148:151], a[100:103], v[108:111]
    buffer_load_dwordx4 a[236:239], v20, s[48:51], s44 offen offset:1024 sc1
    v_mfma_f32_16x16x32_bf16 v[112:115], a[152:155], a[100:103], v[112:115]
    v_mfma_f32_16x16x32_bf16 v[116:119], a[136:139], a[104:107], v[116:119]
    v_mfma_f32_16x16x32_bf16 v[120:123], a[140:143], a[104:107], v[120:123]
    s_add_u32 s44, s18, 294912
    v_mfma_f32_16x16x32_bf16 v[124:127], a[144:147], a[104:107], v[124:127]
    buffer_load_dwordx4 a[240:243], v20, s[48:51], s44 offen offset:2048 sc1
    v_mfma_f32_16x16x32_bf16 v[128:131], a[148:151], a[104:107], v[128:131]
    v_mfma_f32_16x16x32_bf16 v[132:135], a[152:155], a[104:107], v[132:135]
    v_mfma_f32_16x16x32_bf16 v[136:139], a[136:139], a[108:111], v[136:139]
    s_add_u32 s44, s18, 327680
    v_mfma_f32_16x16x32_bf16 v[140:143], a[140:143], a[108:111], v[140:143]
    buffer_load_dwordx4 a[244:247], v20, s[48:51], s44 offen offset:2048 sc1
    v_mfma_f32_16x16x32_bf16 v[144:147], a[144:147], a[108:111], v[144:147]
    v_mfma_f32_16x16x32_bf16 v[148:151], a[148:151], a[108:111], v[148:151]
    v_mfma_f32_16x16x32_bf16 v[152:155], a[152:155], a[108:111], v[152:155]
    s_add_u32 s44, s18, 360448
    s_add_u32 s44, s44, s99
    v_mfma_f32_16x16x32_bf16 v[156:159], a[136:139], a[112:115], v[156:159]
    buffer_load_dwordx4 a[248:251], v20, s[48:51], s44 offen offset:2048 sc1
    v_mfma_f32_16x16x32_bf16 v[160:163], a[140:143], a[112:115], v[160:163]
    v_mfma_f32_16x16x32_bf16 v[164:167], a[144:147], a[112:115], v[164:167]
    v_mfma_f32_16x16x32_bf16 v[168:171], a[148:151], a[112:115], v[168:171]
    s_add_u32 s44, s18, 294912
    v_mfma_f32_16x16x32_bf16 v[172:175], a[152:155], a[112:115], v[172:175]
    buffer_load_dwordx4 a[208:211], v20, s[48:51], s44 offen offset:3072 sc1
    s_waitcnt vmcnt(10)
    v_mfma_f32_16x16x32_bf16 v[96:99], a[156:159], a[116:119], v[96:99]
    v_mfma_f32_16x16x32_bf16 v[100:103], a[160:163], a[116:119], v[100:103]
    v_mfma_f32_16x16x32_bf16 v[104:107], a[164:167], a[116:119], v[104:107]
    s_add_u32 s44, s18, 327680
    v_mfma_f32_16x16x32_bf16 v[108:111], a[168:171], a[116:119], v[108:111]
    buffer_load_dwordx4 a[212:215], v20, s[48:51], s44 offen offset:3072 sc1
    v_mfma_f32_16x16x32_bf16 v[112:115], a[172:175], a[116:119], v[112:115]
    v_mfma_f32_16x16x32_bf16 v[116:119], a[156:159], a[224:227], v[116:119]
    v_mfma_f32_16x16x32_bf16 v[120:123], a[160:163], a[224:227], v[120:123]
    s_add_u32 s44, s18, 360448
    s_add_u32 s44, s44, s99
    v_mfma_f32_16x16x32_bf16 v[124:127], a[164:167], a[224:227], v[124:127]
    buffer_load_dwordx4 a[252:255], v20, s[48:51], s44 offen offset:3072 sc1
    v_mfma_f32_16x16x32_bf16 v[128:131], a[168:171], a[224:227], v[128:131]
    v_mfma_f32_16x16x32_bf16 v[132:135], a[172:175], a[224:227], v[132:135]
    v_mfma_f32_16x16x32_bf16 v[136:139], a[156:159], a[228:231], v[136:139]
    s_add_u32 s44, s19, 131072
    v_mfma_f32_16x16x32_bf16 v[140:143], a[160:163], a[228:231], v[140:143]
    buffer_load_dwordx4 a[120:123], v20, s[48:51], s44 offen offset:0 sc1
    v_mfma_f32_16x16x32_bf16 v[144:147], a[164:167], a[228:231], v[144:147]
    v_mfma_f32_16x16x32_bf16 v[148:151], a[168:171], a[228:231], v[148:151]
    v_mfma_f32_16x16x32_bf16 v[152:155], a[172:175], a[228:231], v[152:155]
    v_mfma_f32_16x16x32_bf16 v[156:159], a[156:159], v[48:51], v[156:159]
    buffer_load_dwordx4 a[124:127], v20, s[48:51], s44 offen offset:1024 sc1
    v_mfma_f32_16x16x32_bf16 v[160:163], a[160:163], v[48:51], v[160:163]
    v_mfma_f32_16x16x32_bf16 v[164:167], a[164:167], v[48:51], v[164:167]
    v_mfma_f32_16x16x32_bf16 v[168:171], a[168:171], v[48:51], v[168:171]
    v_mfma_f32_16x16x32_bf16 v[172:175], a[172:175], v[48:51], v[172:175]
    buffer_load_dwordx4 a[12:15], v20, s[48:51], s44 offen offset:2048 sc1
    s_waitcnt vmcnt(12)
    v_mfma_f32_16x16x32_bf16 v[96:99], a[176:179], v[52:55], v[96:99]
    v_mfma_f32_16x16x32_bf16 v[100:103], a[180:183], v[52:55], v[100:103]
    v_mfma_f32_16x16x32_bf16 v[104:107], a[184:187], v[52:55], v[104:107]
    v_mfma_f32_16x16x32_bf16 v[108:111], a[188:191], v[52:55], v[108:111]
    buffer_load_dwordx4 v[68:71], v20, s[48:51], s44 offen offset:3072 sc1
    v_mfma_f32_16x16x32_bf16 v[112:115], a[192:195], v[52:55], v[112:115]
    v_mfma_f32_16x16x32_bf16 v[96:99], a[196:199], v[56:59], v[96:99]
    v_mfma_f32_16x16x32_bf16 v[100:103], a[200:203], v[56:59], v[100:103]
    s_add_u32 s44, s19, 163840
    v_mfma_f32_16x16x32_bf16 v[104:107], a[204:207], v[56:59], v[104:107]
    buffer_load_dwordx4 v[72:75], v20, s[48:51], s44 offen offset:0 sc1
    v_mfma_f32_16x16x32_bf16 v[108:111], v[88:91], v[56:59], v[108:111]
    v_mfma_f32_16x16x32_bf16 v[112:115], v[92:95], v[56:59], v[112:115]
    v_mfma_f32_16x16x32_bf16 v[96:99], a[88:91], v[60:63], v[96:99]
    v_mfma_f32_16x16x32_bf16 v[100:103], a[128:131], v[60:63], v[100:103]
    buffer_load_dwordx4 v[76:79], v20, s[48:51], s44 offen offset:1024 sc1
    v_mfma_f32_16x16x32_bf16 v[104:107], a[216:219], v[60:63], v[104:107]
    v_mfma_f32_16x16x32_bf16 v[108:111], a[220:223], v[60:63], v[108:111]
    v_mfma_f32_16x16x32_bf16 v[112:115], a[0:3], v[60:63], v[112:115]
    s_waitcnt vmcnt(12)
    v_mfma_f32_16x16x32_bf16 v[116:119], a[176:179], v[64:67], v[116:119]
    buffer_load_dwordx4 v[80:83], v20, s[48:51], s44 offen offset:2048 sc1
    v_mfma_f32_16x16x32_bf16 v[120:123], a[180:183], v[64:67], v[120:123]
    v_mfma_f32_16x16x32_bf16 v[124:127], a[184:187], v[64:67], v[124:127]
    ds_write_b128 v17, v[96:99] offset:0
    v_mfma_f32_16x16x32_bf16 v[128:131], a[188:191], v[64:67], v[128:131]
    v_mfma_f32_16x16x32_bf16 v[132:135], a[192:195], v[64:67], v[132:135]
    buffer_load_dwordx4 a[100:103], v20, s[48:51], s44 offen offset:3072 sc1
    v_mfma_f32_16x16x32_bf16 v[116:119], a[196:199], a[232:235], v[116:119]
    ds_write_b128 v17, v[100:103] offset:64
    v_mfma_f32_16x16x32_bf16 v[120:123], a[200:203], a[232:235], v[120:123]
    v_mfma_f32_16x16x32_bf16 v[124:127], a[204:207], a[232:235], v[124:127]
    s_add_u32 s44, s19, 196608
    v_mfma_f32_16x16x32_bf16 v[128:131], v[88:91], a[232:235], v[128:131]
    buffer_load_dwordx4 a[104:107], v20, s[48:51], s44 offen offset:0 sc1
    ds_write_b128 v17, v[104:107] offset:128
    v_mfma_f32_16x16x32_bf16 v[132:135], v[92:95], a[232:235], v[132:135]
    v_mfma_f32_16x16x32_bf16 v[116:119], a[88:91], a[236:239], v[116:119]
    v_mfma_f32_16x16x32_bf16 v[120:123], a[128:131], a[236:239], v[120:123]
    ds_write_b128 v17, v[108:111] offset:192
    v_mfma_f32_16x16x32_bf16 v[124:127], a[216:219], a[236:239], v[124:127]
    buffer_load_dwordx4 a[108:111], v20, s[48:51], s44 offen offset:1024 sc1
    v_mfma_f32_16x16x32_bf16 v[128:131], a[220:223], a[236:239], v[128:131]
    v_mfma_f32_16x16x32_bf16 v[132:135], a[0:3], a[236:239], v[132:135]
    ds_write_b128 v17, v[112:115] offset:256
    s_waitcnt vmcnt(13)
    v_mfma_f32_16x16x32_bf16 v[136:139], a[176:179], a[240:243], v[136:139]
    v_mfma_f32_16x16x32_bf16 v[140:143], a[180:183], a[240:243], v[140:143]
    buffer_load_dwordx4 a[112:115], v20, s[48:51], s44 offen offset:2048 sc1
    v_mfma_f32_16x16x32_bf16 v[144:147], a[184:187], a[240:243], v[144:147]
    ds_write_b128 v17, v[116:119] offset:5120
    v_mfma_f32_16x16x32_bf16 v[148:151], a[188:191], a[240:243], v[148:151]
    v_mfma_f32_16x16x32_bf16 v[152:155], a[192:195], a[240:243], v[152:155]
    v_mfma_f32_16x16x32_bf16 v[136:139], a[196:199], a[244:247], v[136:139]
    buffer_load_dwordx4 a[116:119], v20, s[48:51], s44 offen offset:3072 sc1
    ds_write_b128 v17, v[120:123] offset:5184
    v_mfma_f32_16x16x32_bf16 v[140:143], a[200:203], a[244:247], v[140:143]
    v_mfma_f32_16x16x32_bf16 v[144:147], a[204:207], a[244:247], v[144:147]
    v_mfma_f32_16x16x32_bf16 v[148:151], v[88:91], a[244:247], v[148:151]
    ds_write_b128 v17, v[124:127] offset:5248
    s_add_u32 s44, s19, 229376
    v_mfma_f32_16x16x32_bf16 v[152:155], v[92:95], a[244:247], v[152:155]
    buffer_load_dwordx4 a[224:227], v20, s[48:51], s44 offen offset:0 sc1
    v_mfma_f32_16x16x32_bf16 v[136:139], a[88:91], a[248:251], v[136:139]
    v_mfma_f32_16x16x32_bf16 v[140:143], a[128:131], a[248:251], v[140:143]
    ds_write_b128 v17, v[128:131] offset:5312
    v_mfma_f32_16x16x32_bf16 v[144:147], a[216:219], a[248:251], v[144:147]
    v_mfma_f32_16x16x32_bf16 v[148:151], a[220:223], a[248:251], v[148:151]
    buffer_load_dwordx4 a[228:231], v20, s[48:51], s44 offen offset:1024 sc1
    v_mfma_f32_16x16x32_bf16 v[152:155], a[0:3], a[248:251], v[152:155]
    ds_write_b128 v17, v[132:135] offset:5376
    s_waitcnt vmcnt(14)
    v_mfma_f32_16x16x32_bf16 v[156:159], a[176:179], a[208:211], v[156:159]
    v_mfma_f32_16x16x32_bf16 v[160:163], a[180:183], a[208:211], v[160:163]
    v_mfma_f32_16x16x32_bf16 v[164:167], a[184:187], a[208:211], v[164:167]
    buffer_load_dwordx4 v[48:51], v20, s[48:51], s44 offen offset:2048 sc1
    ds_write_b128 v17, v[136:139] offset:10240
    v_mfma_f32_16x16x32_bf16 v[168:171], a[188:191], a[208:211], v[168:171]
    v_mfma_f32_16x16x32_bf16 v[172:175], a[192:195], a[208:211], v[172:175]
    v_mfma_f32_16x16x32_bf16 v[156:159], a[196:199], a[212:215], v[156:159]
    ds_write_b128 v17, v[140:143] offset:10304
    v_mfma_f32_16x16x32_bf16 v[160:163], a[200:203], a[212:215], v[160:163]
    buffer_load_dwordx4 v[52:55], v20, s[48:51], s44 offen offset:3072 sc1
    v_mfma_f32_16x16x32_bf16 v[164:167], a[204:207], a[212:215], v[164:167]
    v_mfma_f32_16x16x32_bf16 v[168:171], v[88:91], a[212:215], v[168:171]
    ds_write_b128 v17, v[144:147] offset:10368
    v_mfma_f32_16x16x32_bf16 v[172:175], v[92:95], a[212:215], v[172:175]
    s_add_u32 s44, s19, 262144
    v_mfma_f32_16x16x32_bf16 v[156:159], a[88:91], a[252:255], v[156:159]
    buffer_load_dwordx4 v[56:59], v20, s[48:51], s44 offen offset:0 sc1
    v_mfma_f32_16x16x32_bf16 v[160:163], a[128:131], a[252:255], v[160:163]
    ds_write_b128 v17, v[148:151] offset:10432
    v_mfma_f32_16x16x32_bf16 v[164:167], a[216:219], a[252:255], v[164:167]
    v_mfma_f32_16x16x32_bf16 v[168:171], a[220:223], a[252:255], v[168:171]
    v_mfma_f32_16x16x32_bf16 v[172:175], a[0:3], a[252:255], v[172:175]
    buffer_load_dwordx4 v[60:63], v20, s[48:51], s44 offen offset:1024 sc1
    ds_write_b128 v17, v[152:155] offset:10496
    v_mfma_f32_16x16x32_bf16 v[176:179], v[84:87], a[4:7], v[176:179]
    v_mfma_f32_16x16x32_bf16 v[180:183], a[16:19], a[4:7], v[180:183]
    v_mfma_f32_16x16x32_bf16 v[184:187], a[20:23], a[4:7], v[184:187]
    ds_write_b128 v17, v[156:159] offset:15360
    v_mfma_f32_16x16x32_bf16 v[188:191], a[24:27], a[4:7], v[188:191]
    buffer_load_dwordx4 v[64:67], v20, s[48:51], s44 offen offset:2048 sc1
    v_mfma_f32_16x16x32_bf16 v[192:195], a[28:31], a[4:7], v[192:195]
    v_mfma_f32_16x16x32_bf16 v[196:199], v[84:87], a[8:11], v[196:199]
    ds_write_b128 v17, v[160:163] offset:15424
    v_mfma_f32_16x16x32_bf16 v[200:203], a[16:19], a[8:11], v[200:203]
    v_mfma_f32_16x16x32_bf16 v[204:207], a[20:23], a[8:11], v[204:207]
    buffer_load_dwordx4 a[232:235], v20, s[48:51], s44 offen offset:3072 sc1
    v_mfma_f32_16x16x32_bf16 v[208:211], a[24:27], a[8:11], v[208:211]
    ds_write_b128 v17, v[164:167] offset:15488
    v_mfma_f32_16x16x32_bf16 v[212:215], a[28:31], a[8:11], v[212:215]
    v_mfma_f32_16x16x32_bf16 v[216:219], v[84:87], a[92:95], v[216:219]
    s_add_u32 s44, s19, 294912
    v_mfma_f32_16x16x32_bf16 v[220:223], a[16:19], a[92:95], v[220:223]
    buffer_load_dwordx4 a[236:239], v20, s[48:51], s44 offen offset:0 sc1
    ds_write_b128 v17, v[168:171] offset:15552
    v_mfma_f32_16x16x32_bf16 v[224:227], a[20:23], a[92:95], v[224:227]
    v_mfma_f32_16x16x32_bf16 v[228:231], a[24:27], a[92:95], v[228:231]
    v_mfma_f32_16x16x32_bf16 v[232:235], a[28:31], a[92:95], v[232:235]
    ds_write_b128 v17, v[172:175] offset:15616
    s_add_u32 s44, s19, 327680
    v_mfma_f32_16x16x32_bf16 v[236:239], v[84:87], a[96:99], v[236:239]
    buffer_load_dwordx4 a[240:243], v20, s[48:51], s44 offen offset:0 sc1
    v_mfma_f32_16x16x32_bf16 v[240:243], a[16:19], a[96:99], v[240:243]
    v_mfma_f32_16x16x32_bf16 v[244:247], a[20:23], a[96:99], v[244:247]
    v_mfma_f32_16x16x32_bf16 v[248:251], a[24:27], a[96:99], v[248:251]
    s_add_u32 s44, s19, 360448
    s_add_u32 s44, s44, s99
    v_mfma_f32_16x16x32_bf16 v[252:255], a[28:31], a[96:99], v[252:255]
    buffer_load_dwordx4 a[244:247], v20, s[48:51], s44 offen offset:0 sc1
    s_waitcnt vmcnt(19)
    v_mfma_f32_16x16x32_bf16 v[176:179], a[32:35], a[120:123], v[176:179]
    s_waitcnt lgkmcnt(0)
    s_barrier
    v_mfma_f32_16x16x32_bf16 v[180:183], a[36:39], a[120:123], v[180:183]
    ds_read_b128 v[96:99], v15 offset:0
    ds_read_b128 v[100:103], v15 offset:20480
    v_mfma_f32_16x16x32_bf16 v[184:187], a[40:43], a[120:123], v[184:187]
    ds_read_b128 v[104:107], v15 offset:40960
    ds_read_b128 v[108:111], v15 offset:61440
    s_add_u32 s44, s19, 294912
    v_mfma_f32_16x16x32_bf16 v[188:191], a[44:47], a[120:123], v[188:191]
    buffer_load_dwordx4 a[248:251], v20, s[48:51], s44 offen offset:1024 sc1
    v_mfma_f32_16x16x32_bf16 v[192:195], a[48:51], a[120:123], v[192:195]
    ds_read_b128 v[112:115], v15 offset:64
    ds_read_b128 v[116:119], v15 offset:20544
    v_mfma_f32_16x16x32_bf16 v[196:199], a[32:35], a[124:127], v[196:199]
    ds_read_b128 v[120:123], v15 offset:41024
    ds_read_b128 v[124:127], v15 offset:61504
    v_mfma_f32_16x16x32_bf16 v[200:203], a[36:39], a[124:127], v[200:203]
    ds_read_b128 v[128:131], v15 offset:128
    ds_read_b128 v[132:135], v15 offset:20608
    s_add_u32 s44, s19, 327680
    v_mfma_f32_16x16x32_bf16 v[204:207], a[40:43], a[124:127], v[204:207]
    buffer_load_dwordx4 a[208:211], v20, s[48:51], s44 offen offset:1024 sc1
    v_mfma_f32_16x16x32_bf16 v[208:211], a[44:47], a[124:127], v[208:211]
    ds_read_b128 v[136:139], v15 offset:41088
    ds_read_b128 v[140:143], v15 offset:61568
    v_mfma_f32_16x16x32_bf16 v[212:215], a[48:51], a[124:127], v[212:215]
    ds_read_b128 v[144:147], v15 offset:192
    ds_read_b128 v[148:151], v15 offset:20672
    v_mfma_f32_16x16x32_bf16 v[216:219], a[32:35], a[12:15], v[216:219]
    ds_read_b128 v[152:155], v15 offset:41152
    ds_read_b128 v[156:159], v15 offset:61632
    s_add_u32 s44, s19, 360448
    s_add_u32 s44, s44, s99
    v_mfma_f32_16x16x32_bf16 v[220:223], a[36:39], a[12:15], v[220:223]
    buffer_load_dwordx4 a[212:215], v20, s[48:51], s44 offen offset:1024 sc1
    v_mfma_f32_16x16x32_bf16 v[224:227], a[40:43], a[12:15], v[224:227]
    ds_read_b128 v[160:163], v15 offset:256
    ds_read_b128 v[164:167], v15 offset:20736
    v_mfma_f32_16x16x32_bf16 v[228:231], a[44:47], a[12:15], v[228:231]
    ds_read_b128 v[168:171], v15 offset:41216
    ds_read_b128 v[172:175], v15 offset:61696
    v_mfma_f32_16x16x32_bf16 v[232:235], a[48:51], a[12:15], v[232:235]
    s_add_u32 s44, s19, 294912
    v_mfma_f32_16x16x32_bf16 v[236:239], a[32:35], v[68:71], v[236:239]
    buffer_load_dwordx4 a[252:255], v20, s[48:51], s44 offen offset:2048 sc1
    v_mfma_f32_16x16x32_bf16 v[240:243], a[36:39], v[68:71], v[240:243]
    s_waitcnt lgkmcnt(15)
    v_add_f32 v96, v96, v100
    v_add_f32 v97, v97, v101
    v_add_f32 v98, v98, v102
    v_mfma_f32_16x16x32_bf16 v[244:247], a[40:43], v[68:71], v[244:247]
    v_add_f32 v99, v99, v103
    v_add_f32 v104, v104, v108
    v_add_f32 v105, v105, v109
    v_add_f32 v106, v106, v110
    v_mfma_f32_16x16x32_bf16 v[248:251], a[44:47], v[68:71], v[248:251]
    v_add_f32 v107, v107, v111
    v_add_f32 v96, v96, v104
    v_add_f32 v97, v97, v105
    v_add_f32 v98, v98, v106
    s_add_u32 s44, s19, 327680
    v_mfma_f32_16x16x32_bf16 v[252:255], a[48:51], v[68:71], v[252:255]
    buffer_load_dwordx4 a[4:7], v20, s[48:51], s44 offen offset:2048 sc1
    s_waitcnt vmcnt(20)
    v_mfma_f32_16x16x32_bf16 v[176:179], a[52:55], v[72:75], v[176:179]
    v_add_f32 v99, v99, v107
    v_cvt_pk_bf16_f32 v100, v96, v97
    v_cvt_pk_bf16_f32 v101, v98, v99
    s_waitcnt lgkmcnt(12)
    v_mfma_f32_16x16x32_bf16 v[180:183], a[56:59], v[72:75], v[180:183]
    v_add_f32 v112, v112, v116
    v_add_f32 v113, v113, v117
    v_add_f32 v114, v114, v118
    v_add_f32 v115, v115, v119
    v_mfma_f32_16x16x32_bf16 v[184:187], a[60:63], v[72:75], v[184:187]
    v_add_f32 v120, v120, v124
    v_add_f32 v121, v121, v125
    v_add_f32 v122, v122, v126
    v_add_f32 v123, v123, v127
    s_add_u32 s44, s19, 360448
    s_add_u32 s44, s44, s99
    v_mfma_f32_16x16x32_bf16 v[188:191], a[64:67], v[72:75], v[188:191]
    buffer_load_dwordx4 a[8:11], v20, s[48:51], s44 offen offset:2048 sc1
    v_mfma_f32_16x16x32_bf16 v[192:195], a[68:71], v[72:75], v[192:195]
    v_add_f32 v112, v112, v120
    v_add_f32 v113, v113, v121
    v_add_f32 v114, v114, v122
    v_add_f32 v115, v115, v123
    v_mfma_f32_16x16x32_bf16 v[196:199], a[52:55], v[76:79], v[196:199]
    v_cvt_pk_bf16_f32 v102, v112, v113
    v_cvt_pk_bf16_f32 v108, v114, v115
    v_mov_b32 v103, v26
    v_mfma_f32_16x16x32_bf16 v[200:203], a[56:59], v[76:79], v[200:203]
    buffer_store_dwordx4 v[100:103], v20, s[48:51], s22 offen offset:0 sc1
    s_waitcnt lgkmcnt(8)
    v_add_f32 v128, v128, v132
    s_add_u32 s44, s19, 294912
    v_mfma_f32_16x16x32_bf16 v[204:207], a[60:63], v[76:79], v[204:207]
    buffer_load_dwordx4 a[92:95], v20, s[48:51], s44 offen offset:3072 sc1
    v_mfma_f32_16x16x32_bf16 v[208:211], a[64:67], v[76:79], v[208:211]
    v_add_f32 v129, v129, v133
    v_add_f32 v130, v130, v134
    v_add_f32 v131, v131, v135
    v_add_f32 v136, v136, v140
    v_mfma_f32_16x16x32_bf16 v[212:215], a[68:71], v[76:79], v[212:215]
    v_add_f32 v137, v137, v141
    v_add_f32 v138, v138, v142
    v_add_f32 v139, v139, v143
    v_add_f32 v128, v128, v136
    v_mfma_f32_16x16x32_bf16 v[216:219], a[52:55], v[80:83], v[216:219]
    v_add_f32 v129, v129, v137
    v_add_f32 v130, v130, v138
    v_add_f32 v131, v131, v139
    v_cvt_pk_bf16_f32 v109, v128, v129
    s_add_u32 s44, s19, 327680
    v_mfma_f32_16x16x32_bf16 v[220:223], a[56:59], v[80:83], v[220:223]
    buffer_load_dwordx4 a[96:99], v20, s[48:51], s44 offen offset:3072 sc1
    v_mfma_f32_16x16x32_bf16 v[224:227], a[60:63], v[80:83], v[224:227]
    v_cvt_pk_bf16_f32 v110, v130, v131
    v_mov_b32 v111, v26
    v_mfma_f32_16x16x32_bf16 v[228:231], a[64:67], v[80:83], v[228:231]
    buffer_store_dwordx4 v[108:111], v20, s[48:51], s22 offen offset:1024 sc1
    s_waitcnt lgkmcnt(4)
    v_add_f32 v144, v144, v148
    v_mfma_f32_16x16x32_bf16 v[232:235], a[68:71], v[80:83], v[232:235]
    v_add_f32 v145, v145, v149
    v_add_f32 v146, v146, v150
    v_add_f32 v147, v147, v151
    v_add_f32 v152, v152, v156
    s_add_u32 s44, s19, 360448
    s_add_u32 s44, s44, s99
    v_mfma_f32_16x16x32_bf16 v[236:239], a[52:55], a[100:103], v[236:239]
    buffer_load_dwordx4 v[84:87], v20, s[48:51], s44 offen offset:3072 sc1
    v_mfma_f32_16x16x32_bf16 v[240:243], a[56:59], a[100:103], v[240:243]
    v_add_f32 v153, v153, v157
    v_add_f32 v154, v154, v158
    v_add_f32 v155, v155, v159
    v_add_f32 v144, v144, v152
    v_mfma_f32_16x16x32_bf16 v[244:247], a[60:63], a[100:103], v[244:247]
    v_add_f32 v145, v145, v153
    v_add_f32 v146, v146, v154
    v_add_f32 v147, v147, v155
    v_cvt_pk_bf16_f32 v116, v144, v145
    v_mfma_f32_16x16x32_bf16 v[248:251], a[64:67], a[100:103], v[248:251]
    v_cvt_pk_bf16_f32 v117, v146, v147
    s_waitcnt lgkmcnt(0)
    v_add_f32 v160, v160, v164
    v_add_f32 v161, v161, v165
    v_mfma_f32_16x16x32_bf16 v[252:255], a[68:71], a[100:103], v[252:255]
    v_add_f32 v162, v162, v166
    v_add_f32 v163, v163, v167
    v_add_f32 v168, v168, v172
    v_add_f32 v169, v169, v173
    s_waitcnt vmcnt(22)
    v_mfma_f32_16x16x32_bf16 v[176:179], a[72:75], a[104:107], v[176:179]
    v_add_f32 v170, v170, v174
    v_add_f32 v171, v171, v175
    v_add_f32 v160, v160, v168
    v_add_f32 v161, v161, v169
    v_mfma_f32_16x16x32_bf16 v[180:183], a[76:79], a[104:107], v[180:183]
    v_add_f32 v162, v162, v170
    v_add_f32 v163, v163, v171
    v_cvt_pk_bf16_f32 v118, v160, v161
    v_cvt_pk_bf16_f32 v124, v162, v163
    v_mfma_f32_16x16x32_bf16 v[184:187], a[80:83], a[104:107], v[184:187]
    v_mov_b32 v119, v26
    v_mfma_f32_16x16x32_bf16 v[188:191], a[84:87], a[104:107], v[188:191]
    buffer_store_dwordx4 v[116:119], v20, s[48:51], s22 offen offset:2048 sc1
    v_mov_b32 v125, v26
    v_mfma_f32_16x16x32_bf16 v[192:195], a[132:135], a[104:107], v[192:195]
    buffer_store_dwordx2 v[124:125], v18, s[48:51], s22 offen offset:3072 sc1
    s_barrier
    v_mfma_f32_16x16x32_bf16 v[196:199], a[72:75], a[108:111], v[196:199]
    v_mfma_f32_16x16x32_bf16 v[200:203], a[76:79], a[108:111], v[200:203]
    v_mfma_f32_16x16x32_bf16 v[204:207], a[80:83], a[108:111], v[204:207]
    v_mfma_f32_16x16x32_bf16 v[208:211], a[84:87], a[108:111], v[208:211]
    v_mfma_f32_16x16x32_bf16 v[212:215], a[132:135], a[108:111], v[212:215]
    v_mfma_f32_16x16x32_bf16 v[216:219], a[72:75], a[112:115], v[216:219]
    v_mfma_f32_16x16x32_bf16 v[220:223], a[76:79], a[112:115], v[220:223]
    v_mfma_f32_16x16x32_bf16 v[224:227], a[80:83], a[112:115], v[224:227]
    v_mfma_f32_16x16x32_bf16 v[228:231], a[84:87], a[112:115], v[228:231]
    v_mfma_f32_16x16x32_bf16 v[232:235], a[132:135], a[112:115], v[232:235]
    v_mfma_f32_16x16x32_bf16 v[236:239], a[72:75], a[116:119], v[236:239]
    v_mfma_f32_16x16x32_bf16 v[240:243], a[76:79], a[116:119], v[240:243]
    v_mfma_f32_16x16x32_bf16 v[244:247], a[80:83], a[116:119], v[244:247]
    v_mfma_f32_16x16x32_bf16 v[248:251], a[84:87], a[116:119], v[248:251]
    v_mfma_f32_16x16x32_bf16 v[252:255], a[132:135], a[116:119], v[252:255]
    s_waitcnt vmcnt(20)
    v_mfma_f32_16x16x32_bf16 v[176:179], a[136:139], a[224:227], v[176:179]
    v_mfma_f32_16x16x32_bf16 v[180:183], a[140:143], a[224:227], v[180:183]
    v_mfma_f32_16x16x32_bf16 v[184:187], a[144:147], a[224:227], v[184:187]
    v_mfma_f32_16x16x32_bf16 v[188:191], a[148:151], a[224:227], v[188:191]
    v_mfma_f32_16x16x32_bf16 v[192:195], a[152:155], a[224:227], v[192:195]
    v_mfma_f32_16x16x32_bf16 v[196:199], a[136:139], a[228:231], v[196:199]
    v_mfma_f32_16x16x32_bf16 v[200:203], a[140:143], a[228:231], v[200:203]
    v_mfma_f32_16x16x32_bf16 v[204:207], a[144:147], a[228:231], v[204:207]
    v_mfma_f32_16x16x32_bf16 v[208:211], a[148:151], a[228:231], v[208:211]
    v_mfma_f32_16x16x32_bf16 v[212:215], a[152:155], a[228:231], v[212:215]
    v_mfma_f32_16x16x32_bf16 v[216:219], a[136:139], v[48:51], v[216:219]
    v_mfma_f32_16x16x32_bf16 v[220:223], a[140:143], v[48:51], v[220:223]
    v_mfma_f32_16x16x32_bf16 v[224:227], a[144:147], v[48:51], v[224:227]
    v_mfma_f32_16x16x32_bf16 v[228:231], a[148:151], v[48:51], v[228:231]
    v_mfma_f32_16x16x32_bf16 v[232:235], a[152:155], v[48:51], v[232:235]
    v_mfma_f32_16x16x32_bf16 v[236:239], a[136:139], v[52:55], v[236:239]
    v_mfma_f32_16x16x32_bf16 v[240:243], a[140:143], v[52:55], v[240:243]
    v_mfma_f32_16x16x32_bf16 v[244:247], a[144:147], v[52:55], v[244:247]
    v_mfma_f32_16x16x32_bf16 v[248:251], a[148:151], v[52:55], v[248:251]
    v_mfma_f32_16x16x32_bf16 v[252:255], a[152:155], v[52:55], v[252:255]
    s_waitcnt vmcnt(16)
    v_mfma_f32_16x16x32_bf16 v[176:179], a[156:159], v[56:59], v[176:179]
    v_mfma_f32_16x16x32_bf16 v[180:183], a[160:163], v[56:59], v[180:183]
    buffer_load_dwordx4 v[96:99], v20, s[48:51], s23 offen offset:0 sc1
    v_mfma_f32_16x16x32_bf16 v[184:187], a[164:167], v[56:59], v[184:187]
    v_mfma_f32_16x16x32_bf16 v[188:191], a[168:171], v[56:59], v[188:191]
    v_mfma_f32_16x16x32_bf16 v[192:195], a[172:175], v[56:59], v[192:195]
    v_mfma_f32_16x16x32_bf16 v[196:199], a[156:159], v[60:63], v[196:199]
    v_mfma_f32_16x16x32_bf16 v[200:203], a[160:163], v[60:63], v[200:203]
    v_mfma_f32_16x16x32_bf16 v[204:207], a[164:167], v[60:63], v[204:207]
    buffer_load_dwordx4 v[100:103], v20, s[48:51], s23 offen offset:1024 sc1
    v_mfma_f32_16x16x32_bf16 v[208:211], a[168:171], v[60:63], v[208:211]
    v_mfma_f32_16x16x32_bf16 v[212:215], a[172:175], v[60:63], v[212:215]
    v_mfma_f32_16x16x32_bf16 v[216:219], a[156:159], v[64:67], v[216:219]
    v_mfma_f32_16x16x32_bf16 v[220:223], a[160:163], v[64:67], v[220:223]
    v_mfma_f32_16x16x32_bf16 v[224:227], a[164:167], v[64:67], v[224:227]
    v_mfma_f32_16x16x32_bf16 v[228:231], a[168:171], v[64:67], v[228:231]
    buffer_load_dwordx4 v[104:107], v20, s[48:51], s23 offen offset:2048 sc1
    v_mfma_f32_16x16x32_bf16 v[232:235], a[172:175], v[64:67], v[232:235]
    v_mfma_f32_16x16x32_bf16 v[236:239], a[156:159], a[232:235], v[236:239]
    v_mfma_f32_16x16x32_bf16 v[240:243], a[160:163], a[232:235], v[240:243]
    v_mfma_f32_16x16x32_bf16 v[244:247], a[164:167], a[232:235], v[244:247]
    v_mfma_f32_16x16x32_bf16 v[248:251], a[168:171], a[232:235], v[248:251]
    v_mfma_f32_16x16x32_bf16 v[252:255], a[172:175], a[232:235], v[252:255]
    buffer_load_dwordx2 v[108:109], v18, s[48:51], s23 offen offset:3072 sc1
    s_waitcnt vmcnt(17)
    v_mfma_f32_16x16x32_bf16 v[176:179], a[176:179], a[236:239], v[176:179]
    v_mfma_f32_16x16x32_bf16 v[180:183], a[180:183], a[236:239], v[180:183]
    v_mfma_f32_16x16x32_bf16 v[184:187], a[184:187], a[236:239], v[184:187]
    v_mfma_f32_16x16x32_bf16 v[188:191], a[188:191], a[236:239], v[188:191]
    v_mfma_f32_16x16x32_bf16 v[192:195], a[192:195], a[236:239], v[192:195]
    v_mfma_f32_16x16x32_bf16 v[176:179], a[196:199], a[240:243], v[176:179]
    v_mfma_f32_16x16x32_bf16 v[180:183], a[200:203], a[240:243], v[180:183]
    v_mfma_f32_16x16x32_bf16 v[184:187], a[204:207], a[240:243], v[184:187]
    v_mfma_f32_16x16x32_bf16 v[188:191], v[88:91], a[240:243], v[188:191]
    v_mfma_f32_16x16x32_bf16 v[192:195], v[92:95], a[240:243], v[192:195]
    v_mfma_f32_16x16x32_bf16 v[176:179], a[88:91], a[244:247], v[176:179]
    v_mfma_f32_16x16x32_bf16 v[180:183], a[128:131], a[244:247], v[180:183]
    v_mfma_f32_16x16x32_bf16 v[184:187], a[216:219], a[244:247], v[184:187]
    v_mfma_f32_16x16x32_bf16 v[188:191], a[220:223], a[244:247], v[188:191]
    v_mfma_f32_16x16x32_bf16 v[192:195], a[0:3], a[244:247], v[192:195]
    s_waitcnt vmcnt(14)
    v_mfma_f32_16x16x32_bf16 v[196:199], a[176:179], a[248:251], v[196:199]
    v_mfma_f32_16x16x32_bf16 v[200:203], a[180:183], a[248:251], v[200:203]
    v_mfma_f32_16x16x32_bf16 v[204:207], a[184:187], a[248:251], v[204:207]
    ds_write_b128 v17, v[176:179] offset:0
    v_mfma_f32_16x16x32_bf16 v[208:211], a[188:191], a[248:251], v[208:211]
    v_mfma_f32_16x16x32_bf16 v[212:215], a[192:195], a[248:251], v[212:215]
    v_mfma_f32_16x16x32_bf16 v[196:199], a[196:199], a[208:211], v[196:199]
    ds_write_b128 v17, v[180:183] offset:64
    v_mfma_f32_16x16x32_bf16 v[200:203], a[200:203], a[208:211], v[200:203]
    v_mfma_f32_16x16x32_bf16 v[204:207], a[204:207], a[208:211], v[204:207]
    v_mfma_f32_16x16x32_bf16 v[208:211], v[88:91], a[208:211], v[208:211]
    ds_write_b128 v17, v[184:187] offset:128
    v_mfma_f32_16x16x32_bf16 v[212:215], v[92:95], a[208:211], v[212:215]
    v_mfma_f32_16x16x32_bf16 v[196:199], a[88:91], a[212:215], v[196:199]
    v_mfma_f32_16x16x32_bf16 v[200:203], a[128:131], a[212:215], v[200:203]
    ds_write_b128 v17, v[188:191] offset:192
    v_mfma_f32_16x16x32_bf16 v[204:207], a[216:219], a[212:215], v[204:207]
    v_mfma_f32_16x16x32_bf16 v[208:211], a[220:223], a[212:215], v[208:211]
    v_mfma_f32_16x16x32_bf16 v[212:215], a[0:3], a[212:215], v[212:215]
    ds_write_b128 v17, v[192:195] offset:256
    s_waitcnt vmcnt(11)
    v_mfma_f32_16x16x32_bf16 v[216:219], a[176:179], a[252:255], v[216:219]
    s_waitcnt vmcnt(0)
    v_bitop3_b32 v99, v99, v103, v26 bitop3:0x7e
    v_mfma_f32_16x16x32_bf16 v[220:223], a[180:183], a[252:255], v[220:223]
    v_bitop3_b32 v107, v107, v109, v26 bitop3:0x7e
    v_or_b32 v99, v99, v107
    v_mfma_f32_16x16x32_bf16 v[224:227], a[184:187], a[252:255], v[224:227]
    ds_write_b128 v17, v[196:199] offset:5120
    v_mfma_f32_16x16x32_bf16 v[228:231], a[188:191], a[252:255], v[228:231]
    v_cmp_ne_u32 vcc, 0, v99
    s_nop 1
    s_cmp_lg_u64 vcc, 0
    s_cbranch_scc1 L_slow_22
L_ok_23:
    v_mfma_f32_16x16x32_bf16 v[232:235], a[192:195], a[252:255], v[232:235]
    v_lshlrev_b32 v8, 16, v96
    v_and_b32 v9, 0xffff0000, v96
    v_mfma_f32_16x16x32_bf16 v[216:219], a[196:199], a[4:7], v[216:219]
    ds_write_b128 v17, v[200:203] offset:5184
    v_mfma_f32_16x16x32_bf16 v[220:223], a[200:203], a[4:7], v[220:223]
    v_add_f32 v28, v28, v8
    v_add_f32 v29, v29, v9
    v_mfma_f32_16x16x32_bf16 v[224:227], a[204:207], a[4:7], v[224:227]
    v_lshlrev_b32 v8, 16, v97
    v_and_b32 v9, 0xffff0000, v97
    v_mfma_f32_16x16x32_bf16 v[228:231], v[88:91], a[4:7], v[228:231]
    ds_write_b128 v17, v[204:207] offset:5248
    v_mfma_f32_16x16x32_bf16 v[232:235], v[92:95], a[4:7], v[232:235]
    v_add_f32 v30, v30, v8
    v_add_f32 v31, v31, v9
    v_mfma_f32_16x16x32_bf16 v[216:219], a[88:91], a[8:11], v[216:219]
    v_lshlrev_b32 v8, 16, v98
    v_and_b32 v9, 0xffff0000, v98
    v_mfma_f32_16x16x32_bf16 v[220:223], a[128:131], a[8:11], v[220:223]
    ds_write_b128 v17, v[208:211] offset:5312
    v_mfma_f32_16x16x32_bf16 v[224:227], a[216:219], a[8:11], v[224:227]
    v_add_f32 v32, v32, v8
    v_add_f32 v33, v33, v9
    v_mfma_f32_16x16x32_bf16 v[228:231], a[220:223], a[8:11], v[228:231]
    v_lshlrev_b32 v8, 16, v100
    v_and_b32 v9, 0xffff0000, v100
    v_mfma_f32_16x16x32_bf16 v[232:235], a[0:3], a[8:11], v[232:235]
    ds_write_b128 v17, v[212:215] offset:5376
    v_mfma_f32_16x16x32_bf16 v[236:239], a[176:179], a[92:95], v[236:239]
    v_add_f32 v34, v34, v8
    v_add_f32 v35, v35, v9
    v_mfma_f32_16x16x32_bf16 v[240:243], a[180:183], a[92:95], v[240:243]
    v_lshlrev_b32 v8, 16, v101
    v_and_b32 v9, 0xffff0000, v101
    v_mfma_f32_16x16x32_bf16 v[244:247], a[184:187], a[92:95], v[244:247]
    ds_write_b128 v17, v[216:219] offset:10240
    v_mfma_f32_16x16x32_bf16 v[248:251], a[188:191], a[92:95], v[248:251]
    v_add_f32 v36, v36, v8
    v_add_f32 v37, v37, v9
    v_mfma_f32_16x16x32_bf16 v[252:255], a[192:195], a[92:95], v[252:255]
    v_lshlrev_b32 v8, 16, v102
    v_and_b32 v9, 0xffff0000, v102
    v_mfma_f32_16x16x32_bf16 v[236:239], a[196:199], a[96:99], v[236:239]
    ds_write_b128 v17, v[220:223] offset:10304
    v_mfma_f32_16x16x32_bf16 v[240:243], a[200:203], a[96:99], v[240:243]
    v_add_f32 v38, v38, v8
    v_add_f32 v39, v39, v9
    v_mfma_f32_16x16x32_bf16 v[244:247], a[204:207], a[96:99], v[244:247]
    v_lshlrev_b32 v8, 16, v104
    v_and_b32 v9, 0xffff0000, v104
    v_mfma_f32_16x16x32_bf16 v[248:251], v[88:91], a[96:99], v[248:251]
    ds_write_b128 v17, v[224:227] offset:10368
    v_mfma_f32_16x16x32_bf16 v[252:255], v[92:95], a[96:99], v[252:255]
    v_add_f32 v40, v40, v8
    v_add_f32 v41, v41, v9
    v_mfma_f32_16x16x32_bf16 v[236:239], a[88:91], v[84:87], v[236:239]
    v_lshlrev_b32 v8, 16, v105
    v_and_b32 v9, 0xffff0000, v105
    v_mfma_f32_16x16x32_bf16 v[240:243], a[128:131], v[84:87], v[240:243]
    ds_write_b128 v17, v[228:231] offset:10432
    v_mfma_f32_16x16x32_bf16 v[244:247], a[216:219], v[84:87], v[244:247]
    v_add_f32 v42, v42, v8
    v_add_f32 v43, v43, v9
    v_mfma_f32_16x16x32_bf16 v[248:251], a[220:223], v[84:87], v[248:251]
    v_lshlrev_b32 v8, 16, v106
    v_and_b32 v9, 0xffff0000, v106
    v_mfma_f32_16x16x32_bf16 v[252:255], a[0:3], v[84:87], v[252:255]
    ds_write_b128 v17, v[232:235] offset:10496
    s_nop 7
    ds_write_b128 v17, v[236:239] offset:15360
    ds_write_b128 v17, v[240:243] offset:15424
    ds_write_b128 v17, v[244:247] offset:15488
    ds_write_b128 v17, v[248:251] offset:15552
    ds_write_b128 v17, v[252:255] offset:15616
    v_add_f32 v44, v44, v8
    v_add_f32 v45, v45, v9
    v_lshlrev_b32 v8, 16, v108
    v_and_b32 v9, 0xffff0000, v108
    v_add_f32 v46, v46, v8
    v_add_f32 v47, v47, v9
    s_waitcnt lgkmcnt(0)
    s_barrier
    ds_read_b128 v[176:179], v15 offset:0
    ds_read_b128 v[180:183], v15 offset:20480
    ds_read_b128 v[184:187], v15 offset:40960
    ds_read_b128 v[188:191], v15 offset:61440
    ds_read_b128 v[192:195], v15 offset:64
    ds_read_b128 v[196:199], v15 offset:20544
    ds_read_b128 v[200:203], v15 offset:41024
    ds_read_b128 v[204:207], v15 offset:61504
    ds_read_b128 v[208:211], v15 offset:128
    ds_read_b128 v[212:215], v15 offset:20608
    ds_read_b128 v[216:219], v15 offset:41088
    ds_read_b128 v[220:223], v15 offset:61568
    s_waitcnt lgkmcnt(8)
    v_pk_add_f32 v[176:177], v[176:177], v[180:181]
    v_pk_add_f32 v[184:185], v[184:185], v[188:189]
    v_pk_add_f32 v[178:179], v[178:179], v[182:183]
    v_pk_add_f32 v[186:187], v[186:187], v[190:191]
    v_pk_add_f32 v[28:29], v[28:29], v[176:177]
    v_pk_add_f32 v[30:31], v[30:31], v[178:179]
    v_pk_add_f32 v[28:29], v[28:29], v[184:185]
    v_pk_add_f32 v[30:31], v[30:31], v[186:187]
    buffer_store_dwordx4 v[28:31], v16, s[52:55], s21 offen offset:0 nt
    ds_read_b128 v[224:227], v15 offset:192
    ds_read_b128 v[228:231], v15 offset:20672
    ds_read_b128 v[232:235], v15 offset:41152
    ds_read_b128 v[236:239], v15 offset:61632
    s_waitcnt lgkmcnt(8)
    v_pk_add_f32 v[192:193], v[192:193], v[196:197]
    v_pk_add_f32 v[200:201], v[200:201], v[204:205]
    v_pk_add_f32 v[194:195], v[194:195], v[198:199]
    v_pk_add_f32 v[202:203], v[202:203], v[206:207]
    v_pk_add_f32 v[32:33], v[32:33], v[192:193]
    v_pk_add_f32 v[34:35], v[34:35], v[194:195]
    v_pk_add_f32 v[32:33], v[32:33], v[200:201]
    v_pk_add_f32 v[34:35], v[34:35], v[202:203]
    buffer_store_dwordx4 v[32:35], v16, s[52:55], s21 offen offset:64 nt
    ds_read_b128 v[240:243], v15 offset:256
    ds_read_b128 v[244:247], v15 offset:20736
    ds_read_b128 v[248:251], v15 offset:41216
    ds_read_b128 v[252:255], v15 offset:61696
    s_waitcnt lgkmcnt(8)
    v_pk_add_f32 v[208:209], v[208:209], v[212:213]
    v_pk_add_f32 v[216:217], v[216:217], v[220:221]
    v_pk_add_f32 v[210:211], v[210:211], v[214:215]
    v_pk_add_f32 v[218:219], v[218:219], v[222:223]
    v_pk_add_f32 v[36:37], v[36:37], v[208:209]
    v_pk_add_f32 v[38:39], v[38:39], v[210:211]
    v_pk_add_f32 v[36:37], v[36:37], v[216:217]
    v_pk_add_f32 v[38:39], v[38:39], v[218:219]
    buffer_store_dwordx4 v[36:39], v16, s[52:55], s21 offen offset:128 nt
    s_waitcnt lgkmcnt(4)
    v_pk_add_f32 v[224:225], v[224:225], v[228:229]
    v_pk_add_f32 v[232:233], v[232:233], v[236:237]
    v_pk_add_f32 v[226:227], v[226:227], v[230:231]
    v_pk_add_f32 v[234:235], v[234:235], v[238:239]
    v_pk_add_f32 v[40:41], v[40:41], v[224:225]
    v_pk_add_f32 v[42:43], v[42:43], v[226:227]
    v_pk_add_f32 v[40:41], v[40:41], v[232:233]
    v_pk_add_f32 v[42:43], v[42:43], v[234:235]
    buffer_store_dwordx4 v[40:43], v16, s[52:55], s21 offen offset:192 nt
    s_waitcnt lgkmcnt(0)
    v_pk_add_f32 v[240:241], v[240:241], v[244:245]
    v_pk_add_f32 v[248:249], v[248:249], v[252:253]
    v_pk_add_f32 v[242:243], v[242:243], v[246:247]
    v_pk_add_f32 v[250:251], v[250:251], v[254:255]
    v_pk_add_f32 v[44:45], v[44:45], v[240:241]
    v_pk_add_f32 v[46:47], v[46:47], v[242:243]
    v_pk_add_f32 v[44:45], v[44:45], v[248:249]
    v_pk_add_f32 v[46:47], v[46:47], v[250:251]
    buffer_store_dwordx4 v[44:47], v16, s[52:55], s21 offen offset:256 nt
    s_endpgm
L_typeB:
    buffer_load_dwordx4 v[168:171], v20, s[60:63], s91 offen
    buffer_load_dword v172, v250, s[60:63], s91 offen offset:1024
    s_add_u32 s91, s91, 40960
    buffer_load_dwordx4 v[174:177], v20, s[60:63], s91 offen
    buffer_load_dword v178, v250, s[60:63], s91 offen offset:1024
    s_lshl_b32 s14, s6, 6
    s_mov_b32 s72, s18
    s_mov_b32 s73, s19
    s_mov_b32 s74, 1280
    s_mov_b32 s75, 0x00020000
    buffer_load_ushort v60, v141, s[72:75], s14 offen
    buffer_load_ushort v64, v141, s[72:75], s14 offen offset:64
    s_mov_b32 s72, s20
    s_mov_b32 s73, s21
    s_mov_b32 s74, 1280
    s_mov_b32 s75, 0x00020000
    buffer_load_ushort v61, v141, s[72:75], s14 offen
    buffer_load_ushort v65, v141, s[72:75], s14 offen offset:64
    s_mov_b32 s72, s30
    s_mov_b32 s73, s31
    s_mov_b32 s74, 1280
    s_mov_b32 s75, 0x00020000
    buffer_load_ushort v62, v141, s[72:75], s14 offen
    buffer_load_ushort v66, v141, s[72:75], s14 offen offset:64
    s_bitcmp1_b32 s4, 2
    s_cselect_b32 s72, s38, s36
    s_cselect_b32 s73, s39, s37
    s_mov_b32 s74, 2211840
    s_mov_b32 s75, 0x00020000
    s_mov_b32 s0, s89
    s_mov_b32 s1, s90
    s_add_u32 m0, s82, 98304
    s_add_u32 s83, s83, 128
    buffer_load_dwordx4 v3, s[64:67], s83 offen offset:0 lds
    buffer_load_dwordx4 v4, s[64:67], s83 offen offset:1024 lds
    buffer_load_dwordx4 v5, s[64:67], s83 offen offset:2048 lds
    buffer_load_dwordx4 v6, s[64:67], s83 offen offset:3072 lds
    s_lshl_b32 s84, s2, 2
    s_add_u32 s84, s84, s3
    s_cmp_ge_u32 s84, 540
    s_cbranch_scc1 L_rt_c_25
    s_mul_i32 s85, s84, 6554
    s_lshr_b32 s85, s85, 16
    s_mul_i32 s86, s85, 10
    s_sub_u32 s86, s84, s86
    s_mov_b32 s68, s40
    s_mov_b32 s69, s41
    s_mov_b32 s70, 2211840
    s_mov_b32 s71, 0x00020000
    s_mul_i32 s40, s85, 40960
    s_lshl_b32 s14, s86, 7
    s_add_u32 s40, s40, s14
    s_mov_b32 s41, 9216
    v_lshrrev_b32 v208, 5, v1
    v_bfe_u32 v192, v1, 4, 1
    v_lshlrev_b32 v192, 2, v192
    v_lshl_add_u32 v208, v208, 4, v192
    v_bfe_u32 v192, v1, 2, 2
    v_add_u32 v208, v208, v192
    v_lshlrev_b32 v208, 7, v208
    v_and_b32 v192, 3, v1
    v_lshl_add_u32 v208, v192, 3, v208
    s_cmp_lt_u32 s85, 22
    s_cselect_b32 s14, 20, 40
    s_add_u32 s85, s85, s14
    s_mul_i32 s85, s85, 5120
    s_add_u32 s85, s85, 20971520
    s_lshl_b32 s14, s86, 2
    s_add_u32 s14, s14, 0
    s_mul_i32 s87, s14, 13108
    s_lshr_b32 s87, s87, 16
    s_mul_i32 s87, s87, 476160
    s_lshl_b32 s14, s14, 10
    s_add_u32 s14, s14, s87
    s_add_u32 s36, s14, s85
    s_lshl_b32 s14, s86, 2
    s_add_u32 s14, s14, 1
    s_mul_i32 s87, s14, 13108
    s_lshr_b32 s87, s87, 16
    s_mul_i32 s87, s87, 476160
    s_lshl_b32 s14, s14, 10
    s_add_u32 s14, s14, s87
    s_add_u32 s37, s14, s85
    s_lshl_b32 s14, s86, 2
    s_add_u32 s14, s14, 2
    s_mul_i32 s87, s14, 13108
    s_lshr_b32 s87, s87, 16
    s_mul_i32 s87, s87, 476160
    s_lshl_b32 s14, s14, 10
    s_add_u32 s14, s14, s87
    s_add_u32 s38, s14, s85
    s_lshl_b32 s14, s86, 2
    s_add_u32 s14, s14, 3
    s_mul_i32 s87, s14, 13108
    s_lshr_b32 s87, s87, 16
    s_mul_i32 s87, s87, 476160
    s_lshl_b32 s14, s14, 10
    s_add_u32 s14, s14, s87
    s_add_u32 s39, s14, s85
    s_branch L_rt_done_26
L_rt_c_25:
    s_sub_u32 s84, s84, 540
    s_cmp_ge_u32 s84, 200
    s_cselect_b32 s85, 1, 0
    s_cselect_b32 s68, s28, s26
    s_cselect_b32 s69, s29, s27
    s_mov_b32 s70, 819200
    s_mov_b32 s71, 0x00020000
    s_mul_i32 s14, s85, 200
    s_sub_u32 s84, s84, s14
    s_mul_i32 s86, s84, 13108
    s_lshr_b32 s86, s86, 16
    s_mul_i32 s14, s86, 5
    s_sub_u32 s87, s84, s14
    s_mul_i32 s40, s86, 20480
    s_lshl_b32 s14, s87, 8
    s_add_u32 s40, s40, s14
    s_mov_b32 s41, 4096
    v_lshrrev_b32 v192, 4, v1
    v_and_b32 v193, 15, v1
    v_mul_u32_u24 v209, 1280, v192
    v_lshlrev_b32 v194, 2, v192
    v_xor_b32 v194, v194, v193
    v_lshl_add_u32 v209, v194, 4, v209
    v_lshlrev_b32 v192, 4, v192
    v_lshl_add_u32 v208, v193, 8, v192
    v_and_b32 v194, 3, v1
    v_lshl_add_u32 v208, v194, 6, v208
    s_mul_i32 s84, s86, 13108
    s_lshr_b32 s84, s84, 16
    s_mul_i32 s84, s84, 476160
    s_lshl_b32 s14, s86, 10
    s_add_u32 s84, s84, s14
    s_lshl_b32 s14, s87, 3
    s_add_u32 s14, s14, s85
    s_mul_i32 s14, s14, 5120
    s_add_u32 s84, s84, s14
    s_cmp_ge_u32 s86, 40
    s_cselect_b32 s14, 1073741824, 20971520
    s_add_u32 s84, s84, s14
    s_cmp_ge_u32 s87, 3
    s_cselect_b32 s14, 112640, 0
    s_add_u32 s36, s84, s14
    s_add_u32 s37, s36, 10240
    s_cmp_ge_u32 s87, 2
    s_cselect_b32 s14, 112640, 0
    s_add_u32 s38, s84, s14
    s_add_u32 s38, s38, 20480
    s_add_u32 s39, s38, 10240
L_rt_done_26:
    s_add_u32 s14, s82, 65536
    v_add_u32 v208, s14, v208
    s_waitcnt vmcnt(25)
    v_lshlrev_b32 v96, 16, v116
    v_and_b32 v97, 0xffff0000, v116
    v_lshlrev_b32 v98, 16, v117
    v_and_b32 v99, 0xffff0000, v117
    v_lshlrev_b32 v100, 16, v118
    v_and_b32 v101, 0xffff0000, v118
    v_lshlrev_b32 v102, 16, v119
    v_and_b32 v103, 0xffff0000, v119
    v_lshlrev_b32 v104, 16, v120
    v_and_b32 v105, 0xffff0000, v120
    v_lshlrev_b32 v106, 16, v121
    v_and_b32 v107, 0xffff0000, v121
    v_lshlrev_b32 v108, 16, v122
    v_and_b32 v109, 0xffff0000, v122
    v_lshlrev_b32 v110, 16, v123
    v_and_b32 v111, 0xffff0000, v123
    v_lshlrev_b32 v112, 16, v124
    v_and_b32 v113, 0xffff0000, v124
    v_lshlrev_b32 v114, 16, v125
    v_and_b32 v115, 0xffff0000, v125
    v_pk_add_f32 v[128:129], v[96:97], v[98:99]
    v_pk_add_f32 v[130:131], v[100:101], v[102:103]
    v_pk_add_f32 v[128:129], v[128:129], v[104:105]
    v_pk_add_f32 v[130:131], v[130:131], v[106:107]
    v_pk_add_f32 v[128:129], v[128:129], v[108:109]
    v_pk_add_f32 v[130:131], v[130:131], v[110:111]
    v_pk_add_f32 v[128:129], v[128:129], v[112:113]
    v_pk_add_f32 v[130:131], v[130:131], v[114:115]
    v_pk_add_f32 v[128:129], v[128:129], v[130:131]
    v_add_f32 v128, v128, v129
    s_nop 1
    v_add_f32_dpp v128, v128, v128 row_ror:8 row_mask:0xf bank_mask:0xf
    s_nop 1
    v_add_f32_dpp v128, v128, v128 row_ror:4 row_mask:0xf bank_mask:0xf
    s_nop 1
    v_add_f32_dpp v128, v128, v128 row_ror:2 row_mask:0xf bank_mask:0xf
    s_nop 1
    v_add_f32_dpp v128, v128, v128 row_ror:1 row_mask:0xf bank_mask:0xf
    v_mov_b32 v129, v128
    s_nop 1
    v_permlane16_swap_b32 v128, v129
    s_nop 0
    v_add_f32 v128, v128, v129
    v_mul_f32 v128, 0xbacccccd, v128
    v_pk_add_f32 v[96:97], v[96:97], v[128:129] op_sel_hi:[1,0]
    v_pk_add_f32 v[98:99], v[98:99], v[128:129] op_sel_hi:[1,0]
    v_pk_add_f32 v[100:101], v[100:101], v[128:129] op_sel_hi:[1,0]
    v_pk_add_f32 v[102:103], v[102:103], v[128:129] op_sel_hi:[1,0]
    v_pk_add_f32 v[104:105], v[104:105], v[128:129] op_sel_hi:[1,0]
    v_pk_add_f32 v[106:107], v[106:107], v[128:129] op_sel_hi:[1,0]
    v_pk_add_f32 v[108:109], v[108:109], v[128:129] op_sel_hi:[1,0]
    v_pk_add_f32 v[110:111], v[110:111], v[128:129] op_sel_hi:[1,0]
    v_pk_add_f32 v[112:113], v[112:113], v[128:129] op_sel_hi:[1,0]
    v_pk_add_f32 v[114:115], v[114:115], v[128:129] op_sel_hi:[1,0]
    v_pk_mul_f32 v[130:131], v[96:97], v[96:97]
    v_pk_mul_f32 v[132:133], v[98:99], v[98:99]
    v_pk_fma_f32 v[130:131], v[100:101], v[100:101], v[130:131]
    v_pk_fma_f32 v[132:133], v[102:103], v[102:103], v[132:133]
    v_pk_fma_f32 v[130:131], v[104:105], v[104:105], v[130:131]
    v_pk_fma_f32 v[132:133], v[106:107], v[106:107], v[132:133]
    v_pk_fma_f32 v[130:131], v[108:109], v[108:109], v[130:131]
    v_pk_fma_f32 v[132:133], v[110:111], v[110:111], v[132:133]
    v_pk_fma_f32 v[130:131], v[112:113], v[112:113], v[130:131]
    v_pk_fma_f32 v[132:133], v[114:115], v[114:115], v[132:133]
    v_pk_add_f32 v[130:131], v[130:131], v[132:133]
    v_add_f32 v130, v130, v131
    s_nop 1
    v_add_f32_dpp v130, v130, v130 row_ror:8 row_mask:0xf bank_mask:0xf
    s_nop 1
    v_add_f32_dpp v130, v130, v130 row_ror:4 row_mask:0xf bank_mask:0xf
    s_nop 1
    v_add_f32_dpp v130, v130, v130 row_ror:2 row_mask:0xf bank_mask:0xf
    s_nop 1
    v_add_f32_dpp v130, v130, v130 row_ror:1 row_mask:0xf bank_mask:0xf
    v_mov_b32 v131, v130
    s_nop 1
    v_permlane16_swap_b32 v130, v131
    s_nop 0
    v_add_f32 v130, v130, v131
    v_mul_f32 v130, 0x3acccccd, v130
    v_cvt_pk_bf16_f32 v130, v130, v130
    v_lshlrev_b32 v130, 16, v130
    v_add_f32 v130, 0x3727c5ac, v130
    v_cvt_pk_bf16_f32 v130, v130, v130
    v_lshlrev_b32 v130, 16, v130
    v_sqrt_f32 v130, v130
    s_waitcnt vmcnt(23)
    v_lshl_add_u32 v26, v142, 1, v26
    v_add_u32 v26, 2654435769, v26
    v_and_b32 v26, 0xbfffbfff, v26
    v_mov_b32 v129, v26
    v_cvt_pk_bf16_f32 v128, v128, v130
    buffer_store_dwordx2 v[128:129], v139, s[48:51], 0 offen sc1
    s_add_u32 m0, s82, 16384
    s_add_u32 s10, s10, 256
    buffer_load_dwordx4 v3, s[60:63], s10 offen offset:0 lds
    buffer_load_dwordx4 v4, s[60:63], s10 offen offset:1024 lds
    buffer_load_dwordx4 v5, s[60:63], s10 offen offset:2048 lds
    buffer_load_dwordx4 v6, s[60:63], s10 offen offset:3072 lds
    s_waitcnt vmcnt(15)
    s_mov_b32 s14, 0x3f803f80
    v_dot2_f32_bf16 v173, v168, s14, 0
    v_dot2_f32_bf16 v179, v174, s14, 0
    v_dot2_f32_bf16 v173, v169, s14, v173
    v_dot2_f32_bf16 v179, v175, s14, v179
    v_dot2_f32_bf16 v173, v170, s14, v173
    v_dot2_f32_bf16 v179, v176, s14, v179
    v_dot2_f32_bf16 v173, v171, s14, v173
    v_dot2_f32_bf16 v179, v177, s14, v179
    v_dot2_f32_bf16 v173, v172, s14, v173
    v_dot2_f32_bf16 v179, v178, s14, v179
    s_nop 1
    s_nop 1
    v_add_f32_dpp v173, v173, v173 row_ror:8 row_mask:0xf bank_mask:0xf
    v_add_f32_dpp v179, v179, v179 row_ror:8 row_mask:0xf bank_mask:0xf
    s_nop 1
    v_add_f32_dpp v173, v173, v173 row_ror:4 row_mask:0xf bank_mask:0xf
    v_add_f32_dpp v179, v179, v179 row_ror:4 row_mask:0xf bank_mask:0xf
    s_nop 1
    v_add_f32_dpp v173, v173, v173 row_ror:2 row_mask:0xf bank_mask:0xf
    v_add_f32_dpp v179, v179, v179 row_ror:2 row_mask:0xf bank_mask:0xf
    s_nop 1
    v_add_f32_dpp v173, v173, v173 row_ror:1 row_mask:0xf bank_mask:0xf
    v_add_f32_dpp v179, v179, v179 row_ror:1 row_mask:0xf bank_mask:0xf
    v_cvt_pk_bf16_f32 v170, v173, v173
    v_lshlrev_b32 v170, 16, v170
    v_sub_f32 v173, v173, v170
    v_cvt_pk_bf16_f32 v168, v170, v173
    v_mov_b32 v169, v26
    buffer_store_dwordx2 v[168:169], v140, s[48:51], s92 offen offset:0 sc1
    v_cvt_pk_bf16_f32 v176, v179, v179
    v_lshlrev_b32 v176, 16, v176
    v_sub_f32 v179, v179, v176
    v_cvt_pk_bf16_f32 v174, v176, v179
    v_mov_b32 v175, v26
    buffer_store_dwordx2 v[174:175], v140, s[48:51], s92 offen offset:2048 sc1
    s_add_u32 m0, s82, 114688
    s_add_u32 s83, s83, 128
    buffer_load_dwordx4 v3, s[64:67], s83 offen offset:0 lds
    buffer_load_dwordx4 v4, s[64:67], s83 offen offset:1024 lds
    buffer_load_dwordx4 v5, s[64:67], s83 offen offset:2048 lds
    buffer_load_dwordx4 v6, s[64:67], s83 offen offset:3072 lds
    s_add_u32 m0, s82, 131072
    s_add_u32 s83, s83, 128
    buffer_load_dwordx4 v3, s[64:67], s83 offen offset:0 lds
    buffer_load_dwordx4 v4, s[64:67], s83 offen offset:1024 lds
    buffer_load_dwordx4 v5, s[64:67], s83 offen offset:2048 lds
    buffer_load_dwordx4 v6, s[64:67], s83 offen offset:3072 lds
    s_barrier
    ds_read_b128 a[160:163], v15 offset:0
    ds_read_b128 a[164:167], v15 offset:4096
    ds_read_b128 a[168:171], v16 offset:0
    ds_read_b128 a[172:175], v16 offset:4096
    ds_read_b128 a[0:3], v252 offset:0
    ds_read_b128 a[4:7], v253 offset:0
    ds_read_b128 a[176:179], v17 offset:0
    ds_read_b128 a[180:183], v17 offset:4096
    ds_read_b128 a[184:187], v18 offset:0
    ds_read_b128 a[188:191], v18 offset:4096
    ds_read_b128 a[8:11], v254 offset:0
    ds_read_b128 a[12:15], v255 offset:0
    s_waitcnt lgkmcnt(6)
    v_mfma_f32_32x32x16_bf16 v[96:111], a[0:3], a[160:163], 0
    s_add_u32 m0, s82, 32768
    s_add_u32 s10, s10, 256
    ds_read_b128 a[192:195], v15 offset:8192
    buffer_load_dwordx4 v3, s[60:63], s10 offen offset:0 lds
    s_lshl_b32 s80, s2, 7
    s_add_u32 s80, s80, 131072
    s_cmp_lg_u32 s3, 0
    s_cselect_b32 s80, 1073741824, s80
    v_mov_b32 v92, 1073741824
    v_writelane_b32 v92, s80, 0
    v_mfma_f32_32x32x16_bf16 v[112:127], a[0:3], a[164:167], 0
    ds_read_b128 a[196:199], v15 offset:12288
    s_waitcnt vmcnt(16)
    ds_read_b128 a[16:19], v252 offset:16384
    buffer_load_dwordx4 v4, s[60:63], s10 offen offset:1024 lds
    s_or_b32 s80, s2, s3
    s_cselect_b32 s80, 1073741824, 26214400
    v_mov_b32 v94, 1073741824
    v_writelane_b32 v94, s80, 0
    s_lshl_b32 s80, s3, 13
    s_add_u32 s80, s80, 131072
    v_lshl_add_u32 v91, v1, 7, s80
    v_mfma_f32_32x32x16_bf16 v[96:111], a[4:7], a[168:171], v[96:111]
    ds_read_b128 a[200:203], v16 offset:8192
    buffer_load_dwordx4 v5, s[60:63], s10 offen offset:2048 lds
    v_lshlrev_b32 v62, 16, v62
    v_mul_f32 v62, 1069066811, v62
    v_exp_f32 v62, v62
    v_lshlrev_b32 v60, 16, v60
    v_lshlrev_b32 v61, 16, v61
    v_cvt_pk_bf16_f32 v62, v62, v62
    v_lshlrev_b32 v62, 16, v62
    v_mul_f32 v68, v62, v60
    v_mfma_f32_32x32x16_bf16 v[112:127], a[4:7], a[172:175], v[112:127]
    ds_read_b128 a[204:207], v16 offset:12288
    ds_read_b128 a[20:23], v253 offset:16384
    buffer_load_dwordx4 v6, s[60:63], s10 offen offset:3072 lds
    v_mul_f32 v69, v62, v61
    v_mul_f32 v68, 1069066811, v68
    v_mul_f32 v69, 0.15915494, v69
    v_exp_f32 v68, v68
    v_fract_f32 v69, v69
    s_waitcnt lgkmcnt(6)
    v_mfma_f32_32x32x16_bf16 v[96:111], a[8:11], a[176:179], v[96:111]
    s_add_u32 m0, s82, 81920
    s_add_u32 s83, s83, 128
    ds_read_b128 a[160:163], v17 offset:8192
    buffer_load_dwordx4 v3, s[64:67], s83 offen offset:0 lds
    buffer_load_dwordx4 v[212:215], v248, s[72:75], s0 offen
    s_add_u32 s0, s0, 27648
    v_cos_f32 v70, v69
    v_sin_f32 v71, v69
    v_mfma_f32_32x32x16_bf16 v[112:127], a[8:11], a[180:183], v[112:127]
    ds_read_b128 a[164:167], v17 offset:12288
    ds_read_b128 a[24:27], v254 offset:16384
    buffer_load_dwordx4 v4, s[64:67], s83 offen offset:1024 lds
    v_mul_f32 v72, v60, v60
    v_fmac_f32 v72, v61, v61
    v_mul_f32 v28, v68, v70
    v_mul_f32 v29, v68, v71
    v_rcp_f32 v72, v72
    v_sub_f32 v30, 0, v29
    v_add_f32 v73, -1.0, v28
    v_mfma_f32_32x32x16_bf16 v[96:111], a[12:15], a[184:187], v[96:111]
    ds_read_b128 a[168:171], v18 offset:8192
    buffer_load_dwordx4 v5, s[64:67], s83 offen offset:2048 lds
    buffer_load_dwordx4 v[216:219], v248, s[72:75], s0 offen
    s_add_u32 s0, s0, 27648
    v_add_f32 v72, v72, v72
    v_mul_f32 v74, v73, v60
    v_fmac_f32 v74, v29, v61
    v_mul_f32 v75, v73, v61
    v_fmac_f32 v75, v30, v60
    v_mul_f32 v31, v74, v72
    v_mfma_f32_32x32x16_bf16 v[112:127], a[12:15], a[188:191], v[112:127]
    ds_read_b128 a[172:175], v18 offset:12288
    ds_read_b128 a[28:31], v255 offset:16384
    buffer_load_dwordx4 v6, s[64:67], s83 offen offset:3072 lds
    v_mul_f32 v32, v75, v72
    v_sub_f32 v33, 0, v31
    v_mul_f32 v76, v29, v29
    v_mul_f32 v69, v28, v29
    v_fma_f32 v68, v28, v28, -v76
    v_add_f32 v69, v69, v69
    v_mul_f32 v76, v69, v69
    s_waitcnt lgkmcnt(6)
    v_mfma_f32_32x32x16_bf16 v[96:111], a[16:19], a[192:195], v[96:111]
    s_waitcnt vmcnt(20)
    s_barrier
    ds_read_b128 a[176:179], v15 offset:16384
    buffer_load_dwordx4 v[220:223], v248, s[72:75], s0 offen
    s_add_u32 s0, s0, 27648
    v_mul_f32 v71, v68, v69
    v_fma_f32 v70, v68, v68, -v76
    v_add_f32 v71, v71, v71
    v_mul_f32 v76, v71, v71
    v_mul_f32 v69, v70, v71
    v_mfma_f32_32x32x16_bf16 v[112:127], a[16:19], a[196:199], v[112:127]
    ds_read_b128 a[180:183], v15 offset:20480
    s_waitcnt vmcnt(15)
    ds_read_b128 a[32:35], v252 offset:32768
    v_fma_f32 v68, v70, v70, -v76
    v_add_f32 v69, v69, v69
    v_mul_f32 v76, v69, v69
    v_mul_f32 v35, v68, v69
    v_fma_f32 v34, v68, v68, -v76
    v_add_f32 v35, v35, v35
    v_mul_f32 v76, v35, v35
    v_mul_f32 v69, v34, v35
    v_mfma_f32_32x32x16_bf16 v[96:111], a[20:23], a[200:203], v[96:111]
    ds_read_b128 a[184:187], v16 offset:16384
    buffer_load_dwordx4 v[224:227], v248, s[72:75], s0 offen
    s_add_u32 s0, s0, 27648
    v_fma_f32 v68, v34, v34, -v76
    v_add_f32 v69, v69, v69
    v_mul_f32 v76, v69, v69
    v_mul_f32 v71, v68, v69
    v_fma_f32 v70, v68, v68, -v76
    v_add_f32 v71, v71, v71
    v_mul_f32 v76, v71, v71
    v_mfma_f32_32x32x16_bf16 v[112:127], a[20:23], a[204:207], v[112:127]
    ds_read_b128 a[188:191], v16 offset:20480
    ds_read_b128 a[36:39], v253 offset:32768
    v_mul_f32 v37, v70, v71
    v_fma_f32 v36, v70, v70, -v76
    v_add_f32 v37, v37, v37
    v_mul_f32 v76, v37, v37
    v_mul_f32 v39, v36, v37
    v_fma_f32 v38, v36, v36, -v76
    v_add_f32 v39, v39, v39
    s_mov_b32 s80, 0
    s_waitcnt lgkmcnt(6)
    v_mfma_f32_32x32x16_bf16 v[96:111], a[24:27], a[160:163], v[96:111]
    s_add_u32 m0, s82, 98304
    s_add_u32 s83, s83, 128
    ds_read_b128 a[192:195], v17 offset:16384
    buffer_load_dwordx4 v3, s[64:67], s83 offen offset:0 lds
    buffer_load_dwordx4 v[228:231], v248, s[72:75], s0 offen
    s_mov_b32 s81, -1
    v_cndmask_b32 v40, 1.0, v34, s[80:81]
    v_cndmask_b32 v41, 0, v35, s[80:81]
    s_bfe_i32 s80, s3, 65536
    s_mov_b32 s81, s80
    v_mfma_f32_32x32x16_bf16 v[112:127], a[24:27], a[164:167], v[112:127]
    ds_read_b128 a[196:199], v17 offset:20480
    ds_read_b128 a[40:43], v254 offset:32768
    buffer_load_dwordx4 v4, s[64:67], s83 offen offset:1024 lds
    v_cndmask_b32 v72, 1.0, v68, s[80:81]
    v_cndmask_b32 v73, 0, v69, s[80:81]
    v_mul_f32 v74, v40, v72
    v_mul_f32 v75, v40, v73
    v_fma_f32 v40, -v41, v73, v74
    v_fma_f32 v41, v41, v72, v75
    s_bfe_i32 s80, s3, 65537
    s_mov_b32 s81, s80
    v_mfma_f32_32x32x16_bf16 v[96:111], a[28:31], a[168:171], v[96:111]
    ds_read_b128 a[200:203], v18 offset:16384
    buffer_load_dwordx4 v5, s[64:67], s83 offen offset:2048 lds
    v_cndmask_b32 v72, 1.0, v70, s[80:81]
    v_cndmask_b32 v73, 0, v71, s[80:81]
    v_mul_f32 v74, v40, v72
    v_mul_f32 v75, v40, v73
    v_fma_f32 v40, -v41, v73, v74
    v_fma_f32 v41, v41, v72, v75
    v_mov_b32 v42, 0
    v_mov_b32 v43, 0
    v_lshlrev_b32 v66, 16, v66
    v_mfma_f32_32x32x16_bf16 v[112:127], a[28:31], a[172:175], v[112:127]
    ds_read_b128 a[204:207], v18 offset:20480
    ds_read_b128 a[44:47], v255 offset:32768
    buffer_load_dwordx4 v6, s[64:67], s83 offen offset:3072 lds
    v_mul_f32 v66, 1069066811, v66
    v_exp_f32 v66, v66
    v_lshlrev_b32 v64, 16, v64
    v_lshlrev_b32 v65, 16, v65
    v_cvt_pk_bf16_f32 v66, v66, v66
    v_lshlrev_b32 v66, 16, v66
    s_waitcnt lgkmcnt(6)
    v_mfma_f32_32x32x16_bf16 v[96:111], a[32:35], a[176:179], v[96:111]
    s_add_u32 m0, s82, 49152
    s_add_u32 s10, s10, 256
    ds_read_b128 a[160:163], v15 offset:24576
    buffer_load_dwordx4 v3, s[60:63], s10 offen offset:0 lds
    v_mul_f32 v68, v66, v64
    v_mul_f32 v69, v66, v65
    v_mul_f32 v68, 1069066811, v68
    v_mul_f32 v69, 0.15915494, v69
    v_exp_f32 v68, v68
    v_fract_f32 v69, v69
    v_mfma_f32_32x32x16_bf16 v[112:127], a[32:35], a[180:183], v[112:127]
    ds_read_b128 a[164:167], v15 offset:28672
    s_waitcnt vmcnt(18)
    ds_read_b128 a[48:51], v252 offset:49152
    buffer_load_dwordx4 v4, s[60:63], s10 offen offset:1024 lds
    v_cos_f32 v70, v69
    v_sin_f32 v71, v69
    v_mul_f32 v72, v64, v64
    v_fmac_f32 v72, v65, v65
    v_mul_f32 v44, v68, v70
    v_mfma_f32_32x32x16_bf16 v[96:111], a[36:39], a[184:187], v[96:111]
    ds_read_b128 a[168:171], v16 offset:24576
    buffer_load_dwordx4 v5, s[60:63], s10 offen offset:2048 lds
    v_mul_f32 v45, v68, v71
    v_rcp_f32 v72, v72
    v_sub_f32 v46, 0, v45
    v_add_f32 v73, -1.0, v44
    v_add_f32 v72, v72, v72
    v_mul_f32 v74, v73, v64
    v_fmac_f32 v74, v45, v65
    v_mul_f32 v75, v73, v65
    v_mfma_f32_32x32x16_bf16 v[112:127], a[36:39], a[188:191], v[112:127]
    ds_read_b128 a[172:175], v16 offset:28672
    ds_read_b128 a[52:55], v253 offset:49152
    buffer_load_dwordx4 v6, s[60:63], s10 offen offset:3072 lds
    v_fmac_f32 v75, v46, v64
    v_mul_f32 v47, v74, v72
    v_mul_f32 v48, v75, v72
    v_sub_f32 v49, 0, v47
    v_mul_f32 v76, v45, v45
    v_mul_f32 v69, v44, v45
    v_fma_f32 v68, v44, v44, -v76
    s_waitcnt lgkmcnt(6)
    v_mfma_f32_32x32x16_bf16 v[96:111], a[40:43], a[192:195], v[96:111]
    s_add_u32 m0, s82, 114688
    s_add_u32 s83, s83, 128
    ds_read_b128 a[176:179], v17 offset:24576
    buffer_load_dwordx4 v3, s[64:67], s83 offen offset:0 lds
    v_add_f32 v69, v69, v69
    v_mul_f32 v76, v69, v69
    v_mul_f32 v71, v68, v69
    v_fma_f32 v70, v68, v68, -v76
    v_add_f32 v71, v71, v71
    v_mul_f32 v76, v71, v71
    v_mul_f32 v69, v70, v71
    v_mfma_f32_32x32x16_bf16 v[112:127], a[40:43], a[196:199], v[112:127]
    ds_read_b128 a[180:183], v17 offset:28672
    ds_read_b128 a[56:59], v254 offset:49152
    buffer_load_dwordx4 v4, s[64:67], s83 offen offset:1024 lds
    v_fma_f32 v68, v70, v70, -v76
    v_add_f32 v69, v69, v69
    v_mul_f32 v76, v69, v69
    v_mul_f32 v51, v68, v69
    v_fma_f32 v50, v68, v68, -v76
    v_add_f32 v51, v51, v51
    v_mul_f32 v76, v51, v51
    v_mul_f32 v69, v50, v51
    v_mfma_f32_32x32x16_bf16 v[96:111], a[44:47], a[200:203], v[96:111]
    ds_read_b128 a[184:187], v18 offset:24576
    buffer_load_dwordx4 v5, s[64:67], s83 offen offset:2048 lds
    v_fma_f32 v68, v50, v50, -v76
    v_add_f32 v69, v69, v69
    v_mul_f32 v76, v69, v69
    v_mul_f32 v71, v68, v69
    v_fma_f32 v70, v68, v68, -v76
    v_add_f32 v71, v71, v71
    v_mul_f32 v76, v71, v71
    v_mul_f32 v53, v70, v71
    v_fma_f32 v52, v70, v70, -v76
    v_mfma_f32_32x32x16_bf16 v[112:127], a[44:47], a[204:207], v[112:127]
    ds_read_b128 a[188:191], v18 offset:28672
    ds_read_b128 a[60:63], v255 offset:49152
    buffer_load_dwordx4 v6, s[64:67], s83 offen offset:3072 lds
    v_add_f32 v53, v53, v53
    v_mul_f32 v76, v53, v53
    v_mul_f32 v55, v52, v53
    v_fma_f32 v54, v52, v52, -v76
    v_add_f32 v55, v55, v55
    s_mov_b32 s80, 0
    s_mov_b32 s81, -1
    s_waitcnt lgkmcnt(6)
    v_mfma_f32_32x32x16_bf16 v[96:111], a[48:51], a[160:163], v[96:111]
    s_waitcnt vmcnt(21)
    s_barrier
    ds_read_b128 a[192:195], v15 offset:32768
    v_cndmask_b32 v56, 1.0, v50, s[80:81]
    v_cndmask_b32 v57, 0, v51, s[80:81]
    s_bfe_i32 s80, s3, 65536
    s_mov_b32 s81, s80
    v_cndmask_b32 v72, 1.0, v68, s[80:81]
    v_cndmask_b32 v73, 0, v69, s[80:81]
    v_mul_f32 v74, v56, v72
    v_mul_f32 v75, v56, v73
    v_mfma_f32_32x32x16_bf16 v[112:127], a[48:51], a[164:167], v[112:127]
    ds_read_b128 a[196:199], v15 offset:36864
    s_waitcnt vmcnt(15)
    ds_read_b128 a[64:67], v252 offset:0
    v_fma_f32 v56, -v57, v73, v74
    v_fma_f32 v57, v57, v72, v75
    s_bfe_i32 s80, s3, 65537
    s_mov_b32 s81, s80
    v_cndmask_b32 v72, 1.0, v70, s[80:81]
    v_cndmask_b32 v73, 0, v71, s[80:81]
    v_mul_f32 v74, v56, v72
    v_mul_f32 v75, v56, v73
    v_mfma_f32_32x32x16_bf16 v[96:111], a[52:55], a[168:171], v[96:111]
    ds_read_b128 a[200:203], v16 offset:32768
    v_fma_f32 v56, -v57, v73, v74
    v_fma_f32 v57, v57, v72, v75
    v_mov_b32 v58, 0
    v_mov_b32 v59, 0
    v_and_b32 v80, 31, v1
    v_lshrrev_b32 v82, 5, v1
    v_bfe_u32 v81, v1, 2, 1
    v_lshlrev_b32 v81, 10, v81
    v_lshl_add_u32 v81, v82, 8, v81
    v_bfe_u32 v83, v1, 3, 2
    v_mfma_f32_32x32x16_bf16 v[112:127], a[52:55], a[172:175], v[112:127]
    ds_read_b128 a[204:207], v16 offset:36864
    ds_read_b128 a[68:71], v253 offset:0
    v_lshl_add_u32 v81, v83, 6, v81
    v_and_b32 v83, 3, v1
    v_lshl_add_u32 v19, v83, 4, v81
    s_lshl_b32 s80, s3, 9
    s_add_u32 s80, s80, 147456
    v_lshl_add_u32 v21, v1, 3, s80
    v_lshlrev_b32 v81, 3, v80
    v_add_u32 v22, 147456, v81
    s_waitcnt lgkmcnt(6)
    v_mfma_f32_32x32x16_bf16 v[96:111], a[56:59], a[176:179], v[96:111]
    s_add_u32 m0, s82, 131072
    s_add_u32 s83, s83, 128
    ds_read_b128 a[160:163], v17 offset:32768
    buffer_load_dwordx4 v3, s[64:67], s83 offen offset:0 lds
    s_mul_i32 s80, s3, 2560
    s_add_u32 s80, s80, 151552
    v_lshl_add_u32 v24, v82, 5, v24
    v_add_u32 v24, s80, v24
    v_lshrrev_b32 v81, 4, v1
    v_bfe_u32 v84, v1, 2, 2
    v_lshl_add_u32 v81, v81, 3, v84
    v_mfma_f32_32x32x16_bf16 v[112:127], a[56:59], a[180:183], v[112:127]
    ds_read_b128 a[164:167], v17 offset:36864
    ds_read_b128 a[72:75], v254 offset:0
    buffer_load_dwordx4 v4, s[64:67], s83 offen offset:1024 lds
    v_mul_u32_u24 v81, 80, v81
    v_lshl_add_u32 v81, v83, 3, v81
    v_add_u32 v25, s80, v81
    s_lshl_b32 s15, s4, 9
    s_or_b32 s81, s15, s3
    s_mov_b32 s99, 0x100000
    v_mfma_f32_32x32x16_bf16 v[96:111], a[60:63], a[184:187], v[96:111]
    ds_read_b128 a[168:171], v18 offset:32768
    buffer_load_dwordx4 v5, s[64:67], s83 offen offset:2048 lds
    s_cmp_eq_u32 s81, 1
    s_cselect_b32 s80, 8192, s99
    s_cmp_eq_u32 s3, 0
    s_cselect_b32 s80, s15, s80
    s_cselect_b32 s31, -1, 0
    s_cmp_eq_u32 s5, 10
    s_cselect_b32 s80, s99, s80
    v_lshlrev_b32 v81, 4, v80
    v_mfma_f32_32x32x16_bf16 v[112:127], a[60:63], a[188:191], v[112:127]
    ds_read_b128 a[172:175], v18 offset:36864
    ds_read_b128 a[76:79], v255 offset:0
    buffer_load_dwordx4 v6, s[64:67], s83 offen offset:3072 lds
    v_add_u32 v23, s80, v81
    s_sub_u32 s15, s15, 512
    v_add_u32 v95, 8192, v81
    v_add_u32 v81, s15, v81
    v_lshlrev_b32 v82, 9, v82
    v_sub_u32 v80, v81, v82
    s_lshr_b32 s99, s3, 1
    s_waitcnt lgkmcnt(6)
    v_mfma_f32_32x32x16_bf16 v[96:111], a[64:67], a[192:195], v[96:111]
    s_add_u32 m0, s82, 0
    s_add_u32 s10, s10, 256
    ds_read_b128 a[176:179], v15 offset:40960
    buffer_load_dwordx4 v3, s[60:63], s10 offen offset:0 lds
    s_and_b32 s99, s99, s2
    s_lshl_b32 s99, s99, 30
    v_subrev_u32 v81, 1024, v80
    v_subrev_u32 v82, 2048, v80
    v_subrev_u32 v83, 3072, v80
    v_subrev_u32 v84, 4096, v80
    v_subrev_u32 v85, 5120, v80
    v_mfma_f32_32x32x16_bf16 v[112:127], a[64:67], a[196:199], v[112:127]
    ds_read_b128 a[180:183], v15 offset:45056
    s_waitcnt vmcnt(13)
    ds_read_b128 a[80:83], v252 offset:16384
    buffer_load_dwordx4 v4, s[60:63], s10 offen offset:1024 lds
    v_subrev_u32 v86, 6144, v80
    v_subrev_u32 v87, 7168, v80
    v_min_u32 v80, v80, v95
    v_min_u32 v81, v81, v95
    v_min_u32 v82, v82, v95
    v_min_u32 v83, v83, v95
    v_min_u32 v84, v84, v95
    v_mfma_f32_32x32x16_bf16 v[96:111], a[68:71], a[200:203], v[96:111]
    ds_read_b128 a[184:187], v16 offset:40960
    buffer_load_dwordx4 v5, s[60:63], s10 offen offset:2048 lds
    v_min_u32 v85, v85, v95
    v_min_u32 v86, v86, v95
    v_min_u32 v87, v87, v95
    v_add_u32 v80, 151552, v80
    v_add_u32 v81, 151552, v81
    v_add_u32 v82, 151552, v82
    v_add_u32 v83, 151552, v83
    v_add_u32 v84, 151552, v84
    v_add_u32 v85, 151552, v85
    v_mfma_f32_32x32x16_bf16 v[112:127], a[68:71], a[204:207], v[112:127]
    ds_read_b128 a[188:191], v16 offset:45056
    ds_read_b128 a[84:87], v253 offset:16384
    buffer_load_dwordx4 v6, s[60:63], s10 offen offset:3072 lds
    v_add_u32 v86, 151552, v86
    v_add_u32 v87, 151552, v87
    v_add_u32 v23, 151552, v23
    s_waitcnt lgkmcnt(6)
    v_mfma_f32_32x32x16_bf16 v[96:111], a[72:75], a[160:163], v[96:111]
    s_add_u32 m0, s82, 81920
    s_add_u32 s83, s83, 128
    ds_read_b128 a[192:195], v17 offset:40960
    buffer_load_dwordx4 v3, s[64:67], s83 offen offset:0 lds
    s_mov_b32 s72, s46
    s_mov_b32 s73, s47
    s_cmp_eq_u32 s5, 10
    s_cselect_b32 s74, 0, 41943040
    s_mov_b32 s75, 0x00020000
    v_mfma_f32_32x32x16_bf16 v[112:127], a[72:75], a[164:167], v[112:127]
    ds_read_b128 a[196:199], v17 offset:45056
    ds_read_b128 a[88:91], v254 offset:16384
    buffer_load_dwordx4 v4, s[64:67], s83 offen offset:1024 lds
    v_lshlrev_b32 v232, 16, v212
    v_and_b32 v233, 0xffff0000, v212
    v_lshlrev_b32 v234, 16, v213
    v_and_b32 v235, 0xffff0000, v213
    v_lshlrev_b32 v236, 16, v214
    v_and_b32 v237, 0xffff0000, v214
    v_lshlrev_b32 v238, 16, v215
    v_and_b32 v239, 0xffff0000, v215
    v_mfma_f32_32x32x16_bf16 v[96:111], a[76:79], a[168:171], v[96:111]
    ds_read_b128 a[200:203], v18 offset:40960
    buffer_load_dwordx4 v5, s[64:67], s83 offen offset:2048 lds
    v_lshlrev_b32 v240, 16, v216
    v_and_b32 v241, 0xffff0000, v216
    v_add_f32 v232, v232, v240
    v_add_f32 v233, v233, v241
    v_lshlrev_b32 v242, 16, v217
    v_and_b32 v243, 0xffff0000, v217
    v_add_f32 v234, v234, v242
    v_add_f32 v235, v235, v243
    v_lshlrev_b32 v240, 16, v218
    v_mfma_f32_32x32x16_bf16 v[112:127], a[76:79], a[172:175], v[112:127]
    ds_read_b128 a[204:207], v18 offset:45056
    ds_read_b128 a[92:95], v255 offset:16384
    buffer_load_dwordx4 v6, s[64:67], s83 offen offset:3072 lds
    v_and_b32 v241, 0xffff0000, v218
    v_add_f32 v236, v236, v240
    v_add_f32 v237, v237, v241
    v_lshlrev_b32 v242, 16, v219
    v_and_b32 v243, 0xffff0000, v219
    v_add_f32 v238, v238, v242
    v_add_f32 v239, v239, v243
    s_waitcnt lgkmcnt(6)
    v_mfma_f32_32x32x16_bf16 v[96:111], a[80:83], a[176:179], v[96:111]
    s_waitcnt vmcnt(16)
    s_barrier
    ds_read_b128 a[160:163], v15 offset:49152
    v_lshlrev_b32 v240, 16, v220
    v_and_b32 v241, 0xffff0000, v220
    v_add_f32 v232, v232, v240
    v_add_f32 v233, v233, v241
    v_lshlrev_b32 v242, 16, v221
    v_and_b32 v243, 0xffff0000, v221
    v_add_f32 v234, v234, v242
    v_add_f32 v235, v235, v243
    v_mfma_f32_32x32x16_bf16 v[112:127], a[80:83], a[180:183], v[112:127]
    ds_read_b128 a[164:167], v15 offset:53248
    s_waitcnt vmcnt(12)
    ds_read_b128 a[96:99], v252 offset:32768
    v_lshlrev_b32 v240, 16, v222
    v_and_b32 v241, 0xffff0000, v222
    v_add_f32 v236, v236, v240
    v_add_f32 v237, v237, v241
    v_lshlrev_b32 v242, 16, v223
    v_and_b32 v243, 0xffff0000, v223
    v_add_f32 v238, v238, v242
    v_add_f32 v239, v239, v243
    v_mfma_f32_32x32x16_bf16 v[96:111], a[84:87], a[184:187], v[96:111]
    ds_read_b128 a[168:171], v16 offset:49152
    v_lshlrev_b32 v240, 16, v224
    v_and_b32 v241, 0xffff0000, v224
    v_add_f32 v232, v232, v240
    v_add_f32 v233, v233, v241
    v_lshlrev_b32 v242, 16, v225
    v_and_b32 v243, 0xffff0000, v225
    v_add_f32 v234, v234, v242
    v_add_f32 v235, v235, v243
    v_lshlrev_b32 v240, 16, v226
    v_and_b32 v241, 0xffff0000, v226
    v_mfma_f32_32x32x16_bf16 v[112:127], a[84:87], a[188:191], v[112:127]
    ds_read_b128 a[172:175], v16 offset:53248
    ds_read_b128 a[100:103], v253 offset:32768
    v_add_f32 v236, v236, v240
    v_add_f32 v237, v237, v241
    v_lshlrev_b32 v242, 16, v227
    v_and_b32 v243, 0xffff0000, v227
    v_add_f32 v238, v238, v242
    v_add_f32 v239, v239, v243
    v_lshlrev_b32 v240, 16, v228
    v_and_b32 v241, 0xffff0000, v228
    s_waitcnt lgkmcnt(6)
    v_mfma_f32_32x32x16_bf16 v[96:111], a[88:91], a[192:195], v[96:111]
    s_add_u32 m0, s82, 98304
    s_add_u32 s83, s83, 128
    ds_read_b128 a[176:179], v17 offset:49152
    buffer_load_dwordx4 v3, s[64:67], s83 offen offset:0 lds
    v_add_f32 v232, v232, v240
    v_add_f32 v233, v233, v241
    v_lshlrev_b32 v242, 16, v229
    v_and_b32 v243, 0xffff0000, v229
    v_add_f32 v234, v234, v242
    v_add_f32 v235, v235, v243
    v_lshlrev_b32 v240, 16, v230
    v_mfma_f32_32x32x16_bf16 v[112:127], a[88:91], a[196:199], v[112:127]
    ds_read_b128 a[180:183], v17 offset:53248
    ds_read_b128 a[104:107], v254 offset:32768
    buffer_load_dwordx4 v4, s[64:67], s83 offen offset:1024 lds
    v_and_b32 v241, 0xffff0000, v230
    v_add_f32 v236, v236, v240
    v_add_f32 v237, v237, v241
    v_lshlrev_b32 v242, 16, v231
    v_and_b32 v243, 0xffff0000, v231
    v_add_f32 v238, v238, v242
    v_add_f32 v239, v239, v243
    s_lshl_b32 s0, s3, 8
    v_mfma_f32_32x32x16_bf16 v[96:111], a[92:95], a[200:203], v[96:111]
    ds_read_b128 a[184:187], v18 offset:49152
    buffer_load_dwordx4 v5, s[64:67], s83 offen offset:2048 lds
    v_add_u32 v250, 162816, v250
    v_add_u32 v240, s0, v250
    v_permlane32_swap_b32 v232, v236
    v_permlane32_swap_b32 v233, v237
    v_permlane32_swap_b32 v234, v238
    v_permlane32_swap_b32 v235, v239
    v_add_f32 v232, v232, v236
    v_add_f32 v233, v233, v237
    v_add_f32 v234, v234, v238
    v_mfma_f32_32x32x16_bf16 v[112:127], a[92:95], a[204:207], v[112:127]
    ds_read_b128 a[188:191], v18 offset:53248
    ds_read_b128 a[108:111], v255 offset:32768
    buffer_load_dwordx4 v6, s[64:67], s83 offen offset:3072 lds
    v_add_f32 v235, v235, v239
    s_mov_b32 s34, 0xff00ff00
    v_permlane16_swap_b32 v232, v234
    v_permlane16_swap_b32 v233, v235
    v_add_f32 v232, v232, v234
    v_add_f32 v233, v233, v235
    s_mov_b32 s35, s34
    s_waitcnt lgkmcnt(6)
    v_mfma_f32_32x32x16_bf16 v[96:111], a[96:99], a[160:163], v[96:111]
    s_add_u32 m0, s82, 16384
    ds_read_b128 a[192:195], v15 offset:57344
    buffer_load_dwordx4 v3, s[60:63], s11 offen offset:0 lds
    v_add_f32_dpp v232, v232, v232 row_ror:8 row_mask:0xf bank_mask:0xf
    v_add_f32_dpp v233, v233, v233 row_ror:8 row_mask:0xf bank_mask:0xf
    v_cndmask_b32 v232, v232, v233, s[34:35]
    v_mfma_f32_32x32x16_bf16 v[112:127], a[96:99], a[164:167], v[112:127]
    ds_read_b128 a[196:199], v15 offset:61440
    s_waitcnt vmcnt(13)
    ds_read_b128 a[112:115], v252 offset:49152
    buffer_load_dwordx4 v4, s[60:63], s11 offen offset:1024 lds
    ds_write_b32 v240, v232
    s_lshl_b32 s80, s4, 2
    s_add_u32 s80, s80, s3
    s_lshl_b32 s80, s80, 8
    s_add_u32 s80, s80, 26218496
    v_mfma_f32_32x32x16_bf16 v[96:111], a[100:103], a[168:171], v[96:111]
    ds_read_b128 a[200:203], v16 offset:57344
    buffer_load_dwordx4 v5, s[60:63], s11 offen offset:2048 lds
    s_lshl_b32 s81, s6, 11
    s_add_u32 s81, s81, 110592
    s_cmp_eq_u32 s3, 0
    s_cselect_b32 s85, -1, 0
    s_mov_b32 s84, 0
    s_cmp_eq_u32 s3, 1
    s_cselect_b32 s86, -1, 0
    s_mov_b32 s87, 0
    v_mfma_f32_32x32x16_bf16 v[112:127], a[100:103], a[172:175], v[112:127]
    ds_read_b128 a[204:207], v16 offset:61440
    ds_read_b128 a[116:119], v253 offset:49152
    buffer_load_dwordx4 v6, s[60:63], s11 offen offset:3072 lds
    buffer_load_dwordx2 v[212:213], v210, s[48:51], s80 offen sc1
    s_cmp_eq_u32 s3, 1
    s_cselect_b32 s89, -1, 0
    s_mov_b32 s88, 0
    s_waitcnt lgkmcnt(7)
    v_mfma_f32_32x32x16_bf16 v[96:111], a[104:107], a[176:179], v[96:111]
    s_add_u32 m0, s82, 114688
    s_add_u32 s11, s11, 256
    ds_read_b128 a[160:163], v17 offset:57344
    buffer_load_dwordx4 v3, s[60:63], s11 offen offset:0 lds
    s_waitcnt lgkmcnt(4)
    buffer_load_dwordx4 v[216:219], v20, s[48:51], s81 offen offset:0 sc1
    s_cmp_eq_u32 s3, 2
    s_cselect_b32 s90, -1, 0
    s_mov_b32 s91, 0
    v_mfma_f32_32x32x16_bf16 v[112:127], a[104:107], a[180:183], v[112:127]
    ds_read_b128 a[164:167], v17 offset:61440
    ds_read_b128 a[120:123], v254 offset:49152
    buffer_load_dwordx4 v4, s[60:63], s11 offen offset:1024 lds
    buffer_load_dwordx4 v[220:223], v20, s[48:51], s81 offen offset:1024 sc1
    s_cmp_eq_u32 s3, 2
    s_cselect_b32 s93, -1, 0
    s_mov_b32 s92, 0
    s_cmp_eq_u32 s3, 3
    s_cselect_b32 s94, -1, 0
    s_mov_b32 s95, 0
    v_mfma_f32_32x32x16_bf16 v[96:111], a[108:111], a[184:187], v[96:111]
    ds_read_b128 a[168:171], v18 offset:57344
    buffer_load_dwordx4 v5, s[60:63], s11 offen offset:2048 lds
    buffer_load_dwordx4 v[224:227], v20, s[48:51], s81 offen offset:2048 sc1
    s_cmp_eq_u32 s3, 3
    s_cselect_b32 s97, -1, 0
    s_mov_b32 s96, 0
    v_mfma_f32_32x32x16_bf16 v[112:127], a[108:111], a[188:191], v[112:127]
    ds_read_b128 a[172:175], v18 offset:61440
    ds_read_b128 a[124:127], v255 offset:49152
    buffer_load_dwordx4 v6, s[60:63], s11 offen offset:3072 lds
    buffer_load_dwordx4 v[228:231], v20, s[48:51], s81 offen offset:3072 sc1
    s_waitcnt lgkmcnt(6)
    v_mfma_f32_32x32x16_bf16 v[96:111], a[112:115], a[192:195], v[96:111]
    s_waitcnt vmcnt(21)
    s_barrier
    s_add_u32 m0, s82, 32768
    s_add_u32 s11, s11, 256
    ds_read_b32 v232, v250 offset:0
    ds_read_b32 v233, v250 offset:256
    ds_read_b32 v234, v250 offset:512
    ds_read_b32 v235, v250 offset:768
    ds_read_b128 a[176:179], v15 offset:0
    buffer_load_dwordx4 v3, s[60:63], s11 offen offset:0 lds
    v_mfma_f32_32x32x16_bf16 v[112:127], a[112:115], a[196:199], v[112:127]
    ds_read_b128 a[180:183], v15 offset:4096
    s_waitcnt vmcnt(18)
    ds_read_b128 a[128:131], v252 offset:0
    buffer_load_dwordx4 v4, s[60:63], s11 offen offset:1024 lds
    v_mfma_f32_32x32x16_bf16 v[96:111], a[116:119], a[200:203], v[96:111]
    ds_read_b128 a[184:187], v16 offset:0
    buffer_load_dwordx4 v5, s[60:63], s11 offen offset:2048 lds
    v_mfma_f32_32x32x16_bf16 v[112:127], a[116:119], a[204:207], v[112:127]
    ds_read_b128 a[188:191], v16 offset:4096
    ds_read_b128 a[132:135], v253 offset:0
    buffer_load_dwordx4 v6, s[60:63], s11 offen offset:3072 lds
    s_waitcnt lgkmcnt(6)
    v_add_f32 v232, v232, v233
    v_add_f32 v234, v234, v235
    v_add_f32 v234, v232, v234
    v_cvt_pk_bf16_f32 v235, v234, v234
    v_lshlrev_b32 v235, 16, v235
    v_sub_f32 v234, v234, v235
    v_cvt_pk_bf16_f32 v232, v235, v234
    v_mov_b32 v233, v26
    buffer_store_dwordx2 v[232:233], v249, s[48:51], s1 offen sc1
    v_mfma_f32_32x32x16_bf16 v[96:111], a[120:123], a[160:163], v[96:111]
    s_add_u32 m0, s82, 131072
    s_add_u32 s11, s11, 256
    ds_read_b128 a[192:195], v17 offset:0
    buffer_load_dwordx4 v3, s[60:63], s11 offen offset:0 lds
    s_lshl_b32 s0, s5, 12
    s_add_u32 s1, s0, 65536
    v_mfma_f32_32x32x16_bf16 v[112:127], a[120:123], a[164:167], v[112:127]
    ds_read_b128 a[196:199], v17 offset:4096
    ds_read_b128 a[136:139], v254 offset:0
    buffer_load_dwordx4 v4, s[60:63], s11 offen offset:1024 lds
    v_mfma_f32_32x32x16_bf16 v[96:111], a[124:127], a[168:171], v[96:111]
    ds_read_b128 a[200:203], v18 offset:0
    buffer_load_dwordx4 v5, s[60:63], s11 offen offset:2048 lds
    v_mfma_f32_32x32x16_bf16 v[112:127], a[124:127], a[172:175], v[112:127]
    ds_read_b128 a[204:207], v18 offset:4096
    ds_read_b128 a[140:143], v255 offset:0
    buffer_load_dwordx4 v6, s[60:63], s11 offen offset:3072 lds
    s_waitcnt vmcnt(9)
    v_xor_b32 v214, v213, v26
    v_bitop3_b32 v215, v217, v219, v26 bitop3:0x7e
    v_or_b32 v214, v214, v215
    v_bitop3_b32 v215, v221, v223, v26 bitop3:0x7e
    v_or_b32 v214, v214, v215
    v_bitop3_b32 v215, v225, v227, v26 bitop3:0x7e
    s_waitcnt lgkmcnt(6)
    v_mfma_f32_32x32x16_bf16 v[96:111], a[128:131], a[176:179], v[96:111]
    s_add_u32 m0, s82, 65536
    ds_read_b128 a[160:163], v15 offset:8192
    buffer_load_dwordx4 v209, s[68:71], s40 offen offset:0 nt lds
    s_add_u32 s40, s40, s41
    v_or_b32 v214, v214, v215
    v_bitop3_b32 v215, v229, v231, v26 bitop3:0x7e
    v_or_b32 v214, v214, v215
    v_mfma_f32_32x32x16_bf16 v[112:127], a[128:131], a[180:183], v[112:127]
    ds_read_b128 a[164:167], v15 offset:12288
    ds_read_b128 a[144:147], v252 offset:16384
    v_cmp_ne_u32 vcc, 0, v214
    s_nop 1
    s_cmp_lg_u64 vcc, 0
    s_cbranch_scc1 L_slow_27
L_ok_28:
    v_and_b32 v89, 0xffff0000, v212
    v_and_b32 v214, 0xffff, v212
    v_rcp_f32 v215, v89
    v_lshl_or_b32 v214, v214, 16, v214
    v_mfma_f32_32x32x16_bf16 v[96:111], a[132:135], a[184:187], v[96:111]
    ds_read_b128 a[168:171], v16 offset:8192
    buffer_load_dwordx4 v209, s[68:71], s40 offen offset:1024 nt lds
    s_add_u32 s40, s40, s41
    v_accvgpr_write_b32 a252, v214
    v_accvgpr_write_b32 a253, 0
    v_accvgpr_write_b32 a254, v214
    v_accvgpr_write_b32 a255, 0
    v_mul_f32 v88, 3216550459, v215
    s_lshl_b32 s80, s3, 7
    s_add_u32 s80, s80, 161792
    v_lshrrev_b32 v210, 1, v210
    v_mfma_f32_32x32x16_bf16 v[112:127], a[132:135], a[188:191], v[112:127]
    ds_read_b128 a[172:175], v16 offset:12288
    ds_read_b128 a[148:151], v253 offset:16384
    v_add_u32 v210, s80, v210
    v_lshrrev_b32 v95, 5, v1
    v_lshl_add_u32 v95, v95, 6, s80
    s_waitcnt lgkmcnt(6)
    v_mfma_f32_32x32x16_bf16 v[96:111], a[136:139], a[192:195], v[96:111]
    ds_read_b128 a[176:179], v17 offset:8192
    buffer_load_dwordx4 v209, s[68:71], s40 offen offset:2048 nt lds
    s_add_u32 s40, s40, s41
    ds_write_b32 v210, v215
    v_mfma_f32_32x32x16_bf16 v[96:111], a[252:255], v[216:219], v[96:111]
    v_mfma_f32_32x32x16_bf16 v[112:127], a[136:139], a[196:199], v[112:127]
    ds_read_b128 a[180:183], v17 offset:12288
    ds_read_b128 a[152:155], v254 offset:16384
    v_mfma_f32_32x32x16_bf16 v[112:127], a[252:255], v[220:223], v[112:127]
    v_mfma_f32_32x32x16_bf16 v[96:111], a[140:143], a[200:203], v[96:111]
    ds_read_b128 a[184:187], v18 offset:8192
    buffer_load_dwordx4 v209, s[68:71], s40 offen offset:3072 nt lds
    v_mfma_f32_32x32x16_bf16 v[112:127], a[140:143], a[204:207], v[112:127]
    s_add_u32 m0, s82, 81920
    s_add_u32 s11, s11, 256
    ds_read_b128 a[188:191], v18 offset:12288
    ds_read_b128 a[156:159], v255 offset:16384
    buffer_load_dwordx4 v3, s[60:63], s11 offen offset:0 lds
    s_waitcnt lgkmcnt(7)
    v_mfma_f32_32x32x16_bf16 v[96:111], a[144:147], a[160:163], v[96:111]
    s_barrier
    ds_read_b128 a[192:195], v15 offset:16384
    buffer_load_dwordx4 v4, s[60:63], s11 offen offset:1024 lds
    v_mfma_f32_32x32x16_bf16 v[112:127], a[144:147], a[164:167], v[112:127]
    ds_read_b128 a[196:199], v15 offset:20480
    buffer_load_dwordx4 v5, s[60:63], s11 offen offset:2048 lds
    v_mfma_f32_32x32x16_bf16 v[96:111], a[148:151], a[168:171], v[96:111]
    ds_read_b128 a[200:203], v16 offset:16384
    buffer_load_dwordx4 v6, s[60:63], s11 offen offset:3072 lds
    v_mfma_f32_32x32x16_bf16 v[112:127], a[148:151], a[172:175], v[112:127]
    s_add_u32 m0, s82, 49152
    ds_read_b128 a[204:207], v16 offset:20480
    buffer_load_dwordx4 v7, s[52:55], s12 offen offset:0 lds
    s_waitcnt lgkmcnt(4)
    v_mfma_f32_32x32x16_bf16 v[96:111], a[152:155], a[176:179], v[96:111]
    ds_read_b128 a[160:163], v17 offset:16384
    buffer_load_dwordx4 v8, s[52:55], s12 offen offset:1024 lds
    v_mfma_f32_32x32x16_bf16 v[112:127], a[152:155], a[180:183], v[112:127]
    ds_read_b128 a[164:167], v17 offset:20480
    buffer_load_dwordx4 v7, s[56:59], s12 offen offset:2048 lds
    v_mfma_f32_32x32x16_bf16 v[96:111], a[156:159], a[184:187], v[96:111]
    ds_read_b128 a[168:171], v18 offset:16384
    buffer_load_dwordx4 v8, s[56:59], s12 offen offset:3072 lds
    v_mfma_f32_32x32x16_bf16 v[112:127], a[156:159], a[188:191], v[112:127]
    s_add_u32 m0, s82, 98304
    s_add_u32 s12, s12, 221184
    ds_read_b128 a[172:175], v18 offset:20480
    buffer_load_dwordx4 v7, s[52:55], s12 offen offset:0 lds
    s_waitcnt lgkmcnt(4)
    v_mfma_f32_32x32x16_bf16 v[128:143], a[0:3], a[192:195], 0
    ds_read_b128 a[176:179], v15 offset:24576
    s_mul_i32 s66, s6, 8704
    s_add_u32 s66, s66, 25014272
    s_add_u32 s64, s46, s66
    s_addc_u32 s65, s47, 0
    s_mov_b32 s66, 160256
    s_mov_b32 s67, 0x00020000
    v_mfma_f32_32x32x16_bf16 v[144:159], a[0:3], a[196:199], 0
    ds_read_b128 a[180:183], v15 offset:28672
    s_cmp_ge_u32 s3, 2
    s_cselect_b32 s44, s1, s0
    s_and_b32 s45, s3, 1
    s_lshl_b32 s45, s45, 11
    s_add_u32 s44, s44, s45
    v_add_u32 v93, 151552, v20
    v_mfma_f32_32x32x16_bf16 v[128:143], a[4:7], a[200:203], v[128:143]
    ds_read_b128 a[184:187], v16 offset:24576
    buffer_load_dwordx4 v8, s[52:55], s12 offen offset:1024 lds
    v_mfma_f32_32x32x16_bf16 v[144:159], a[4:7], a[204:207], v[144:159]
    ds_read_b128 a[188:191], v16 offset:28672
    s_waitcnt lgkmcnt(4)
    v_mfma_f32_32x32x16_bf16 v[128:143], a[8:11], a[160:163], v[128:143]
    ds_read_b128 a[192:195], v17 offset:24576
    v_mfma_f32_32x32x16_bf16 v[128:143], a[252:255], v[224:227], v[128:143]
    v_mfma_f32_32x32x16_bf16 v[144:159], a[252:255], v[228:231], v[144:159]
    ds_read_b128 v[64:67], v95 offset:0
    ds_read_b128 v[68:71], v95 offset:16
    v_mfma_f32_32x32x16_bf16 v[144:159], a[8:11], a[164:167], v[144:159]
    ds_read_b128 a[196:199], v17 offset:28672
    s_waitcnt vmcnt(10)
    s_cmp_eq_u32 s41, 4096
    s_cbranch_scc1 L_rtc_29
    ds_read_b64_tr_b16 v[192:193], v208 offset:0
    ds_read_b64_tr_b16 v[194:195], v208 offset:1024
    ds_read_b64_tr_b16 v[196:197], v208 offset:32
    ds_read_b64_tr_b16 v[198:199], v208 offset:1056
    ds_read_b64_tr_b16 v[200:201], v208 offset:64
    ds_read_b64_tr_b16 v[202:203], v208 offset:1088
    ds_read_b64_tr_b16 v[204:205], v208 offset:96
    ds_read_b64_tr_b16 v[206:207], v208 offset:1120
    s_branch L_rtd_30
L_rtc_29:
    v_xor_b32 v199, 64, v208
    v_xor_b32 v203, 128, v208
    v_xor_b32 v207, 192, v208
    ds_read_b64 v[192:193], v208 offset:0
    ds_read_b64 v[194:195], v208 offset:8
    ds_read_b64 v[196:197], v199 offset:0
    ds_read_b64 v[198:199], v199 offset:8
    ds_read_b64 v[200:201], v203 offset:0
    ds_read_b64 v[202:203], v203 offset:8
    ds_read_b64 v[204:205], v207 offset:0
    ds_read_b64 v[206:207], v207 offset:8
L_rtd_30:
    ds_read_b128 v[72:75], v95 offset:32
    ds_read_b128 v[76:79], v95 offset:48
    v_mfma_f32_32x32x16_bf16 v[128:143], a[12:15], a[168:171], v[128:143]
    ds_read_b128 a[200:203], v18 offset:24576
    buffer_load_dwordx4 v7, s[56:59], s12 offen offset:2048 lds
    v_mfma_f32_32x32x16_bf16 v[144:159], a[12:15], a[172:175], v[144:159]
    ds_read_b128 a[204:207], v18 offset:28672
    s_waitcnt lgkmcnt(15)
    v_mfma_f32_32x32x16_bf16 v[128:143], a[16:19], a[176:179], v[128:143]
    v_subrev_u32 v252, s82, v252
    v_subrev_u32 v253, s82, v253
    v_subrev_u32 v254, s82, v254
    v_subrev_u32 v255, s82, v255
    ds_read_b128 a[160:163], v252 offset:32768
    v_mfma_f32_32x32x16_bf16 v[144:159], a[16:19], a[180:183], v[144:159]
    ds_read_b128 a[164:167], v252 offset:36864
    s_waitcnt lgkmcnt(6)
    buffer_store_dwordx4 v[192:195], v20, s[48:51], s36 offen sc1
    s_waitcnt lgkmcnt(4)
    v_mul_f32 v96, v64, v96
    v_mul_f32 v112, v64, v112
    v_mul_f32 v97, v65, v97
    v_mul_f32 v113, v65, v113
    v_mul_f32 v98, v66, v98
    v_mul_f32 v114, v66, v114
    v_mul_f32 v99, v67, v99
    v_mul_f32 v115, v67, v115
    v_mul_f32 v100, v68, v100
    v_mul_f32 v116, v68, v116
    v_mul_f32 v101, v69, v101
    v_mul_f32 v117, v69, v117
    v_mfma_f32_32x32x16_bf16 v[128:143], a[20:23], a[184:187], v[128:143]
    ds_read_b128 a[168:171], v253 offset:32768
    buffer_load_dwordx4 v8, s[56:59], s12 offen offset:3072 lds
    v_mul_f32 v102, v70, v102
    v_mul_f32 v118, v70, v118
    v_mul_f32 v103, v71, v103
    v_mul_f32 v119, v71, v119
    v_mul_f32 v104, v72, v104
    v_mul_f32 v120, v72, v120
    v_mul_f32 v105, v73, v105
    v_mul_f32 v121, v73, v121
    v_mul_f32 v106, v74, v106
    v_mul_f32 v122, v74, v122
    v_mul_f32 v107, v75, v107
    v_mul_f32 v123, v75, v123
    v_mul_f32 v108, v76, v108
    v_mul_f32 v124, v76, v124
    v_mfma_f32_32x32x16_bf16 v[144:159], a[20:23], a[188:191], v[144:159]
    s_lshr_b32 m0, s82, 1
    s_add_u32 m0, m0, 151552
    ds_read_b128 a[172:175], v253 offset:36864
    buffer_load_dwordx4 v20, s[48:51], s44 offen offset:0 sc1 lds
    v_mul_f32 v109, v77, v109
    v_mul_f32 v125, v77, v125
    v_mul_f32 v110, v78, v110
    v_mul_f32 v126, v78, v126
    v_mul_f32 v111, v79, v111
    v_mul_f32 v127, v79, v127
    v_fma_f32 v62, v28, v96, v97
    v_fma_f32 v63, v28, v112, v113
    v_fmac_f32 v62, v30, v112
    v_fmac_f32 v63, v29, v96
    s_waitcnt lgkmcnt(4)
    v_mfma_f32_32x32x16_bf16 v[128:143], a[24:27], a[192:195], v[128:143]
    ds_read_b128 a[176:179], v254 offset:32768
    buffer_load_dwordx4 v20, s[48:51], s44 offen offset:1024 sc1 lds
    v_fma_f32 v60, v28, v62, v98
    v_fma_f32 v61, v28, v63, v114
    v_fmac_f32 v60, v30, v63
    v_fmac_f32 v61, v29, v62
    v_fma_f32 v62, v28, v60, v99
    v_fma_f32 v63, v28, v61, v115
    v_fmac_f32 v62, v30, v61
    v_fmac_f32 v63, v29, v60
    v_fma_f32 v60, v28, v62, v100
    v_fma_f32 v61, v28, v63, v116
    v_fmac_f32 v60, v30, v63
    v_fmac_f32 v61, v29, v62
    v_fma_f32 v62, v28, v60, v101
    v_fma_f32 v63, v28, v61, v117
    v_mfma_f32_32x32x16_bf16 v[144:159], a[24:27], a[196:199], v[144:159]
    ds_read_b128 a[180:183], v254 offset:36864
    buffer_store_dwordx4 v[196:199], v20, s[48:51], s37 offen sc1
    v_fmac_f32 v62, v30, v61
    v_fmac_f32 v63, v29, v60
    v_fma_f32 v60, v28, v62, v102
    v_fma_f32 v61, v28, v63, v118
    v_fmac_f32 v60, v30, v63
    v_fmac_f32 v61, v29, v62
    v_fma_f32 v62, v28, v60, v103
    v_fma_f32 v63, v28, v61, v119
    v_fmac_f32 v62, v30, v61
    v_fmac_f32 v63, v29, v60
    v_fma_f32 v60, v28, v62, v104
    v_fma_f32 v61, v28, v63, v120
    v_fmac_f32 v60, v30, v63
    v_mfma_f32_32x32x16_bf16 v[128:143], a[28:31], a[200:203], v[128:143]
    s_add_u32 m0, s82, 65536
    s_add_u32 s12, s12, 221184
    ds_read_b128 a[184:187], v255 offset:32768
    buffer_load_dwordx4 v7, s[52:55], s12 offen offset:0 lds
    v_fmac_f32 v61, v29, v62
    v_fma_f32 v62, v28, v60, v105
    v_fma_f32 v63, v28, v61, v121
    v_fmac_f32 v62, v30, v61
    v_fmac_f32 v63, v29, v60
    v_fma_f32 v60, v28, v62, v106
    v_fma_f32 v61, v28, v63, v122
    v_fmac_f32 v60, v30, v63
    v_fmac_f32 v61, v29, v62
    v_fma_f32 v62, v28, v60, v107
    v_fma_f32 v63, v28, v61, v123
    v_fmac_f32 v62, v30, v61
    v_mfma_f32_32x32x16_bf16 v[144:159], a[28:31], a[204:207], v[144:159]
    ds_read_b128 a[188:191], v255 offset:36864
    v_fmac_f32 v63, v29, v60
    v_fma_f32 v60, v28, v62, v108
    v_fma_f32 v61, v28, v63, v124
    v_fmac_f32 v60, v30, v63
    v_fmac_f32 v61, v29, v62
    v_fma_f32 v62, v28, v60, v109
    v_fma_f32 v63, v28, v61, v125
    v_fmac_f32 v62, v30, v61
    v_fmac_f32 v63, v29, v60
    v_fma_f32 v60, v28, v62, v110
    v_fma_f32 v61, v28, v63, v126
    v_fmac_f32 v60, v30, v63
    v_fmac_f32 v61, v29, v62
    v_fma_f32 v62, v28, v60, v111
    s_waitcnt lgkmcnt(4)
    v_mfma_f32_32x32x16_bf16 v[128:143], a[32:35], a[160:163], v[128:143]
    ds_read_b128 a[192:195], v252 offset:40960
    v_fma_f32 v63, v28, v61, v127
    v_fmac_f32 v62, v30, v61
    v_fmac_f32 v63, v29, v60
    v_mfma_f32_32x32x16_bf16 v[144:159], a[32:35], a[164:167], v[144:159]
    ds_read_b128 a[196:199], v252 offset:45056
    buffer_store_dwordx4 v[200:203], v20, s[48:51], s38 offen sc1
    ds_write_b64 v21, v[62:63] offset:0
    v_mfma_f32_32x32x16_bf16 v[128:143], a[36:39], a[168:171], v[128:143]
    ds_read_b128 a[200:203], v253 offset:40960
    buffer_load_dwordx4 v8, s[52:55], s12 offen offset:1024 lds
    v_mfma_f32_32x32x16_bf16 v[144:159], a[36:39], a[172:175], v[144:159]
    ds_read_b128 a[204:207], v253 offset:45056
    s_waitcnt lgkmcnt(5)
    v_mfma_f32_32x32x16_bf16 v[128:143], a[40:43], a[176:179], v[128:143]
    ds_read_b128 a[160:163], v254 offset:40960
    s_waitcnt lgkmcnt(3)
    s_barrier
    ds_read_b64 v[64:65], v22 offset:0
    ds_read_b64 v[66:67], v22 offset:256
    v_mfma_f32_32x32x16_bf16 v[144:159], a[40:43], a[180:183], v[144:159]
    ds_read_b128 a[164:167], v254 offset:45056
    buffer_store_dwordx4 v[204:207], v20, s[48:51], s39 offen sc1
    ds_read_b64 v[68:69], v22 offset:512
    ds_read_b64 v[70:71], v22 offset:768
    v_mfma_f32_32x32x16_bf16 v[128:143], a[44:47], a[184:187], v[128:143]
    ds_read_b128 a[168:171], v255 offset:40960
    buffer_load_dwordx4 v7, s[56:59], s12 offen offset:2048 lds
    ds_read_b64 v[72:73], v22 offset:1024
    ds_read_b64 v[74:75], v22 offset:1280
    v_mfma_f32_32x32x16_bf16 v[144:159], a[44:47], a[188:191], v[144:159]
    ds_read_b128 a[172:175], v255 offset:45056
    ds_read_b64 v[76:77], v22 offset:1536
    ds_read_b64 v[78:79], v22 offset:1792
    s_waitcnt lgkmcnt(12)
    v_mfma_f32_32x32x16_bf16 v[128:143], a[48:51], a[192:195], v[128:143]
    s_barrier
    ds_read_b128 a[176:179], v15 offset:32768
    v_mfma_f32_32x32x16_bf16 v[144:159], a[48:51], a[196:199], v[144:159]
    ds_read_b128 a[180:183], v15 offset:36864
    v_mfma_f32_32x32x16_bf16 v[128:143], a[52:55], a[200:203], v[128:143]
    ds_read_b128 a[184:187], v16 offset:32768
    buffer_load_dwordx4 v8, s[56:59], s12 offen offset:3072 lds
    v_mfma_f32_32x32x16_bf16 v[144:159], a[52:55], a[204:207], v[144:159]
    ds_read_b128 a[188:191], v16 offset:36864
    s_waitcnt vmcnt(7)
    s_waitcnt lgkmcnt(4)
    v_fmac_f32 v66, v34, v64
    v_fmac_f32 v67, v34, v65
    v_fma_f32 v66, -v35, v65, v66
    v_fmac_f32 v67, v35, v64
    v_fmac_f32 v68, v34, v66
    v_fmac_f32 v69, v34, v67
    v_fma_f32 v68, -v35, v67, v68
    v_fmac_f32 v69, v35, v66
    v_fmac_f32 v70, v34, v68
    v_fmac_f32 v71, v34, v69
    v_fma_f32 v70, -v35, v69, v70
    v_fmac_f32 v71, v35, v68
    v_mfma_f32_32x32x16_bf16 v[128:143], a[56:59], a[160:163], v[128:143]
    ds_read_b128 a[192:195], v17 offset:32768
    v_fmac_f32 v72, v34, v70
    v_fmac_f32 v73, v34, v71
    v_fma_f32 v72, -v35, v71, v72
    v_fmac_f32 v73, v35, v70
    v_fmac_f32 v74, v34, v72
    v_fmac_f32 v75, v34, v73
    v_fma_f32 v74, -v35, v73, v74
    v_fmac_f32 v75, v35, v72
    v_fmac_f32 v76, v34, v74
    v_fmac_f32 v77, v34, v75
    v_fma_f32 v76, -v35, v75, v76
    v_fmac_f32 v77, v35, v74
    v_fmac_f32 v78, v34, v76
    v_fmac_f32 v79, v34, v77
    v_fma_f32 v78, -v35, v77, v78
    v_mfma_f32_32x32x16_bf16 v[144:159], a[56:59], a[164:167], v[144:159]
    ds_read_b128 a[196:199], v17 offset:36864
    v_fmac_f32 v79, v35, v76
    v_and_b32 v60, s31, v78
    v_mov_b32 v61, v26
    v_and_b32 v62, s31, v79
    v_mov_b32 v63, v26
    v_mfma_f32_32x32x16_bf16 v[128:143], a[60:63], a[168:171], v[128:143]
    s_add_u32 m0, s82, 16384
    s_add_u32 s12, s12, 221184
    ds_read_b128 a[200:203], v18 offset:32768
    buffer_load_dwordx4 v7, s[52:55], s12 offen offset:0 lds
    v_mfma_f32_32x32x16_bf16 v[144:159], a[60:63], a[172:175], v[144:159]
    ds_read_b128 a[204:207], v18 offset:36864
    buffer_store_dwordx4 v[60:63], v23, s[64:67], 0 offen sc1
    v_cndmask_b32 v42, v42, v64, s[84:85]
    v_cndmask_b32 v43, v43, v65, s[84:85]
    v_cndmask_b32 v42, v42, v66, s[86:87]
    v_cndmask_b32 v43, v43, v67, s[86:87]
    v_cndmask_b32 v42, v42, v68, s[88:89]
    v_cndmask_b32 v43, v43, v69, s[88:89]
    v_cndmask_b32 v42, v42, v70, s[90:91]
    v_cndmask_b32 v43, v43, v71, s[90:91]
    v_cndmask_b32 v42, v42, v72, s[92:93]
    v_cndmask_b32 v43, v43, v73, s[92:93]
    v_cndmask_b32 v42, v42, v74, s[94:95]
    v_cndmask_b32 v43, v43, v75, s[94:95]
    s_waitcnt lgkmcnt(4)
    v_mfma_f32_32x32x16_bf16 v[128:143], a[64:67], a[176:179], v[128:143]
    ds_read_b128 a[160:163], v15 offset:40960
    v_cndmask_b32 v42, v42, v76, s[96:97]
    v_cndmask_b32 v43, v43, v77, s[96:97]
    v_mul_f32 v3, v31, v96
    v_fmac_f32 v3, v32, v112
    v_mul_f32 v112, v33, v112
    v_fmac_f32 v112, v32, v96
    v_mul_f32 v96, v31, v97
    v_fmac_f32 v96, v32, v113
    v_mul_f32 v113, v33, v113
    v_fmac_f32 v113, v32, v97
    v_mul_f32 v97, v31, v98
    v_fmac_f32 v97, v32, v114
    v_mul_f32 v114, v33, v114
    v_fmac_f32 v114, v32, v98
    v_mul_f32 v98, v31, v99
    v_mfma_f32_32x32x16_bf16 v[144:159], a[64:67], a[180:183], v[144:159]
    ds_read_b128 a[164:167], v15 offset:45056
    v_fmac_f32 v98, v32, v115
    v_mul_f32 v115, v33, v115
    v_fmac_f32 v115, v32, v99
    v_mul_f32 v99, v31, v100
    v_fmac_f32 v99, v32, v116
    v_mul_f32 v116, v33, v116
    v_fmac_f32 v116, v32, v100
    v_mul_f32 v100, v31, v101
    v_fmac_f32 v100, v32, v117
    v_mul_f32 v117, v33, v117
    v_fmac_f32 v117, v32, v101
    v_mul_f32 v101, v31, v102
    v_fmac_f32 v101, v32, v118
    v_mul_f32 v118, v33, v118
    v_fmac_f32 v118, v32, v102
    v_mfma_f32_32x32x16_bf16 v[128:143], a[68:71], a[184:187], v[128:143]
    ds_read_b128 a[168:171], v16 offset:40960
    buffer_load_dwordx4 v8, s[52:55], s12 offen offset:1024 lds
    v_mul_f32 v102, v31, v103
    v_fmac_f32 v102, v32, v119
    v_mul_f32 v119, v33, v119
    v_fmac_f32 v119, v32, v103
    v_mul_f32 v103, v31, v104
    v_fmac_f32 v103, v32, v120
    v_mul_f32 v120, v33, v120
    v_fmac_f32 v120, v32, v104
    v_mul_f32 v104, v31, v105
    v_fmac_f32 v104, v32, v121
    v_mul_f32 v121, v33, v121
    v_fmac_f32 v121, v32, v105
    v_mul_f32 v105, v31, v106
    v_fmac_f32 v105, v32, v122
    v_mfma_f32_32x32x16_bf16 v[144:159], a[68:71], a[188:191], v[144:159]
    ds_read_b128 a[172:175], v16 offset:45056
    v_mul_f32 v122, v33, v122
    v_fmac_f32 v122, v32, v106
    v_mul_f32 v106, v31, v107
    v_fmac_f32 v106, v32, v123
    v_mul_f32 v123, v33, v123
    v_fmac_f32 v123, v32, v107
    v_mul_f32 v107, v31, v108
    v_fmac_f32 v107, v32, v124
    v_mul_f32 v124, v33, v124
    v_fmac_f32 v124, v32, v108
    v_mul_f32 v108, v31, v109
    v_fmac_f32 v108, v32, v125
    v_mul_f32 v125, v33, v125
    v_fmac_f32 v125, v32, v109
    s_waitcnt lgkmcnt(4)
    v_mfma_f32_32x32x16_bf16 v[128:143], a[72:75], a[192:195], v[128:143]
    ds_read_b128 a[176:179], v17 offset:40960
    s_waitcnt vmcnt(5)
    s_barrier
    buffer_store_dword v26, v92, s[76:79], 0 offen sc1
    v_mul_f32 v109, v31, v110
    v_fmac_f32 v109, v32, v126
    v_mul_f32 v126, v33, v126
    v_fmac_f32 v126, v32, v110
    v_mul_f32 v110, v31, v111
    v_fmac_f32 v110, v32, v127
    v_mul_f32 v127, v33, v127
    v_fmac_f32 v127, v32, v111
    s_lshl_b32 s14, s4, 1
    s_lshr_b32 s80, s3, 1
    s_add_u32 s14, s14, s80
    v_mfma_f32_32x32x16_bf16 v[144:159], a[72:75], a[196:199], v[144:159]
    ds_read_b128 a[180:183], v17 offset:45056
    s_mul_i32 s14, s14, 385024
    s_and_b32 s80, s3, 1
    s_lshl_b32 s80, s80, 11
    s_add_u32 s14, s14, s80
    s_add_u32 s14, s14, 4194304
    s_and_b32 s80, s2, 1
    s_lshl_b32 s81, s8, 1
    s_add_u32 s81, s81, s80
    s_lshl_b32 s80, s80, 2
    s_add_u32 s80, s80, s3
    s_mul_i32 s20, s9, 94
    s_add_u32 s20, s20, s80
    s_mul_i32 s20, s20, 5120
    s_add_u32 s20, s20, 20971520
    s_lshl_b32 s80, s80, 12
    v_mfma_f32_32x32x16_bf16 v[128:143], a[76:79], a[200:203], v[128:143]
    ds_read_b128 a[184:187], v18 offset:40960
    buffer_load_dwordx4 v7, s[56:59], s12 offen offset:2048 lds
    s_add_u32 s80, s80, 4194304
    s_mul_i32 s19, s81, 385024
    s_add_u32 s19, s19, s80
    s_xor_b32 s18, s81, 1
    s_mul_i32 s18, s18, 385024
    s_add_u32 s18, s18, s80
    s_lshl_b32 s81, s81, 2
    s_add_u32 s81, s81, s3
    s_lshl_b32 s24, s81, 7
    s_add_u32 s24, s24, 26218496
    s_mul_i32 s26, s81, 20480
    s_mul_i32 s25, s9, 160
    s_add_u32 s26, s26, s25
    s_lshl_b32 s21, s26, 1
    v_mfma_f32_32x32x16_bf16 v[144:159], a[76:79], a[204:207], v[144:159]
    ds_read_b128 a[188:191], v18 offset:45056
    s_lshl_b32 s80, s2, 2
    s_add_u32 s80, s80, s3
    s_mul_i32 s22, s80, 3584
    s_add_u32 s22, s22, 28311552
    s_xor_b32 s80, s80, 4
    s_mul_i32 s23, s80, 3584
    s_add_u32 s23, s23, 28311552
    s_mov_b32 s28, -1
    s_mov_b32 s29, 0xfff
    s_lshl_b32 s80, s3, 4
    s_lshr_b64 s[28:29], s[28:29], s80
    s_and_b32 s28, s28, 0xffff
    s_waitcnt lgkmcnt(4)
    v_mfma_f32_32x32x16_bf16 v[128:143], a[80:83], a[160:163], v[128:143]
    ds_read_b128 a[192:195], v252 offset:49152
    s_mul_i32 s70, s7, 8704
    s_add_u32 s70, s70, 25014272
    s_add_u32 s68, s46, s70
    s_addc_u32 s69, s47, 0
    s_mov_b32 s70, 160256
    s_mov_b32 s71, 0x00020000
    v_mfma_f32_32x32x16_bf16 v[144:159], a[80:83], a[164:167], v[144:159]
    ds_read_b128 a[196:199], v252 offset:53248
    v_mfma_f32_32x32x16_bf16 v[128:143], a[84:87], a[168:171], v[128:143]
    ds_read_b128 a[200:203], v253 offset:49152
    buffer_load_dwordx4 v8, s[56:59], s12 offen offset:3072 lds
    v_mfma_f32_32x32x16_bf16 v[144:159], a[84:87], a[172:175], v[144:159]
    ds_read_b128 a[204:207], v253 offset:53248
    s_waitcnt lgkmcnt(4)
    v_mfma_f32_32x32x16_bf16 v[128:143], a[88:91], a[176:179], v[128:143]
    ds_read_b128 a[160:163], v254 offset:49152
    v_mfma_f32_32x32x16_bf16 v[144:159], a[88:91], a[180:183], v[144:159]
    ds_read_b128 a[164:167], v254 offset:53248
    v_mfma_f32_32x32x16_bf16 v[128:143], a[92:95], a[184:187], v[128:143]
    s_add_u32 m0, s82, 0
    s_add_u32 s12, s12, 221184
    ds_read_b128 a[168:171], v255 offset:49152
    buffer_load_dwordx4 v7, s[52:55], s12 offen offset:0 lds
    v_mfma_f32_32x32x16_bf16 v[144:159], a[92:95], a[188:191], v[144:159]
    ds_read_b128 a[172:175], v255 offset:53248
    s_waitcnt lgkmcnt(4)
    v_mfma_f32_32x32x16_bf16 v[128:143], a[96:99], a[192:195], v[128:143]
    ds_read_b128 a[176:179], v252 offset:57344
    v_mfma_f32_32x32x16_bf16 v[144:159], a[96:99], a[196:199], v[144:159]
    ds_read_b128 a[180:183], v252 offset:61440
    v_mfma_f32_32x32x16_bf16 v[128:143], a[100:103], a[200:203], v[128:143]
    ds_read_b128 a[184:187], v253 offset:57344
    buffer_load_dwordx4 v8, s[52:55], s12 offen offset:1024 lds
    v_mfma_f32_32x32x16_bf16 v[144:159], a[100:103], a[204:207], v[144:159]
    ds_read_b128 a[188:191], v253 offset:61440
    s_waitcnt lgkmcnt(4)
    v_mfma_f32_32x32x16_bf16 v[128:143], a[104:107], a[160:163], v[128:143]
    ds_read_b128 a[192:195], v254 offset:57344
    v_mfma_f32_32x32x16_bf16 v[144:159], a[104:107], a[164:167], v[144:159]
    ds_read_b128 a[196:199], v254 offset:61440
    v_mfma_f32_32x32x16_bf16 v[128:143], a[108:111], a[168:171], v[128:143]
    ds_read_b128 a[200:203], v255 offset:57344
    buffer_load_dwordx4 v7, s[56:59], s12 offen offset:2048 lds
    v_mfma_f32_32x32x16_bf16 v[144:159], a[108:111], a[172:175], v[144:159]
    ds_read_b128 a[204:207], v255 offset:61440
    s_waitcnt lgkmcnt(4)
    v_mfma_f32_32x32x16_bf16 v[128:143], a[112:115], a[176:179], v[128:143]
    s_barrier
    ds_read_b128 a[160:163], v252 offset:0
    ds_read_b128 a[208:211], v93 offset:0
    ds_read_b128 a[212:215], v93 offset:1024
    v_mfma_f32_32x32x16_bf16 v[144:159], a[112:115], a[180:183], v[144:159]
    ds_read_b128 a[164:167], v252 offset:4096
    ds_read_b128 a[216:219], v93 offset:2048
    ds_read_b128 a[220:223], v93 offset:3072
    v_mfma_f32_32x32x16_bf16 v[128:143], a[116:119], a[184:187], v[128:143]
    ds_read_b128 a[168:171], v253 offset:0
    buffer_load_dwordx4 v8, s[56:59], s12 offen offset:3072 lds
    v_mfma_f32_32x32x16_bf16 v[144:159], a[116:119], a[188:191], v[144:159]
    ds_read_b128 a[172:175], v253 offset:4096
    s_waitcnt lgkmcnt(8)
    v_mfma_f32_32x32x16_bf16 v[128:143], a[120:123], a[192:195], v[128:143]
    ds_read_b128 a[176:179], v254 offset:0
    s_waitcnt lgkmcnt(3)
    s_barrier
    s_lshr_b32 s80, s82, 1
    s_add_u32 s80, s80, 151552
    v_mov_b32 v60, 0
    v_mov_b32 v61, v26
    v_lshlrev_b32 v160, 3, v1
    v_add_u32 v160, 159744, v160
    v_mfma_f32_32x32x16_bf16 v[144:159], a[120:123], a[196:199], v[144:159]
    s_lshr_b32 m0, s82, 1
    s_add_u32 m0, m0, 151552
    ds_read_b128 a[180:183], v254 offset:4096
    buffer_load_dwordx4 v20, s[64:67], s80 offen offset:0 sc1 lds
    ds_write_b64 v160, v[60:61]
    v_mfma_f32_32x32x16_bf16 v[128:143], a[124:127], a[200:203], v[128:143]
    ds_read_b128 a[184:187], v255 offset:0
    buffer_load_dwordx4 v20, s[64:67], s80 offen offset:1024 sc1 lds
    v_mfma_f32_32x32x16_bf16 v[144:159], a[124:127], a[204:207], v[144:159]
    ds_read_b128 a[188:191], v255 offset:4096
    s_waitcnt lgkmcnt(5)
    v_mfma_f32_32x32x16_bf16 v[128:143], a[128:131], a[160:163], v[128:143]
    ds_read_b128 a[192:195], v252 offset:8192
    v_mfma_f32_32x32x16_bf16 v[144:159], a[128:131], a[164:167], v[144:159]
    ds_read_b128 a[196:199], v252 offset:12288
    v_mfma_f32_32x32x16_bf16 v[128:143], a[132:135], a[168:171], v[128:143]
    s_add_u32 m0, s82, 114688
    s_add_u32 s12, s12, 221184
    ds_read_b128 a[200:203], v253 offset:8192
    buffer_load_dwordx4 v7, s[52:55], s12 offen offset:0 lds
    v_mfma_f32_32x32x16_bf16 v[144:159], a[132:135], a[172:175], v[144:159]
    ds_read_b128 a[204:207], v253 offset:12288
    s_waitcnt lgkmcnt(4)
    v_mfma_f32_32x32x16_bf16 v[128:143], a[136:139], a[176:179], v[128:143]
    ds_read_b128 a[160:163], v254 offset:8192
    v_mfma_f32_32x32x16_bf16 v[144:159], a[136:139], a[180:183], v[144:159]
    ds_read_b128 a[164:167], v254 offset:12288
    v_mfma_f32_32x32x16_bf16 v[128:143], a[140:143], a[184:187], v[128:143]
    ds_read_b128 a[168:171], v255 offset:8192
    buffer_load_dwordx4 v8, s[52:55], s12 offen offset:1024 lds
    v_mfma_f32_32x32x16_bf16 v[144:159], a[140:143], a[188:191], v[144:159]
    ds_read_b128 a[172:175], v255 offset:12288
    s_waitcnt lgkmcnt(4)
    v_mfma_f32_32x32x16_bf16 v[128:143], a[144:147], a[192:195], v[128:143]
    ds_read_b64_tr_b16 a[176:177], v9 offset:49152
    ds_read_b64_tr_b16 a[178:179], v9 offset:49664
    v_mfma_f32_32x32x16_bf16 v[144:159], a[144:147], a[196:199], v[144:159]
    ds_read_b64_tr_b16 a[180:181], v9 offset:51200
    ds_read_b64_tr_b16 a[182:183], v9 offset:51712
    v_mfma_f32_32x32x16_bf16 v[128:143], a[148:151], a[200:203], v[128:143]
    ds_read_b64_tr_b16 a[184:185], v12 offset:49152
    ds_read_b64_tr_b16 a[186:187], v12 offset:49664
    buffer_load_dwordx4 v7, s[56:59], s12 offen offset:2048 lds
    v_mfma_f32_32x32x16_bf16 v[144:159], a[148:151], a[204:207], v[144:159]
    ds_read_b64_tr_b16 a[188:189], v12 offset:51200
    ds_read_b64_tr_b16 a[190:191], v12 offset:51712
    s_waitcnt lgkmcnt(8)
    v_mfma_f32_32x32x16_bf16 v[128:143], a[152:155], a[160:163], v[128:143]
    ds_read_b64_tr_b16 a[192:193], v9 offset:53248
    ds_read_b64_tr_b16 a[194:195], v9 offset:53760
    v_mfma_f32_32x32x16_bf16 v[144:159], a[152:155], a[164:167], v[144:159]
    ds_read_b64_tr_b16 a[196:197], v9 offset:55296
    ds_read_b64_tr_b16 a[198:199], v9 offset:55808
    s_waitcnt vmcnt(3)
    s_barrier
    ds_read_b128 v[160:163], v80
    ds_read_b128 v[164:167], v81
    v_mfma_f32_32x32x16_bf16 v[128:143], a[156:159], a[168:171], v[128:143]
    ds_read_b64_tr_b16 a[200:201], v12 offset:53248
    ds_read_b64_tr_b16 a[202:203], v12 offset:53760
    buffer_load_dwordx4 v8, s[56:59], s12 offen offset:3072 lds
    ds_read_b128 v[168:171], v82
    ds_read_b128 v[172:175], v83
    v_mfma_f32_32x32x16_bf16 v[144:159], a[156:159], a[172:175], v[144:159]
    ds_read_b64_tr_b16 a[204:205], v12 offset:55296
    ds_read_b64_tr_b16 a[206:207], v12 offset:55808
    ds_read_b128 v[176:179], v84
    ds_read_b128 v[180:183], v85
    s_waitcnt lgkmcnt(14)
    v_mfma_f32_32x32x16_bf16 v[192:207], a[176:179], a[0:3], 0
    ds_read_b64_tr_b16 a[160:161], v9 offset:57344
    ds_read_b64_tr_b16 a[162:163], v9 offset:57856
    buffer_load_dword v90, v91, s[76:79], 0 offen offset:0 sc1
    v_mfma_f32_32x32x16_bf16 v[208:223], a[180:183], a[0:3], 0
    ds_read_b64_tr_b16 a[164:165], v9 offset:59392
    ds_read_b64_tr_b16 a[166:167], v9 offset:59904
    v_mfma_f32_32x32x16_bf16 v[224:239], a[184:187], a[0:3], 0
    s_add_u32 m0, s82, 32768
    s_add_u32 s12, s12, 221184
    ds_read_b64_tr_b16 a[168:169], v12 offset:57344
    ds_read_b64_tr_b16 a[170:171], v12 offset:57856
    buffer_load_dwordx4 v7, s[52:55], s12 offen offset:0 lds
    v_mfma_f32_32x32x16_bf16 v[240:255], a[188:191], a[0:3], 0
    ds_read_b64_tr_b16 a[172:173], v12 offset:59392
    ds_read_b64_tr_b16 a[174:175], v12 offset:59904
    s_waitcnt lgkmcnt(10)
    v_mfma_f32_32x32x16_bf16 v[192:207], a[192:195], a[4:7], v[192:207]
    ds_read_b64_tr_b16 a[176:177], v9 offset:61440
    ds_read_b64_tr_b16 a[178:179], v9 offset:61952
    ds_read_b128 v[64:67], v95 offset:0
    ds_read_b128 v[68:71], v95 offset:16
    v_mfma_f32_32x32x16_bf16 v[208:223], a[196:199], a[4:7], v[208:223]
    ds_read_b64_tr_b16 a[180:181], v9 offset:63488
    ds_read_b64_tr_b16 a[182:183], v9 offset:64000
    ds_read_b128 v[72:75], v95 offset:32
    ds_read_b128 v[76:79], v95 offset:48
    v_mfma_f32_32x32x16_bf16 v[224:239], a[200:203], a[4:7], v[224:239]
    ds_read_b64_tr_b16 a[184:185], v12 offset:61440
    ds_read_b64_tr_b16 a[186:187], v12 offset:61952
    buffer_load_dwordx4 v8, s[52:55], s12 offen offset:1024 lds
    v_mfma_f32_32x32x16_bf16 v[240:255], a[204:207], a[4:7], v[240:255]
    ds_read_b64_tr_b16 a[188:189], v12 offset:63488
    ds_read_b64_tr_b16 a[190:191], v12 offset:64000
    s_waitcnt lgkmcnt(12)
    v_mfma_f32_32x32x16_bf16 v[192:207], a[160:163], a[8:11], v[192:207]
    s_barrier
    ds_read_b64_tr_b16 a[192:193], v10 offset:32768
    ds_read_b64_tr_b16 a[194:195], v10 offset:33280
    v_mfma_f32_32x32x16_bf16 v[208:223], a[164:167], a[8:11], v[208:223]
    ds_read_b64_tr_b16 a[196:197], v10 offset:34816
    ds_read_b64_tr_b16 a[198:199], v10 offset:35328
    s_waitcnt lgkmcnt(8)
    v_mul_f32 v128, v64, v128
    v_mul_f32 v144, v64, v144
    v_mul_f32 v129, v65, v129
    v_mul_f32 v145, v65, v145
    v_mul_f32 v130, v66, v130
    v_mul_f32 v146, v66, v146
    v_mul_f32 v131, v67, v131
    v_mul_f32 v147, v67, v147
    v_mul_f32 v132, v68, v132
    v_mul_f32 v148, v68, v148
    v_mul_f32 v133, v69, v133
    v_mul_f32 v149, v69, v149
    v_mul_f32 v134, v70, v134
    v_mfma_f32_32x32x16_bf16 v[224:239], a[168:171], a[8:11], v[224:239]
    ds_read_b64_tr_b16 a[200:201], v13 offset:32768
    ds_read_b64_tr_b16 a[202:203], v13 offset:33280
    buffer_load_dwordx4 v7, s[56:59], s12 offen offset:2048 lds
    v_mul_f32 v150, v70, v150
    v_mul_f32 v135, v71, v135
    v_mul_f32 v151, v71, v151
    v_mul_f32 v136, v72, v136
    v_mul_f32 v152, v72, v152
    v_mul_f32 v137, v73, v137
    v_mul_f32 v153, v73, v153
    v_mul_f32 v138, v74, v138
    v_mul_f32 v154, v74, v154
    v_mul_f32 v139, v75, v139
    v_mul_f32 v155, v75, v155
    v_mul_f32 v140, v76, v140
    v_mul_f32 v156, v76, v156
    v_mfma_f32_32x32x16_bf16 v[240:255], a[172:175], a[8:11], v[240:255]
    ds_read_b64_tr_b16 a[204:205], v13 offset:34816
    ds_read_b64_tr_b16 a[206:207], v13 offset:35328
    v_mul_f32 v141, v77, v141
    v_mul_f32 v157, v77, v157
    v_mul_f32 v142, v78, v142
    v_mul_f32 v158, v78, v158
    v_mul_f32 v143, v79, v143
    v_mul_f32 v159, v79, v159
    v_fma_f32 v62, v44, v128, v129
    v_fma_f32 v63, v44, v144, v145
    v_fmac_f32 v62, v46, v144
    v_fmac_f32 v63, v45, v128
    v_fma_f32 v60, v44, v62, v130
    v_fma_f32 v61, v44, v63, v146
    v_fmac_f32 v60, v46, v63
    s_waitcnt lgkmcnt(8)
    v_mfma_f32_32x32x16_bf16 v[192:207], a[176:179], a[12:15], v[192:207]
    ds_read_b64_tr_b16 a[160:161], v10 offset:36864
    ds_read_b64_tr_b16 a[162:163], v10 offset:37376
    v_fmac_f32 v61, v45, v62
    v_fma_f32 v62, v44, v60, v131
    v_fma_f32 v63, v44, v61, v147
    v_fmac_f32 v62, v46, v61
    v_fmac_f32 v63, v45, v60
    v_fma_f32 v60, v44, v62, v132
    v_fma_f32 v61, v44, v63, v148
    v_fmac_f32 v60, v46, v63
    v_fmac_f32 v61, v45, v62
    v_fma_f32 v62, v44, v60, v133
    v_fma_f32 v63, v44, v61, v149
    v_fmac_f32 v62, v46, v61
    v_fmac_f32 v63, v45, v60
    v_fma_f32 v60, v44, v62, v134
    v_mfma_f32_32x32x16_bf16 v[208:223], a[180:183], a[12:15], v[208:223]
    ds_read_b64_tr_b16 a[164:165], v10 offset:38912
    ds_read_b64_tr_b16 a[166:167], v10 offset:39424
    v_fma_f32 v61, v44, v63, v150
    v_fmac_f32 v60, v46, v63
    v_fmac_f32 v61, v45, v62
    v_fma_f32 v62, v44, v60, v135
    v_fma_f32 v63, v44, v61, v151
    v_fmac_f32 v62, v46, v61
    v_fmac_f32 v63, v45, v60
    v_fma_f32 v60, v44, v62, v136
    v_fma_f32 v61, v44, v63, v152
    v_fmac_f32 v60, v46, v63
    v_fmac_f32 v61, v45, v62
    v_fma_f32 v62, v44, v60, v137
    v_fma_f32 v63, v44, v61, v153
    v_fmac_f32 v62, v46, v61
    v_mfma_f32_32x32x16_bf16 v[224:239], a[184:187], a[12:15], v[224:239]
    ds_read_b64_tr_b16 a[168:169], v13 offset:36864
    ds_read_b64_tr_b16 a[170:171], v13 offset:37376
    buffer_load_dwordx4 v8, s[56:59], s12 offen offset:3072 lds
    v_fmac_f32 v63, v45, v60
    v_fma_f32 v60, v44, v62, v138
    v_fma_f32 v61, v44, v63, v154
    v_fmac_f32 v60, v46, v63
    v_fmac_f32 v61, v45, v62
    v_fma_f32 v62, v44, v60, v139
    v_fma_f32 v63, v44, v61, v155
    v_fmac_f32 v62, v46, v61
    v_fmac_f32 v63, v45, v60
    v_fma_f32 v60, v44, v62, v140
    v_fma_f32 v61, v44, v63, v156
    v_fmac_f32 v60, v46, v63
    v_fmac_f32 v61, v45, v62
    v_mfma_f32_32x32x16_bf16 v[240:255], a[188:191], a[12:15], v[240:255]
    ds_read_b64_tr_b16 a[172:173], v13 offset:38912
    ds_read_b64_tr_b16 a[174:175], v13 offset:39424
    v_fma_f32 v62, v44, v60, v141
    v_fma_f32 v63, v44, v61, v157
    v_fmac_f32 v62, v46, v61
    v_fmac_f32 v63, v45, v60
    v_fma_f32 v60, v44, v62, v142
    v_fma_f32 v61, v44, v63, v158
    v_fmac_f32 v60, v46, v63
    v_fmac_f32 v61, v45, v62
    v_fma_f32 v62, v44, v60, v143
    v_fma_f32 v63, v44, v61, v159
    v_fmac_f32 v62, v46, v61
    v_fmac_f32 v63, v45, v60
    s_waitcnt lgkmcnt(8)
    v_mfma_f32_32x32x16_bf16 v[192:207], a[192:195], a[16:19], v[192:207]
    ds_read_b64_tr_b16 a[176:177], v10 offset:40960
    ds_read_b64_tr_b16 a[178:179], v10 offset:41472
    ds_write_b64 v21, v[62:63] offset:2048
    v_mfma_f32_32x32x16_bf16 v[208:223], a[196:199], a[16:19], v[208:223]
    ds_read_b64_tr_b16 a[180:181], v10 offset:43008
    ds_read_b64_tr_b16 a[182:183], v10 offset:43520
    v_mfma_f32_32x32x16_bf16 v[224:239], a[200:203], a[16:19], v[224:239]
    s_add_u32 m0, s82, 81920
    s_add_u32 s12, s12, 221184
    ds_read_b64_tr_b16 a[184:185], v13 offset:40960
    ds_read_b64_tr_b16 a[186:187], v13 offset:41472
    buffer_load_dwordx4 v7, s[52:55], s12 offen offset:0 lds
    v_mfma_f32_32x32x16_bf16 v[240:255], a[204:207], a[16:19], v[240:255]
    ds_read_b64_tr_b16 a[188:189], v13 offset:43008
    ds_read_b64_tr_b16 a[190:191], v13 offset:43520
    s_waitcnt lgkmcnt(6)
    s_barrier
    ds_read_b64 v[64:65], v22 offset:2048
    ds_read_b64 v[66:67], v22 offset:2304
    v_mfma_f32_32x32x16_bf16 v[192:207], a[160:163], a[20:23], v[192:207]
    ds_read_b64_tr_b16 a[192:193], v10 offset:45056
    ds_read_b64_tr_b16 a[194:195], v10 offset:45568
    ds_read_b64 v[68:69], v22 offset:2560
    ds_read_b64 v[70:71], v22 offset:2816
    v_mfma_f32_32x32x16_bf16 v[208:223], a[164:167], a[20:23], v[208:223]
    ds_read_b64_tr_b16 a[196:197], v10 offset:47104
    ds_read_b64_tr_b16 a[198:199], v10 offset:47616
    ds_read_b64 v[72:73], v22 offset:3072
    ds_read_b64 v[74:75], v22 offset:3328
    v_mfma_f32_32x32x16_bf16 v[224:239], a[168:171], a[20:23], v[224:239]
    ds_read_b64_tr_b16 a[200:201], v13 offset:45056
    ds_read_b64_tr_b16 a[202:203], v13 offset:45568
    buffer_load_dwordx4 v8, s[52:55], s12 offen offset:1024 lds
    ds_read_b64 v[76:77], v22 offset:3584
    ds_read_b64 v[78:79], v22 offset:3840
    v_mfma_f32_32x32x16_bf16 v[240:255], a[172:175], a[20:23], v[240:255]
    ds_read_b64_tr_b16 a[204:205], v13 offset:47104
    ds_read_b64_tr_b16 a[206:207], v13 offset:47616
    s_waitcnt lgkmcnt(15)
    v_mfma_f32_32x32x16_bf16 v[192:207], a[176:179], a[24:27], v[192:207]
    ds_read_b64_tr_b16 a[160:161], v10 offset:0
    ds_read_b64_tr_b16 a[162:163], v10 offset:512
    v_mfma_f32_32x32x16_bf16 v[208:223], a[180:183], a[24:27], v[208:223]
    ds_read_b64_tr_b16 a[164:165], v10 offset:2048
    ds_read_b64_tr_b16 a[166:167], v10 offset:2560
    v_mfma_f32_32x32x16_bf16 v[224:239], a[184:187], a[24:27], v[224:239]
    ds_read_b64_tr_b16 a[168:169], v13 offset:0
    ds_read_b64_tr_b16 a[170:171], v13 offset:512
    buffer_load_dwordx4 v7, s[56:59], s12 offen offset:2048 lds
    s_waitcnt lgkmcnt(8)
    v_fmac_f32 v66, v50, v64
    v_fmac_f32 v67, v50, v65
    v_fma_f32 v66, -v51, v65, v66
    v_fmac_f32 v67, v51, v64
    v_fmac_f32 v68, v50, v66
    v_fmac_f32 v69, v50, v67
    v_fma_f32 v68, -v51, v67, v68
    v_fmac_f32 v69, v51, v66
    v_fmac_f32 v70, v50, v68
    v_fmac_f32 v71, v50, v69
    v_fma_f32 v70, -v51, v69, v70
    v_fmac_f32 v71, v51, v68
    v_mfma_f32_32x32x16_bf16 v[240:255], a[188:191], a[24:27], v[240:255]
    ds_read_b64_tr_b16 a[172:173], v13 offset:2048
    ds_read_b64_tr_b16 a[174:175], v13 offset:2560
    v_fmac_f32 v72, v50, v70
    v_fmac_f32 v73, v50, v71
    v_fma_f32 v72, -v51, v71, v72
    v_fmac_f32 v73, v51, v70
    v_fmac_f32 v74, v50, v72
    v_fmac_f32 v75, v50, v73
    v_fma_f32 v74, -v51, v73, v74
    v_fmac_f32 v75, v51, v72
    v_fmac_f32 v76, v50, v74
    v_fmac_f32 v77, v50, v75
    v_fma_f32 v76, -v51, v75, v76
    v_fmac_f32 v77, v51, v74
    v_fmac_f32 v78, v50, v76
    s_waitcnt lgkmcnt(8)
    v_mfma_f32_32x32x16_bf16 v[192:207], a[192:195], a[28:31], v[192:207]
    ds_read_b64_tr_b16 a[176:177], v10 offset:4096
    ds_read_b64_tr_b16 a[178:179], v10 offset:4608
    v_fmac_f32 v79, v50, v77
    v_fma_f32 v78, -v51, v77, v78
    v_fmac_f32 v79, v51, v76
    v_and_b32 v60, s31, v78
    v_mov_b32 v61, v26
    v_and_b32 v62, s31, v79
    v_mov_b32 v63, v26
    v_mfma_f32_32x32x16_bf16 v[208:223], a[196:199], a[28:31], v[208:223]
    ds_read_b64_tr_b16 a[180:181], v10 offset:6144
    ds_read_b64_tr_b16 a[182:183], v10 offset:6656
    buffer_store_dwordx4 v[60:63], v23, s[68:71], 0 offen sc1
    v_cndmask_b32 v58, v58, v64, s[84:85]
    v_cndmask_b32 v59, v59, v65, s[84:85]
    v_cndmask_b32 v58, v58, v66, s[86:87]
    v_cndmask_b32 v59, v59, v67, s[86:87]
    v_cndmask_b32 v58, v58, v68, s[88:89]
    v_cndmask_b32 v59, v59, v69, s[88:89]
    v_cndmask_b32 v58, v58, v70, s[90:91]
    v_cndmask_b32 v59, v59, v71, s[90:91]
    v_cndmask_b32 v58, v58, v72, s[92:93]
    v_cndmask_b32 v59, v59, v73, s[92:93]
    v_cndmask_b32 v58, v58, v74, s[94:95]
    v_cndmask_b32 v59, v59, v75, s[94:95]
    v_mfma_f32_32x32x16_bf16 v[224:239], a[200:203], a[28:31], v[224:239]
    ds_read_b64_tr_b16 a[184:185], v13 offset:4096
    ds_read_b64_tr_b16 a[186:187], v13 offset:4608
    buffer_load_dwordx4 v8, s[56:59], s12 offen offset:3072 lds
    s_waitcnt vmcnt(9)
    v_cmp_ne_u32 vcc, v90, v26
    s_nop 1
    s_cmp_lg_u64 vcc, 0
    s_cbranch_scc1 L_slow_31
L_ok_32:
    s_barrier
    buffer_store_dword v26, v94, s[48:51], 0 offen sc1
    v_cndmask_b32 v58, v58, v76, s[96:97]
    v_cndmask_b32 v59, v59, v77, s[96:97]
    v_mfma_f32_32x32x16_bf16 v[240:255], a[204:207], a[28:31], v[240:255]
    ds_read_b64_tr_b16 a[188:189], v13 offset:6144
    ds_read_b64_tr_b16 a[190:191], v13 offset:6656
    ds_read_b128 v[184:187], v86
    ds_read_b128 v[188:191], v87
    s_waitcnt lgkmcnt(10)
    v_mfma_f32_32x32x16_bf16 v[192:207], a[160:163], a[32:35], v[192:207]
    s_add_u32 s45, s20, 0
    ds_read_b64_tr_b16 a[192:193], v10 offset:8192
    ds_read_b64_tr_b16 a[194:195], v10 offset:8704
    buffer_load_dwordx4 a[224:227], v20, s[48:51], s45 offen offset:0 sc1
    v_mfma_f32_32x32x16_bf16 v[208:223], a[164:167], a[32:35], v[208:223]
    ds_read_b64_tr_b16 a[196:197], v10 offset:10240
    ds_read_b64_tr_b16 a[198:199], v10 offset:10752
    v_mfma_f32_32x32x16_bf16 v[224:239], a[168:171], a[32:35], v[224:239]
    s_add_u32 m0, s82, 131072
    s_add_u32 s12, s12, 221184
    ds_read_b64_tr_b16 a[200:201], v13 offset:8192
    ds_read_b64_tr_b16 a[202:203], v13 offset:8704
    buffer_load_dwordx4 v7, s[52:55], s12 offen offset:0 lds
    v_mfma_f32_32x32x16_bf16 v[240:255], a[172:175], a[32:35], v[240:255]
    ds_read_b64_tr_b16 a[204:205], v13 offset:10240
    ds_read_b64_tr_b16 a[206:207], v13 offset:10752
    s_waitcnt lgkmcnt(8)
    v_bitop3_b32 v161, v161, v163, v26 bitop3:0x7e
    v_bitop3_b32 v165, v165, v167, v26 bitop3:0x7e
    v_bitop3_b32 v169, v169, v171, v26 bitop3:0x7e
    v_bitop3_b32 v173, v173, v175, v26 bitop3:0x7e
    v_bitop3_b32 v177, v177, v179, v26 bitop3:0x7e
    v_bitop3_b32 v181, v181, v183, v26 bitop3:0x7e
    v_bitop3_b32 v185, v185, v187, v26 bitop3:0x7e
    v_bitop3_b32 v189, v189, v191, v26 bitop3:0x7e
    v_or3_b32 v161, v161, v165, v169
    v_or3_b32 v173, v173, v177, v181
    v_or3_b32 v161, v161, v185, v189
    v_or_b32 v161, v161, v173
    v_mfma_f32_32x32x16_bf16 v[192:207], a[176:179], a[36:39], v[192:207]
    ds_read_b64_tr_b16 a[160:161], v10 offset:12288
    ds_read_b64_tr_b16 a[162:163], v10 offset:12800
    buffer_load_dwordx4 a[228:231], v20, s[48:51], s45 offen offset:1024 sc1
    v_cmp_ne_u32 vcc, 0, v161
    s_nop 1
    s_cmp_lg_u64 vcc, 0
    s_cbranch_scc1 L_slow_33
L_ok_34:
    v_fmac_f32 v184, v38, v188
    v_fmac_f32 v186, v38, v190
    v_fma_f32 v184, -v39, v190, v184
    v_fmac_f32 v186, v39, v188
    v_fmac_f32 v180, v38, v184
    v_fmac_f32 v182, v38, v186
    v_fma_f32 v180, -v39, v186, v180
    v_fmac_f32 v182, v39, v184
    v_fmac_f32 v176, v38, v180
    v_mfma_f32_32x32x16_bf16 v[208:223], a[180:183], a[36:39], v[208:223]
    ds_read_b64_tr_b16 a[164:165], v10 offset:14336
    ds_read_b64_tr_b16 a[166:167], v10 offset:14848
    v_fmac_f32 v178, v38, v182
    v_fma_f32 v176, -v39, v182, v176
    v_fmac_f32 v178, v39, v180
    v_fmac_f32 v172, v38, v176
    v_fmac_f32 v174, v38, v178
    v_fma_f32 v172, -v39, v178, v172
    v_fmac_f32 v174, v39, v176
    v_fmac_f32 v168, v38, v172
    v_fmac_f32 v170, v38, v174
    v_fma_f32 v168, -v39, v174, v168
    v_fmac_f32 v170, v39, v172
    v_fmac_f32 v164, v38, v168
    v_fmac_f32 v166, v38, v170
    v_fma_f32 v164, -v39, v170, v164
    v_mfma_f32_32x32x16_bf16 v[224:239], a[184:187], a[36:39], v[224:239]
    ds_read_b64_tr_b16 a[168:169], v13 offset:12288
    ds_read_b64_tr_b16 a[170:171], v13 offset:12800
    buffer_load_dwordx4 v8, s[52:55], s12 offen offset:1024 lds
    v_fmac_f32 v166, v39, v168
    v_fmac_f32 v160, v38, v164
    v_fmac_f32 v162, v38, v166
    v_fma_f32 v160, -v39, v166, v160
    v_fmac_f32 v162, v39, v164
    v_mov_b32 v164, v160
    v_mov_b32 v166, v162
    s_lshl_b32 s80, s6, 13
    s_add_u32 s80, s80, s14
    v_permlane32_swap_b32 v160, v164
    v_permlane32_swap_b32 v162, v166
    s_add_u32 s80, s80, 90112
    s_add_u32 s81, s80, 4096
    v_mfma_f32_32x32x16_bf16 v[240:255], a[188:191], a[36:39], v[240:255]
    ds_read_b64_tr_b16 a[172:173], v13 offset:14336
    ds_read_b64_tr_b16 a[174:175], v13 offset:14848
    v_fmac_f32 v160, v36, v164
    v_fmac_f32 v162, v36, v166
    v_fma_f32 v160, -v37, v166, v160
    v_fmac_f32 v162, v37, v164
    v_fmac_f32 v42, v40, v160
    v_fmac_f32 v43, v40, v162
    v_fma_f32 v42, -v41, v162, v42
    v_fmac_f32 v43, v41, v160
    v_mul_f32 v160, v31, v42
    v_mul_f32 v161, v32, v42
    v_fmac_f32 v160, v32, v43
    v_fmac_f32 v161, v33, v43
    v_fmac_f32 v3, v28, v160
    s_waitcnt lgkmcnt(8)
    v_mfma_f32_32x32x16_bf16 v[192:207], a[192:195], a[40:43], v[192:207]
    s_barrier
    ds_read_b64_tr_b16 a[176:177], v9 offset:16384
    ds_read_b64_tr_b16 a[178:179], v9 offset:16896
    buffer_load_dwordx4 a[232:235], v20, s[48:51], s45 offen offset:2048 sc1
    v_fmac_f32 v112, v28, v161
    v_fmac_f32 v3, v29, v161
    v_fmac_f32 v112, v30, v160
    v_fmac_f32 v96, v28, v3
    v_fmac_f32 v113, v28, v112
    v_fmac_f32 v96, v29, v112
    v_fmac_f32 v113, v30, v3
    v_fmac_f32 v97, v28, v96
    v_fmac_f32 v114, v28, v113
    v_fmac_f32 v97, v29, v113
    v_fmac_f32 v114, v30, v96
    v_fmac_f32 v98, v28, v97
    v_mfma_f32_32x32x16_bf16 v[208:223], a[196:199], a[40:43], v[208:223]
    ds_read_b64_tr_b16 a[180:181], v9 offset:18432
    ds_read_b64_tr_b16 a[182:183], v9 offset:18944
    v_fmac_f32 v115, v28, v114
    v_fmac_f32 v98, v29, v114
    v_fmac_f32 v115, v30, v97
    v_fmac_f32 v99, v28, v98
    v_fmac_f32 v116, v28, v115
    v_fmac_f32 v99, v29, v115
    v_fmac_f32 v116, v30, v98
    v_fmac_f32 v100, v28, v99
    v_fmac_f32 v117, v28, v116
    v_fmac_f32 v100, v29, v116
    v_fmac_f32 v117, v30, v99
    v_fmac_f32 v101, v28, v100
    v_fmac_f32 v118, v28, v117
    v_fmac_f32 v101, v29, v117
    v_mfma_f32_32x32x16_bf16 v[224:239], a[200:203], a[40:43], v[224:239]
    ds_read_b64_tr_b16 a[184:185], v12 offset:16384
    ds_read_b64_tr_b16 a[186:187], v12 offset:16896
    buffer_load_dwordx4 v7, s[56:59], s12 offen offset:2048 lds
    v_fmac_f32 v118, v30, v100
    v_fmac_f32 v102, v28, v101
    v_fmac_f32 v119, v28, v118
    v_fmac_f32 v102, v29, v118
    v_fmac_f32 v119, v30, v101
    v_fmac_f32 v103, v28, v102
    v_fmac_f32 v120, v28, v119
    v_fmac_f32 v103, v29, v119
    v_fmac_f32 v120, v30, v102
    v_fmac_f32 v104, v28, v103
    v_fmac_f32 v121, v28, v120
    v_fmac_f32 v104, v29, v120
    v_fmac_f32 v121, v30, v103
    v_mfma_f32_32x32x16_bf16 v[240:255], a[204:207], a[40:43], v[240:255]
    ds_read_b64_tr_b16 a[188:189], v12 offset:18432
    ds_read_b64_tr_b16 a[190:191], v12 offset:18944
    v_fmac_f32 v105, v28, v104
    v_fmac_f32 v122, v28, v121
    v_fmac_f32 v105, v29, v121
    v_fmac_f32 v122, v30, v104
    v_fmac_f32 v106, v28, v105
    v_fmac_f32 v123, v28, v122
    v_fmac_f32 v106, v29, v122
    v_fmac_f32 v123, v30, v105
    v_fmac_f32 v107, v28, v106
    v_fmac_f32 v124, v28, v123
    v_fmac_f32 v107, v29, v123
    v_fmac_f32 v124, v30, v106
    v_fmac_f32 v108, v28, v107
    s_waitcnt lgkmcnt(8)
    v_mfma_f32_32x32x16_bf16 v[192:207], a[160:163], a[44:47], v[192:207]
    ds_read_b64_tr_b16 a[192:193], v9 offset:20480
    ds_read_b64_tr_b16 a[194:195], v9 offset:20992
    buffer_load_dwordx4 a[236:239], v20, s[48:51], s45 offen offset:3072 sc1
    v_fmac_f32 v125, v28, v124
    v_fmac_f32 v108, v29, v124
    v_fmac_f32 v125, v30, v107
    v_fmac_f32 v109, v28, v108
    v_fmac_f32 v126, v28, v125
    v_fmac_f32 v109, v29, v125
    v_fmac_f32 v126, v30, v108
    v_fmac_f32 v110, v28, v109
    v_fmac_f32 v127, v28, v126
    v_fmac_f32 v110, v29, v126
    v_fmac_f32 v127, v30, v109
    v_cvt_pk_bf16_f32 v160, v3, v96
    v_cvt_pk_bf16_f32 v161, v97, v98
    v_mfma_f32_32x32x16_bf16 v[208:223], a[164:167], a[44:47], v[208:223]
    ds_read_b64_tr_b16 a[196:197], v9 offset:22528
    ds_read_b64_tr_b16 a[198:199], v9 offset:23040
    ds_write_b64 v24, v[160:161] offset:0
    v_cvt_pk_bf16_f32 v162, v99, v100
    v_cvt_pk_bf16_f32 v163, v101, v102
    v_mfma_f32_32x32x16_bf16 v[224:239], a[168:171], a[44:47], v[224:239]
    ds_read_b64_tr_b16 a[200:201], v12 offset:20480
    ds_read_b64_tr_b16 a[202:203], v12 offset:20992
    buffer_load_dwordx4 v8, s[56:59], s12 offen offset:3072 lds
    ds_write_b64 v24, v[162:163] offset:8
    v_cvt_pk_bf16_f32 v164, v103, v104
    v_cvt_pk_bf16_f32 v165, v105, v106
    v_mfma_f32_32x32x16_bf16 v[240:255], a[172:175], a[44:47], v[240:255]
    ds_read_b64_tr_b16 a[204:205], v12 offset:22528
    ds_read_b64_tr_b16 a[206:207], v12 offset:23040
    ds_write_b64 v24, v[164:165] offset:16
    v_cvt_pk_bf16_f32 v166, v107, v108
    v_cvt_pk_bf16_f32 v167, v109, v110
    s_waitcnt lgkmcnt(11)
    v_mfma_f32_32x32x16_bf16 v[192:207], a[176:179], a[48:51], v[192:207]
    s_add_u32 s45, s20, 4096
    ds_read_b64_tr_b16 a[160:161], v9 offset:24576
    ds_read_b64_tr_b16 a[162:163], v9 offset:25088
    buffer_load_dwordx4 a[240:243], v20, s[48:51], s45 offen offset:0 sc1
    ds_write_b64 v24, v[166:167] offset:24
    ds_read_b64_tr_b16 v[176:177], v25 offset:0
    v_mfma_f32_32x32x16_bf16 v[208:223], a[180:183], a[48:51], v[208:223]
    ds_read_b64_tr_b16 a[164:165], v9 offset:26624
    ds_read_b64_tr_b16 a[166:167], v9 offset:27136
    ds_read_b64_tr_b16 v[178:179], v25 offset:320
    v_mfma_f32_32x32x16_bf16 v[224:239], a[184:187], a[48:51], v[224:239]
    s_add_u32 m0, s82, 98304
    s_add_u32 s12, s12, 221184
    ds_read_b64_tr_b16 a[168:169], v12 offset:24576
    ds_read_b64_tr_b16 a[170:171], v12 offset:25088
    buffer_load_dwordx4 v7, s[52:55], s12 offen offset:0 lds
    ds_read_b64_tr_b16 v[180:181], v25 offset:32
    ds_read_b64_tr_b16 v[182:183], v25 offset:352
    v_mfma_f32_32x32x16_bf16 v[240:255], a[188:191], a[48:51], v[240:255]
    ds_read_b64_tr_b16 a[172:173], v12 offset:26624
    ds_read_b64_tr_b16 a[174:175], v12 offset:27136
    v_cvt_pk_bf16_f32 v168, v112, v113
    v_cvt_pk_bf16_f32 v169, v114, v115
    s_waitcnt lgkmcnt(14)
    v_mfma_f32_32x32x16_bf16 v[192:207], a[192:195], a[52:55], v[192:207]
    s_add_u32 s45, s20, 40960
    ds_read_b64_tr_b16 a[176:177], v9 offset:28672
    ds_read_b64_tr_b16 a[178:179], v9 offset:29184
    buffer_load_dwordx4 a[244:247], v20, s[48:51], s45 offen offset:0 sc1
    ds_write_b64 v24, v[168:169] offset:0
    v_cvt_pk_bf16_f32 v170, v116, v117
    v_cvt_pk_bf16_f32 v171, v118, v119
    v_mfma_f32_32x32x16_bf16 v[208:223], a[196:199], a[52:55], v[208:223]
    ds_read_b64_tr_b16 a[180:181], v9 offset:30720
    ds_read_b64_tr_b16 a[182:183], v9 offset:31232
    ds_write_b64 v24, v[170:171] offset:8
    v_cvt_pk_bf16_f32 v172, v120, v121
    v_cvt_pk_bf16_f32 v173, v122, v123
    v_mfma_f32_32x32x16_bf16 v[224:239], a[200:203], a[52:55], v[224:239]
    ds_read_b64_tr_b16 a[184:185], v12 offset:28672
    ds_read_b64_tr_b16 a[186:187], v12 offset:29184
    buffer_load_dwordx4 v8, s[52:55], s12 offen offset:1024 lds
    ds_write_b64 v24, v[172:173] offset:16
    v_cvt_pk_bf16_f32 v174, v124, v125
    v_cvt_pk_bf16_f32 v175, v126, v127
    v_mfma_f32_32x32x16_bf16 v[240:255], a[204:207], a[52:55], v[240:255]
    ds_read_b64_tr_b16 a[188:189], v12 offset:30720
    ds_read_b64_tr_b16 a[190:191], v12 offset:31232
    ds_write_b64 v24, v[174:175] offset:24
    ds_read_b64_tr_b16 v[184:185], v25 offset:0
    s_waitcnt lgkmcnt(13)
    v_mfma_f32_32x32x16_bf16 v[192:207], a[160:163], a[56:59], v[192:207]
    ds_read_b64_tr_b16 a[192:193], v9 offset:0
    ds_read_b64_tr_b16 a[194:195], v9 offset:512
    buffer_load_dwordx4 a[248:251], v20, s[48:51], s45 offen offset:1024 sc1
    ds_read_b64_tr_b16 v[186:187], v25 offset:320
    v_mfma_f32_32x32x16_bf16 v[208:223], a[164:167], a[56:59], v[208:223]
    ds_read_b64_tr_b16 a[196:197], v9 offset:2048
    ds_read_b64_tr_b16 a[198:199], v9 offset:2560
    ds_read_b64_tr_b16 v[188:189], v25 offset:32
    ds_read_b64_tr_b16 v[190:191], v25 offset:352
    v_mfma_f32_32x32x16_bf16 v[224:239], a[168:171], a[56:59], v[224:239]
    ds_read_b64_tr_b16 a[200:201], v12 offset:0
    ds_read_b64_tr_b16 a[202:203], v12 offset:512
    buffer_load_dwordx4 v7, s[56:59], s12 offen offset:2048 lds
    v_mfma_f32_32x32x16_bf16 v[240:255], a[172:175], a[56:59], v[240:255]
    ds_read_b64_tr_b16 a[204:205], v12 offset:2048
    ds_read_b64_tr_b16 a[206:207], v12 offset:2560
    s_waitcnt lgkmcnt(13)
    v_mfma_f32_32x32x16_bf16 v[192:207], a[176:179], a[60:63], v[192:207]
    ds_read_b64_tr_b16 a[160:161], v9 offset:4096
    ds_read_b64_tr_b16 a[162:163], v9 offset:4608
    buffer_load_dwordx4 a[0:3], v20, s[48:51], s45 offen offset:2048 sc1
    v_mfma_f32_32x32x16_bf16 v[208:223], a[180:183], a[60:63], v[208:223]
    ds_read_b64_tr_b16 a[164:165], v9 offset:6144
    ds_read_b64_tr_b16 a[166:167], v9 offset:6656
    v_mfma_f32_32x32x16_bf16 v[224:239], a[184:187], a[60:63], v[224:239]
    ds_read_b64_tr_b16 a[168:169], v12 offset:4096
    ds_read_b64_tr_b16 a[170:171], v12 offset:4608
    buffer_load_dwordx4 v8, s[56:59], s12 offen offset:3072 lds
    v_mfma_f32_32x32x16_bf16 v[240:255], a[188:191], a[60:63], v[240:255]
    ds_read_b64_tr_b16 a[172:173], v12 offset:6144
    ds_read_b64_tr_b16 a[174:175], v12 offset:6656
    s_waitcnt lgkmcnt(12)
    buffer_store_dwordx4 v[176:179], v20, s[72:75], s80 offen offset:0 sc1
    s_waitcnt lgkmcnt(8)
    v_mfma_f32_32x32x16_bf16 v[192:207], a[192:195], a[64:67], v[192:207]
    ds_read_b64_tr_b16 a[176:177], v9 offset:8192
    ds_read_b64_tr_b16 a[178:179], v9 offset:8704
    buffer_store_dwordx4 v[180:183], v20, s[72:75], s80 offen offset:1024 sc1
    v_mfma_f32_32x32x16_bf16 v[208:223], a[196:199], a[64:67], v[208:223]
    ds_read_b64_tr_b16 a[180:181], v9 offset:10240
    ds_read_b64_tr_b16 a[182:183], v9 offset:10752
    buffer_store_dwordx4 v[184:187], v20, s[72:75], s81 offen offset:0 sc1
    v_mfma_f32_32x32x16_bf16 v[224:239], a[200:203], a[64:67], v[224:239]
    ds_read_b64_tr_b16 a[184:185], v12 offset:8192
    ds_read_b64_tr_b16 a[186:187], v12 offset:8704
    buffer_store_dwordx4 v[188:191], v20, s[72:75], s81 offen offset:1024 sc1
    v_mfma_f32_32x32x16_bf16 v[240:255], a[204:207], a[64:67], v[240:255]
    ds_read_b64_tr_b16 a[188:189], v12 offset:10240
    ds_read_b64_tr_b16 a[190:191], v12 offset:10752
    v_accvgpr_read_b32 v93, a209
    v_accvgpr_read_b32 v6, a211
    v_bitop3_b32 v4, v93, v6, v26 bitop3:0x7e
    v_accvgpr_read_b32 v93, a213
    v_accvgpr_read_b32 v6, a215
    v_bitop3_b32 v93, v93, v6, v26 bitop3:0x7e
    v_or_b32 v4, v4, v93
    v_accvgpr_read_b32 v93, a217
    v_accvgpr_read_b32 v6, a219
    v_bitop3_b32 v93, v93, v6, v26 bitop3:0x7e
    v_or_b32 v4, v4, v93
    v_accvgpr_read_b32 v93, a221
    v_accvgpr_read_b32 v6, a223
    s_waitcnt lgkmcnt(8)
    v_mfma_f32_32x32x16_bf16 v[192:207], a[160:163], a[68:71], v[192:207]
    ds_read_b64_tr_b16 a[192:193], v9 offset:12288
    ds_read_b64_tr_b16 a[194:195], v9 offset:12800
    buffer_load_dwordx4 a[4:7], v20, s[48:51], s45 offen offset:3072 sc1
    v_bitop3_b32 v93, v93, v6, v26 bitop3:0x7e
    v_or_b32 v4, v4, v93
    v_cmp_ne_u32 vcc, 0, v4
    s_nop 1
    s_cmp_lg_u64 vcc, 0
    s_cbranch_scc1 L_slow_35
L_ok_36:
    v_mfma_f32_32x32x16_bf16 v[192:207], a[208:211], a[252:255], v[192:207]
    v_mfma_f32_32x32x16_bf16 v[208:223], a[164:167], a[68:71], v[208:223]
    ds_read_b64_tr_b16 a[196:197], v9 offset:14336
    ds_read_b64_tr_b16 a[198:199], v9 offset:14848
    v_mfma_f32_32x32x16_bf16 v[208:223], a[212:215], a[252:255], v[208:223]
    v_mfma_f32_32x32x16_bf16 v[224:239], a[168:171], a[68:71], v[224:239]
    s_add_u32 s45, s20, 45056
    ds_read_b64_tr_b16 a[200:201], v12 offset:12288
    ds_read_b64_tr_b16 a[202:203], v12 offset:12800
    buffer_load_dwordx4 a[8:11], v20, s[48:51], s45 offen offset:0 sc1
    v_mfma_f32_32x32x16_bf16 v[224:239], a[216:219], a[252:255], v[224:239]
    v_mfma_f32_32x32x16_bf16 v[240:255], a[172:175], a[68:71], v[240:255]
    ds_read_b64_tr_b16 a[204:205], v12 offset:14336
    ds_read_b64_tr_b16 a[206:207], v12 offset:14848
    v_mfma_f32_32x32x16_bf16 v[240:255], a[220:223], a[252:255], v[240:255]
    s_waitcnt lgkmcnt(8)
    v_mfma_f32_32x32x16_bf16 v[192:207], a[176:179], a[72:75], v[192:207]
    s_waitcnt vmcnt(28)
    s_barrier
    s_add_u32 s45, s20, 81920
    ds_read_b64_tr_b16 a[160:161], v10 offset:49152
    ds_read_b64_tr_b16 a[162:163], v10 offset:49664
    buffer_load_dwordx4 a[12:15], v20, s[48:51], s45 offen offset:0 sc1
    s_lshr_b32 s80, s82, 1
    s_add_u32 s80, s80, 151552
    v_mov_b32 v60, 0
    v_mov_b32 v61, v26
    v_lshlrev_b32 v96, 3, v1
    v_add_u32 v96, 159744, v96
    v_mfma_f32_32x32x16_bf16 v[208:223], a[180:183], a[72:75], v[208:223]
    s_lshr_b32 m0, s82, 1
    s_add_u32 m0, m0, 151552
    ds_read_b64_tr_b16 a[164:165], v10 offset:51200
    ds_read_b64_tr_b16 a[166:167], v10 offset:51712
    buffer_load_dwordx4 v20, s[68:71], s80 offen offset:0 sc1 lds
    ds_write_b64 v96, v[60:61]
    v_mul_f32 v4, v47, v128
    v_fmac_f32 v4, v48, v144
    v_mul_f32 v144, v49, v144
    v_fmac_f32 v144, v48, v128
    v_mul_f32 v128, v47, v129
    v_fmac_f32 v128, v48, v145
    v_mul_f32 v145, v49, v145
    v_mfma_f32_32x32x16_bf16 v[224:239], a[184:187], a[72:75], v[224:239]
    ds_read_b64_tr_b16 a[168:169], v13 offset:49152
    ds_read_b64_tr_b16 a[170:171], v13 offset:49664
    buffer_load_dwordx4 v20, s[68:71], s80 offen offset:1024 sc1 lds
    v_fmac_f32 v145, v48, v129
    v_mul_f32 v129, v47, v130
    v_fmac_f32 v129, v48, v146
    v_mul_f32 v146, v49, v146
    v_fmac_f32 v146, v48, v130
    v_mul_f32 v130, v47, v131
    v_fmac_f32 v130, v48, v147
    v_mul_f32 v147, v49, v147
    v_fmac_f32 v147, v48, v131
    v_mul_f32 v131, v47, v132
    v_fmac_f32 v131, v48, v148
    v_mul_f32 v148, v49, v148
    v_fmac_f32 v148, v48, v132
    v_mfma_f32_32x32x16_bf16 v[240:255], a[188:191], a[72:75], v[240:255]
    ds_read_b64_tr_b16 a[172:173], v13 offset:51200
    ds_read_b64_tr_b16 a[174:175], v13 offset:51712
    v_mul_f32 v132, v47, v133
    v_fmac_f32 v132, v48, v149
    v_mul_f32 v149, v49, v149
    v_fmac_f32 v149, v48, v133
    v_mul_f32 v133, v47, v134
    v_fmac_f32 v133, v48, v150
    v_mul_f32 v150, v49, v150
    v_fmac_f32 v150, v48, v134
    v_mul_f32 v134, v47, v135
    v_fmac_f32 v134, v48, v151
    v_mul_f32 v151, v49, v151
    v_fmac_f32 v151, v48, v135
    v_mul_f32 v135, v47, v136
    s_waitcnt lgkmcnt(9)
    v_mfma_f32_32x32x16_bf16 v[192:207], a[192:195], a[76:79], v[192:207]
    ds_read_b64_tr_b16 a[176:177], v10 offset:53248
    ds_read_b64_tr_b16 a[178:179], v10 offset:53760
    buffer_load_dwordx4 a[16:19], v20, s[48:51], s45 offen offset:1024 sc1
    v_fmac_f32 v135, v48, v152
    v_mul_f32 v152, v49, v152
    v_fmac_f32 v152, v48, v136
    v_mul_f32 v136, v47, v137
    v_fmac_f32 v136, v48, v153
    v_mul_f32 v153, v49, v153
    v_fmac_f32 v153, v48, v137
    v_mul_f32 v137, v47, v138
    v_fmac_f32 v137, v48, v154
    v_mul_f32 v154, v49, v154
    v_fmac_f32 v154, v48, v138
    v_mul_f32 v138, v47, v139
    v_fmac_f32 v138, v48, v155
    v_mfma_f32_32x32x16_bf16 v[208:223], a[196:199], a[76:79], v[208:223]
    ds_read_b64_tr_b16 a[180:181], v10 offset:55296
    ds_read_b64_tr_b16 a[182:183], v10 offset:55808
    v_mul_f32 v155, v49, v155
    v_fmac_f32 v155, v48, v139
    v_mul_f32 v139, v47, v140
    v_fmac_f32 v139, v48, v156
    v_mul_f32 v156, v49, v156
    v_fmac_f32 v156, v48, v140
    v_mul_f32 v140, v47, v141
    v_fmac_f32 v140, v48, v157
    v_mul_f32 v157, v49, v157
    v_fmac_f32 v157, v48, v141
    v_mul_f32 v141, v47, v142
    v_fmac_f32 v141, v48, v158
    v_mul_f32 v158, v49, v158
    v_fmac_f32 v158, v48, v142
    v_mfma_f32_32x32x16_bf16 v[224:239], a[200:203], a[76:79], v[224:239]
    ds_read_b64_tr_b16 a[184:185], v13 offset:53248
    ds_read_b64_tr_b16 a[186:187], v13 offset:53760
    buffer_load_dwordx4 a[20:23], v20, s[48:51], s45 offen offset:2048 sc1
    v_mul_f32 v142, v47, v143
    v_fmac_f32 v142, v48, v159
    v_mul_f32 v159, v49, v159
    v_fmac_f32 v159, v48, v143
    v_mfma_f32_32x32x16_bf16 v[240:255], a[204:207], a[76:79], v[240:255]
    ds_read_b64_tr_b16 a[188:189], v13 offset:55296
    ds_read_b64_tr_b16 a[190:191], v13 offset:55808
    s_waitcnt lgkmcnt(8)
    v_mfma_f32_32x32x16_bf16 v[192:207], a[160:163], a[80:83], v[192:207]
    ds_read_b64_tr_b16 a[192:193], v10 offset:57344
    ds_read_b64_tr_b16 a[194:195], v10 offset:57856
    buffer_load_dwordx4 a[24:27], v20, s[48:51], s45 offen offset:3072 sc1
    v_mfma_f32_32x32x16_bf16 v[208:223], a[164:167], a[80:83], v[208:223]
    ds_read_b64_tr_b16 a[196:197], v10 offset:59392
    ds_read_b64_tr_b16 a[198:199], v10 offset:59904
    v_mfma_f32_32x32x16_bf16 v[224:239], a[168:171], a[80:83], v[224:239]
    s_add_u32 s45, s20, 86016
    ds_read_b64_tr_b16 a[200:201], v13 offset:57344
    ds_read_b64_tr_b16 a[202:203], v13 offset:57856
    buffer_load_dwordx4 a[28:31], v20, s[48:51], s45 offen offset:0 sc1
    v_mfma_f32_32x32x16_bf16 v[240:255], a[172:175], a[80:83], v[240:255]
    ds_read_b64_tr_b16 a[204:205], v13 offset:59392
    ds_read_b64_tr_b16 a[206:207], v13 offset:59904
    s_waitcnt lgkmcnt(8)
    v_mfma_f32_32x32x16_bf16 v[192:207], a[176:179], a[84:87], v[192:207]
    s_add_u32 s45, s20, 122880
    ds_read_b64_tr_b16 a[160:161], v10 offset:61440
    ds_read_b64_tr_b16 a[162:163], v10 offset:61952
    buffer_load_dwordx4 a[32:35], v20, s[48:51], s45 offen offset:0 sc1
    v_mfma_f32_32x32x16_bf16 v[208:223], a[180:183], a[84:87], v[208:223]
    ds_read_b64_tr_b16 a[164:165], v10 offset:63488
    ds_read_b64_tr_b16 a[166:167], v10 offset:64000
    v_mfma_f32_32x32x16_bf16 v[224:239], a[184:187], a[84:87], v[224:239]
    ds_read_b64_tr_b16 a[168:169], v13 offset:61440
    ds_read_b64_tr_b16 a[170:171], v13 offset:61952
    buffer_load_dwordx4 a[36:39], v20, s[48:51], s45 offen offset:1024 sc1
    v_mfma_f32_32x32x16_bf16 v[240:255], a[188:191], a[84:87], v[240:255]
    ds_read_b64_tr_b16 a[172:173], v13 offset:63488
    ds_read_b64_tr_b16 a[174:175], v13 offset:64000
    s_waitcnt vmcnt(6)
    s_barrier
    ds_read_b128 v[96:99], v80
    ds_read_b128 v[100:103], v81
    s_waitcnt lgkmcnt(10)
    v_mfma_f32_32x32x16_bf16 v[192:207], a[192:195], a[88:91], v[192:207]
    ds_read_b64_tr_b16 a[176:177], v9 offset:32768
    ds_read_b64_tr_b16 a[178:179], v9 offset:33280
    buffer_load_dwordx4 a[40:43], v20, s[48:51], s45 offen offset:2048 sc1
    ds_read_b128 v[104:107], v82
    ds_read_b128 v[108:111], v83
    v_mfma_f32_32x32x16_bf16 v[208:223], a[196:199], a[88:91], v[208:223]
    ds_read_b64_tr_b16 a[180:181], v9 offset:34816
    ds_read_b64_tr_b16 a[182:183], v9 offset:35328
    ds_read_b128 v[112:115], v84
    ds_read_b128 v[116:119], v85
    v_mfma_f32_32x32x16_bf16 v[224:239], a[200:203], a[88:91], v[224:239]
    ds_read_b64_tr_b16 a[184:185], v12 offset:32768
    ds_read_b64_tr_b16 a[186:187], v12 offset:33280
    buffer_load_dwordx4 a[44:47], v20, s[48:51], s45 offen offset:3072 sc1
    ds_read_b128 v[120:123], v86
    ds_read_b128 v[124:127], v87
    v_mfma_f32_32x32x16_bf16 v[240:255], a[204:207], a[88:91], v[240:255]
    ds_read_b64_tr_b16 a[188:189], v12 offset:34816
    ds_read_b64_tr_b16 a[190:191], v12 offset:35328
    s_waitcnt lgkmcnt(15)
    v_mfma_f32_32x32x16_bf16 v[192:207], a[160:163], a[92:95], v[192:207]
    s_add_u32 s45, s20, 126976
    ds_read_b64_tr_b16 a[192:193], v9 offset:36864
    ds_read_b64_tr_b16 a[194:195], v9 offset:37376
    buffer_load_dwordx4 a[48:51], v20, s[48:51], s45 offen offset:0 sc1
    v_mfma_f32_32x32x16_bf16 v[208:223], a[164:167], a[92:95], v[208:223]
    ds_read_b64_tr_b16 a[196:197], v9 offset:38912
    ds_read_b64_tr_b16 a[198:199], v9 offset:39424
    v_mfma_f32_32x32x16_bf16 v[224:239], a[168:171], a[92:95], v[224:239]
    s_add_u32 s45, s20, 163840
    ds_read_b64_tr_b16 a[200:201], v12 offset:36864
    ds_read_b64_tr_b16 a[202:203], v12 offset:37376
    buffer_load_dwordx4 a[52:55], v20, s[48:51], s45 offen offset:0 sc1
    s_waitcnt lgkmcnt(8)
    v_bitop3_b32 v97, v97, v99, v26 bitop3:0x7e
    v_bitop3_b32 v101, v101, v103, v26 bitop3:0x7e
    v_bitop3_b32 v105, v105, v107, v26 bitop3:0x7e
    v_bitop3_b32 v109, v109, v111, v26 bitop3:0x7e
    v_bitop3_b32 v113, v113, v115, v26 bitop3:0x7e
    v_bitop3_b32 v117, v117, v119, v26 bitop3:0x7e
    v_bitop3_b32 v121, v121, v123, v26 bitop3:0x7e
    v_bitop3_b32 v125, v125, v127, v26 bitop3:0x7e
    v_or3_b32 v97, v97, v101, v105
    v_or3_b32 v109, v109, v113, v117
    v_or3_b32 v97, v97, v121, v125
    v_mfma_f32_32x32x16_bf16 v[240:255], a[172:175], a[92:95], v[240:255]
    ds_read_b64_tr_b16 a[204:205], v12 offset:38912
    ds_read_b64_tr_b16 a[206:207], v12 offset:39424
    v_or_b32 v97, v97, v109
    v_cmp_ne_u32 vcc, 0, v97
    s_nop 1
    s_cmp_lg_u64 vcc, 0
    s_cbranch_scc1 L_slow_37
L_ok_38:
    v_fmac_f32 v120, v54, v124
    v_fmac_f32 v122, v54, v126
    v_fma_f32 v120, -v55, v126, v120
    v_fmac_f32 v122, v55, v124
    v_fmac_f32 v116, v54, v120
    v_fmac_f32 v118, v54, v122
    v_fma_f32 v116, -v55, v122, v116
    v_fmac_f32 v118, v55, v120
    s_waitcnt lgkmcnt(8)
    v_mfma_f32_32x32x16_bf16 v[192:207], a[176:179], a[96:99], v[192:207]
    ds_read_b64_tr_b16 a[160:161], v9 offset:40960
    ds_read_b64_tr_b16 a[162:163], v9 offset:41472
    buffer_load_dwordx4 a[56:59], v20, s[48:51], s45 offen offset:1024 sc1
    v_fmac_f32 v112, v54, v116
    v_fmac_f32 v114, v54, v118
    v_fma_f32 v112, -v55, v118, v112
    v_fmac_f32 v114, v55, v116
    v_fmac_f32 v108, v54, v112
    v_fmac_f32 v110, v54, v114
    v_fma_f32 v108, -v55, v114, v108
    v_fmac_f32 v110, v55, v112
    v_fmac_f32 v104, v54, v108
    v_fmac_f32 v106, v54, v110
    v_fma_f32 v104, -v55, v110, v104
    v_fmac_f32 v106, v55, v108
    v_fmac_f32 v100, v54, v104
    v_mfma_f32_32x32x16_bf16 v[208:223], a[180:183], a[96:99], v[208:223]
    ds_read_b64_tr_b16 a[164:165], v9 offset:43008
    ds_read_b64_tr_b16 a[166:167], v9 offset:43520
    v_fmac_f32 v102, v54, v106
    v_fma_f32 v100, -v55, v106, v100
    v_fmac_f32 v102, v55, v104
    v_fmac_f32 v96, v54, v100
    v_fmac_f32 v98, v54, v102
    v_fma_f32 v96, -v55, v102, v96
    v_fmac_f32 v98, v55, v100
    v_mov_b32 v100, v96
    v_mov_b32 v102, v98
    s_lshl_b32 s80, s7, 13
    s_add_u32 s80, s80, s14
    v_permlane32_swap_b32 v96, v100
    v_permlane32_swap_b32 v98, v102
    s_add_u32 s80, s80, 90112
    v_mfma_f32_32x32x16_bf16 v[224:239], a[184:187], a[96:99], v[224:239]
    ds_read_b64_tr_b16 a[168:169], v12 offset:40960
    ds_read_b64_tr_b16 a[170:171], v12 offset:41472
    buffer_load_dwordx4 a[60:63], v20, s[48:51], s45 offen offset:2048 sc1
    s_add_u32 s81, s80, 4096
    v_fmac_f32 v96, v52, v100
    v_fmac_f32 v98, v52, v102
    v_fma_f32 v96, -v53, v102, v96
    v_fmac_f32 v98, v53, v100
    v_fmac_f32 v58, v56, v96
    v_fmac_f32 v59, v56, v98
    v_fma_f32 v58, -v57, v98, v58
    v_fmac_f32 v59, v57, v96
    v_mul_f32 v96, v47, v58
    v_mul_f32 v97, v48, v58
    v_fmac_f32 v96, v48, v59
    v_fmac_f32 v97, v49, v59
    v_mfma_f32_32x32x16_bf16 v[240:255], a[188:191], a[96:99], v[240:255]
    ds_read_b64_tr_b16 a[172:173], v12 offset:43008
    ds_read_b64_tr_b16 a[174:175], v12 offset:43520
    v_fmac_f32 v4, v44, v96
    v_fmac_f32 v144, v44, v97
    v_fmac_f32 v4, v45, v97
    v_fmac_f32 v144, v46, v96
    v_fmac_f32 v128, v44, v4
    v_fmac_f32 v145, v44, v144
    v_fmac_f32 v128, v45, v144
    v_fmac_f32 v145, v46, v4
    v_fmac_f32 v129, v44, v128
    v_fmac_f32 v146, v44, v145
    v_fmac_f32 v129, v45, v145
    v_fmac_f32 v146, v46, v128
    v_fmac_f32 v130, v44, v129
    s_waitcnt lgkmcnt(8)
    v_mfma_f32_32x32x16_bf16 v[192:207], a[192:195], a[100:103], v[192:207]
    ds_read_b64_tr_b16 a[176:177], v9 offset:45056
    ds_read_b64_tr_b16 a[178:179], v9 offset:45568
    buffer_load_dwordx4 a[64:67], v20, s[48:51], s45 offen offset:3072 sc1
    v_fmac_f32 v147, v44, v146
    v_fmac_f32 v130, v45, v146
    v_fmac_f32 v147, v46, v129
    v_fmac_f32 v131, v44, v130
    v_fmac_f32 v148, v44, v147
    v_fmac_f32 v131, v45, v147
    v_fmac_f32 v148, v46, v130
    v_fmac_f32 v132, v44, v131
    v_fmac_f32 v149, v44, v148
    v_fmac_f32 v132, v45, v148
    v_fmac_f32 v149, v46, v131
    v_fmac_f32 v133, v44, v132
    v_fmac_f32 v150, v44, v149
    v_mfma_f32_32x32x16_bf16 v[208:223], a[196:199], a[100:103], v[208:223]
    ds_read_b64_tr_b16 a[180:181], v9 offset:47104
    ds_read_b64_tr_b16 a[182:183], v9 offset:47616
    v_fmac_f32 v133, v45, v149
    v_fmac_f32 v150, v46, v132
    v_fmac_f32 v134, v44, v133
    v_fmac_f32 v151, v44, v150
    v_fmac_f32 v134, v45, v150
    v_fmac_f32 v151, v46, v133
    v_fmac_f32 v135, v44, v134
    v_fmac_f32 v152, v44, v151
    v_fmac_f32 v135, v45, v151
    v_fmac_f32 v152, v46, v134
    v_fmac_f32 v136, v44, v135
    v_fmac_f32 v153, v44, v152
    v_fmac_f32 v136, v45, v152
    v_fmac_f32 v153, v46, v135
    v_mfma_f32_32x32x16_bf16 v[224:239], a[200:203], a[100:103], v[224:239]
    s_add_u32 s45, s20, 167936
    ds_read_b64_tr_b16 a[184:185], v12 offset:45056
    ds_read_b64_tr_b16 a[186:187], v12 offset:45568
    buffer_load_dwordx4 a[68:71], v20, s[48:51], s45 offen offset:0 sc1
    v_fmac_f32 v137, v44, v136
    v_fmac_f32 v154, v44, v153
    v_fmac_f32 v137, v45, v153
    v_fmac_f32 v154, v46, v136
    v_fmac_f32 v138, v44, v137
    v_fmac_f32 v155, v44, v154
    v_fmac_f32 v138, v45, v154
    v_fmac_f32 v155, v46, v137
    v_fmac_f32 v139, v44, v138
    v_fmac_f32 v156, v44, v155
    v_fmac_f32 v139, v45, v155
    v_fmac_f32 v156, v46, v138
    v_mfma_f32_32x32x16_bf16 v[240:255], a[204:207], a[100:103], v[240:255]
    ds_read_b64_tr_b16 a[188:189], v12 offset:47104
    ds_read_b64_tr_b16 a[190:191], v12 offset:47616
    v_fmac_f32 v140, v44, v139
    v_fmac_f32 v157, v44, v156
    v_fmac_f32 v140, v45, v156
    v_fmac_f32 v157, v46, v139
    v_fmac_f32 v141, v44, v140
    v_fmac_f32 v158, v44, v157
    v_fmac_f32 v141, v45, v157
    v_fmac_f32 v158, v46, v140
    v_fmac_f32 v142, v44, v141
    v_fmac_f32 v159, v44, v158
    v_fmac_f32 v142, v45, v158
    v_fmac_f32 v159, v46, v141
    s_barrier
    v_cvt_pk_bf16_f32 v96, v4, v128
    s_waitcnt lgkmcnt(8)
    v_mfma_f32_32x32x16_bf16 v[192:207], a[160:163], a[104:107], v[192:207]
    s_barrier
    s_add_u32 s45, s20, 204800
    ds_read_b64_tr_b16 a[192:193], v10 offset:16384
    ds_read_b64_tr_b16 a[194:195], v10 offset:16896
    buffer_load_dwordx4 a[208:211], v20, s[48:51], s45 offen offset:0 sc1
    v_cvt_pk_bf16_f32 v97, v129, v130
    v_mfma_f32_32x32x16_bf16 v[208:223], a[164:167], a[104:107], v[208:223]
    ds_read_b64_tr_b16 a[196:197], v10 offset:18432
    ds_read_b64_tr_b16 a[198:199], v10 offset:18944
    ds_write_b64 v24, v[96:97] offset:0
    v_cvt_pk_bf16_f32 v98, v131, v132
    v_cvt_pk_bf16_f32 v99, v133, v134
    v_mfma_f32_32x32x16_bf16 v[224:239], a[168:171], a[104:107], v[224:239]
    ds_read_b64_tr_b16 a[200:201], v13 offset:16384
    ds_read_b64_tr_b16 a[202:203], v13 offset:16896
    buffer_load_dwordx4 a[212:215], v20, s[48:51], s45 offen offset:1024 sc1
    ds_write_b64 v24, v[98:99] offset:8
    v_cvt_pk_bf16_f32 v100, v135, v136
    v_cvt_pk_bf16_f32 v101, v137, v138
    v_mfma_f32_32x32x16_bf16 v[240:255], a[172:175], a[104:107], v[240:255]
    ds_read_b64_tr_b16 a[204:205], v13 offset:18432
    ds_read_b64_tr_b16 a[206:207], v13 offset:18944
    ds_write_b64 v24, v[100:101] offset:16
    v_cvt_pk_bf16_f32 v102, v139, v140
    v_cvt_pk_bf16_f32 v103, v141, v142
    s_waitcnt lgkmcnt(11)
    v_mfma_f32_32x32x16_bf16 v[192:207], a[176:179], a[108:111], v[192:207]
    ds_read_b64_tr_b16 a[160:161], v10 offset:20480
    ds_read_b64_tr_b16 a[162:163], v10 offset:20992
    buffer_load_dwordx4 a[216:219], v20, s[48:51], s45 offen offset:2048 sc1
    ds_write_b64 v24, v[102:103] offset:24
    ds_read_b64_tr_b16 v[112:113], v25 offset:0
    v_mfma_f32_32x32x16_bf16 v[208:223], a[180:183], a[108:111], v[208:223]
    ds_read_b64_tr_b16 a[164:165], v10 offset:22528
    ds_read_b64_tr_b16 a[166:167], v10 offset:23040
    ds_read_b64_tr_b16 v[114:115], v25 offset:320
    v_mfma_f32_32x32x16_bf16 v[224:239], a[184:187], a[108:111], v[224:239]
    ds_read_b64_tr_b16 a[168:169], v13 offset:20480
    ds_read_b64_tr_b16 a[170:171], v13 offset:20992
    buffer_load_dwordx4 a[220:223], v20, s[48:51], s45 offen offset:3072 sc1
    ds_read_b64_tr_b16 v[116:117], v25 offset:32
    ds_read_b64_tr_b16 v[118:119], v25 offset:352
    v_mfma_f32_32x32x16_bf16 v[240:255], a[188:191], a[108:111], v[240:255]
    ds_read_b64_tr_b16 a[172:173], v13 offset:22528
    ds_read_b64_tr_b16 a[174:175], v13 offset:23040
    v_cvt_pk_bf16_f32 v104, v144, v145
    v_cvt_pk_bf16_f32 v105, v146, v147
    s_waitcnt lgkmcnt(14)
    v_mfma_f32_32x32x16_bf16 v[192:207], a[192:195], a[112:115], v[192:207]
    s_add_u32 s45, s20, 208896
    ds_read_b64_tr_b16 a[176:177], v10 offset:24576
    ds_read_b64_tr_b16 a[178:179], v10 offset:25088
    buffer_load_dwordx4 a[252:255], v20, s[48:51], s45 offen offset:0 sc1
    ds_write_b64 v24, v[104:105] offset:0
    v_cvt_pk_bf16_f32 v106, v148, v149
    v_cvt_pk_bf16_f32 v107, v150, v151
    v_mfma_f32_32x32x16_bf16 v[208:223], a[196:199], a[112:115], v[208:223]
    ds_read_b64_tr_b16 a[180:181], v10 offset:26624
    ds_read_b64_tr_b16 a[182:183], v10 offset:27136
    ds_write_b64 v24, v[106:107] offset:8
    v_cvt_pk_bf16_f32 v108, v152, v153
    v_cvt_pk_bf16_f32 v109, v154, v155
    v_mfma_f32_32x32x16_bf16 v[224:239], a[200:203], a[112:115], v[224:239]
    s_add_u32 s45, s20, 245760
    ds_read_b64_tr_b16 a[184:185], v13 offset:24576
    ds_read_b64_tr_b16 a[186:187], v13 offset:25088
    buffer_load_dwordx4 a[72:75], v20, s[48:51], s45 offen offset:0 sc1
    ds_write_b64 v24, v[108:109] offset:16
    v_cvt_pk_bf16_f32 v110, v156, v157
    v_cvt_pk_bf16_f32 v111, v158, v159
    v_mfma_f32_32x32x16_bf16 v[240:255], a[204:207], a[112:115], v[240:255]
    ds_read_b64_tr_b16 a[188:189], v13 offset:26624
    ds_read_b64_tr_b16 a[190:191], v13 offset:27136
    ds_write_b64 v24, v[110:111] offset:24
    ds_read_b64_tr_b16 v[120:121], v25 offset:0
    s_waitcnt lgkmcnt(13)
    v_mfma_f32_32x32x16_bf16 v[192:207], a[160:163], a[116:119], v[192:207]
    ds_read_b64_tr_b16 a[192:193], v10 offset:28672
    ds_read_b64_tr_b16 a[194:195], v10 offset:29184
    buffer_load_dwordx4 a[76:79], v20, s[48:51], s45 offen offset:1024 sc1
    ds_read_b64_tr_b16 v[122:123], v25 offset:320
    v_mfma_f32_32x32x16_bf16 v[208:223], a[164:167], a[116:119], v[208:223]
    ds_read_b64_tr_b16 a[196:197], v10 offset:30720
    ds_read_b64_tr_b16 a[198:199], v10 offset:31232
    ds_read_b64_tr_b16 v[124:125], v25 offset:32
    ds_read_b64_tr_b16 v[126:127], v25 offset:352
    v_mfma_f32_32x32x16_bf16 v[224:239], a[168:171], a[116:119], v[224:239]
    ds_read_b64_tr_b16 a[200:201], v13 offset:28672
    ds_read_b64_tr_b16 a[202:203], v13 offset:29184
    buffer_load_dwordx4 a[80:83], v20, s[48:51], s45 offen offset:2048 sc1
    v_mfma_f32_32x32x16_bf16 v[240:255], a[172:175], a[116:119], v[240:255]
    ds_read_b64_tr_b16 a[204:205], v13 offset:30720
    ds_read_b64_tr_b16 a[206:207], v13 offset:31232
    s_waitcnt lgkmcnt(13)
    v_mfma_f32_32x32x16_bf16 v[192:207], a[176:179], a[120:123], v[192:207]
    ds_read_b64_tr_b16 a[160:161], v11 offset:0
    ds_read_b64_tr_b16 a[162:163], v11 offset:512
    buffer_load_dwordx4 a[84:87], v20, s[48:51], s45 offen offset:3072 sc1
    v_mfma_f32_32x32x16_bf16 v[208:223], a[180:183], a[120:123], v[208:223]
    ds_read_b64_tr_b16 a[164:165], v11 offset:2048
    ds_read_b64_tr_b16 a[166:167], v11 offset:2560
    v_mfma_f32_32x32x16_bf16 v[224:239], a[184:187], a[120:123], v[224:239]
    s_add_u32 s45, s20, 249856
    ds_read_b64_tr_b16 a[168:169], v14 offset:0
    ds_read_b64_tr_b16 a[170:171], v14 offset:512
    buffer_load_dwordx4 a[88:91], v20, s[48:51], s45 offen offset:0 sc1
    v_mfma_f32_32x32x16_bf16 v[240:255], a[188:191], a[120:123], v[240:255]
    ds_read_b64_tr_b16 a[172:173], v14 offset:2048
    ds_read_b64_tr_b16 a[174:175], v14 offset:2560
    s_waitcnt lgkmcnt(12)
    buffer_store_dwordx4 v[112:115], v20, s[72:75], s80 offen offset:0 sc1
    s_waitcnt lgkmcnt(8)
    v_mfma_f32_32x32x16_bf16 v[192:207], a[192:195], a[124:127], v[192:207]
    ds_read_b64_tr_b16 a[176:177], v11 offset:4096
    ds_read_b64_tr_b16 a[178:179], v11 offset:4608
    buffer_store_dwordx4 v[116:119], v20, s[72:75], s80 offen offset:1024 sc1
    v_mfma_f32_32x32x16_bf16 v[208:223], a[196:199], a[124:127], v[208:223]
    ds_read_b64_tr_b16 a[180:181], v11 offset:6144
    ds_read_b64_tr_b16 a[182:183], v11 offset:6656
    buffer_store_dwordx4 v[120:123], v20, s[72:75], s81 offen offset:0 sc1
    v_mfma_f32_32x32x16_bf16 v[224:239], a[200:203], a[124:127], v[224:239]
    ds_read_b64_tr_b16 a[184:185], v14 offset:4096
    ds_read_b64_tr_b16 a[186:187], v14 offset:4608
    buffer_store_dwordx4 v[124:127], v20, s[72:75], s81 offen offset:1024 sc1
    v_mfma_f32_32x32x16_bf16 v[240:255], a[204:207], a[124:127], v[240:255]
    ds_read_b64_tr_b16 a[188:189], v14 offset:6144
    ds_read_b64_tr_b16 a[190:191], v14 offset:6656
    s_waitcnt lgkmcnt(8)
    v_mfma_f32_32x32x16_bf16 v[192:207], a[160:163], a[128:131], v[192:207]
    s_add_u32 s45, s20, 286720
    ds_read_b64_tr_b16 a[192:193], v11 offset:8192
    ds_read_b64_tr_b16 a[194:195], v11 offset:8704
    buffer_load_dwordx4 a[92:95], v20, s[48:51], s45 offen offset:0 sc1
    buffer_load_dword v5, v2, s[76:79], 0 offen offset:128 sc1
    v_mfma_f32_32x32x16_bf16 v[208:223], a[164:167], a[128:131], v[208:223]
    ds_read_b64_tr_b16 a[196:197], v11 offset:10240
    ds_read_b64_tr_b16 a[198:199], v11 offset:10752
    v_mfma_f32_32x32x16_bf16 v[224:239], a[168:171], a[128:131], v[224:239]
    ds_read_b64_tr_b16 a[200:201], v14 offset:8192
    ds_read_b64_tr_b16 a[202:203], v14 offset:8704
    buffer_load_dwordx4 a[96:99], v20, s[48:51], s45 offen offset:1024 sc1
    v_mfma_f32_32x32x16_bf16 v[240:255], a[172:175], a[128:131], v[240:255]
    ds_read_b64_tr_b16 a[204:205], v14 offset:10240
    ds_read_b64_tr_b16 a[206:207], v14 offset:10752
    s_waitcnt lgkmcnt(8)
    v_mfma_f32_32x32x16_bf16 v[192:207], a[176:179], a[132:135], v[192:207]
    ds_read_b64_tr_b16 a[160:161], v11 offset:12288
    ds_read_b64_tr_b16 a[162:163], v11 offset:12800
    buffer_load_dwordx4 a[100:103], v20, s[48:51], s45 offen offset:2048 sc1
    v_mfma_f32_32x32x16_bf16 v[208:223], a[180:183], a[132:135], v[208:223]
    ds_read_b64_tr_b16 a[164:165], v11 offset:14336
    ds_read_b64_tr_b16 a[166:167], v11 offset:14848
    v_mfma_f32_32x32x16_bf16 v[224:239], a[184:187], a[132:135], v[224:239]
    ds_read_b64_tr_b16 a[168:169], v14 offset:12288
    ds_read_b64_tr_b16 a[170:171], v14 offset:12800
    buffer_load_dwordx4 a[104:107], v20, s[48:51], s45 offen offset:3072 sc1
    v_mfma_f32_32x32x16_bf16 v[240:255], a[188:191], a[132:135], v[240:255]
    ds_read_b64_tr_b16 a[172:173], v14 offset:14336
    ds_read_b64_tr_b16 a[174:175], v14 offset:14848
    s_waitcnt lgkmcnt(8)
    v_mfma_f32_32x32x16_bf16 v[192:207], a[192:195], a[136:139], v[192:207]
    s_barrier
    s_add_u32 s45, s20, 290816
    ds_read_b64_tr_b16 a[176:177], v10 offset:32768
    ds_read_b64_tr_b16 a[178:179], v10 offset:33280
    buffer_load_dwordx4 a[108:111], v20, s[48:51], s45 offen offset:0 sc1
    v_mfma_f32_32x32x16_bf16 v[208:223], a[196:199], a[136:139], v[208:223]
    ds_read_b64_tr_b16 a[180:181], v10 offset:34816
    ds_read_b64_tr_b16 a[182:183], v10 offset:35328
    v_mfma_f32_32x32x16_bf16 v[224:239], a[200:203], a[136:139], v[224:239]
    s_add_u32 s45, s20, 327680
    ds_read_b64_tr_b16 a[184:185], v13 offset:32768
    ds_read_b64_tr_b16 a[186:187], v13 offset:33280
    buffer_load_dwordx4 a[112:115], v20, s[48:51], s45 offen offset:0 sc1
    v_mfma_f32_32x32x16_bf16 v[240:255], a[204:207], a[136:139], v[240:255]
    ds_read_b64_tr_b16 a[188:189], v13 offset:34816
    ds_read_b64_tr_b16 a[190:191], v13 offset:35328
    s_waitcnt lgkmcnt(8)
    v_mfma_f32_32x32x16_bf16 v[192:207], a[160:163], a[140:143], v[192:207]
    ds_read_b64_tr_b16 a[192:193], v10 offset:36864
    ds_read_b64_tr_b16 a[194:195], v10 offset:37376
    buffer_load_dwordx4 a[116:119], v20, s[48:51], s45 offen offset:1024 sc1
    v_mfma_f32_32x32x16_bf16 v[208:223], a[164:167], a[140:143], v[208:223]
    ds_read_b64_tr_b16 a[196:197], v10 offset:38912
    ds_read_b64_tr_b16 a[198:199], v10 offset:39424
    v_mfma_f32_32x32x16_bf16 v[224:239], a[168:171], a[140:143], v[224:239]
    ds_read_b64_tr_b16 a[200:201], v13 offset:36864
    ds_read_b64_tr_b16 a[202:203], v13 offset:37376
    buffer_load_dwordx4 a[120:123], v20, s[48:51], s45 offen offset:2048 sc1
    v_mfma_f32_32x32x16_bf16 v[240:255], a[172:175], a[140:143], v[240:255]
    ds_read_b64_tr_b16 a[204:205], v13 offset:38912
    ds_read_b64_tr_b16 a[206:207], v13 offset:39424
    s_waitcnt lgkmcnt(8)
    v_mfma_f32_32x32x16_bf16 v[192:207], a[176:179], a[144:147], v[192:207]
    ds_read_b64_tr_b16 a[160:161], v10 offset:40960
    ds_read_b64_tr_b16 a[162:163], v10 offset:41472
    buffer_load_dwordx4 v[68:71], v20, s[48:51], s45 offen offset:3072 sc1
    v_mfma_f32_32x32x16_bf16 v[208:223], a[180:183], a[144:147], v[208:223]
    ds_read_b64_tr_b16 a[164:165], v10 offset:43008
    ds_read_b64_tr_b16 a[166:167], v10 offset:43520
    v_mfma_f32_32x32x16_bf16 v[224:239], a[184:187], a[144:147], v[224:239]
    s_add_u32 s45, s20, 331776
    ds_read_b64_tr_b16 a[168:169], v13 offset:40960
    ds_read_b64_tr_b16 a[170:171], v13 offset:41472
    buffer_load_dwordx4 v[72:75], v20, s[48:51], s45 offen offset:0 sc1
    v_mfma_f32_32x32x16_bf16 v[240:255], a[188:191], a[144:147], v[240:255]
    ds_read_b64_tr_b16 a[172:173], v13 offset:43008
    ds_read_b64_tr_b16 a[174:175], v13 offset:43520
    s_waitcnt lgkmcnt(8)
    v_mfma_f32_32x32x16_bf16 v[192:207], a[192:195], a[148:151], v[192:207]
    s_add_u32 s45, s20, 368640
    ds_read_b64_tr_b16 a[176:177], v10 offset:45056
    ds_read_b64_tr_b16 a[178:179], v10 offset:45568
    buffer_load_dwordx4 v[76:79], v20, s[48:51], s45 offen offset:0 sc1
    s_waitcnt vmcnt(10)
    v_cmp_ne_u32 vcc, v5, v26
    s_nop 1
    s_and_b32 s34, vcc_lo, s28
    s_cbranch_scc1 L_slow_39
L_ok_40:
    s_barrier
    v_mfma_f32_32x32x16_bf16 v[208:223], a[196:199], a[148:151], v[208:223]
    ds_read_b64_tr_b16 a[180:181], v10 offset:47104
    ds_read_b64_tr_b16 a[182:183], v10 offset:47616
    v_mfma_f32_32x32x16_bf16 v[224:239], a[200:203], a[148:151], v[224:239]
    s_add_u32 s44, s18, 0
    ds_read_b64_tr_b16 a[184:185], v13 offset:45056
    ds_read_b64_tr_b16 a[186:187], v13 offset:45568
    buffer_load_dwordx4 v[80:83], v20, s[48:51], s44 offen offset:0 sc1
    v_mfma_f32_32x32x16_bf16 v[240:255], a[204:207], a[148:151], v[240:255]
    ds_read_b64_tr_b16 a[188:189], v13 offset:47104
    ds_read_b64_tr_b16 a[190:191], v13 offset:47616
    buffer_store_dword v26, v27, s[76:79], 0 offen offset:256 sc1
    s_waitcnt lgkmcnt(8)
    v_mfma_f32_32x32x16_bf16 v[192:207], a[160:163], a[152:155], v[192:207]
    v_mfma_f32_32x32x16_bf16 v[208:223], a[164:167], a[152:155], v[208:223]
    v_mfma_f32_32x32x16_bf16 v[224:239], a[168:171], a[152:155], v[224:239]
    buffer_load_dwordx4 v[84:87], v20, s[48:51], s44 offen offset:1024 sc1
    v_mfma_f32_32x32x16_bf16 v[240:255], a[172:175], a[152:155], v[240:255]
    s_waitcnt lgkmcnt(0)
    v_mfma_f32_32x32x16_bf16 v[192:207], a[176:179], a[156:159], v[192:207]
    buffer_load_dwordx4 a[124:127], v20, s[48:51], s44 offen offset:2048 sc1
    v_mfma_f32_32x32x16_bf16 v[208:223], a[180:183], a[156:159], v[208:223]
    v_mfma_f32_32x32x16_bf16 v[224:239], a[184:187], a[156:159], v[224:239]
    buffer_load_dwordx4 a[128:131], v20, s[48:51], s44 offen offset:3072 sc1
    v_mfma_f32_32x32x16_bf16 v[240:255], a[188:191], a[156:159], v[240:255]
    s_nop 7
    s_nop 3
    v_and_b32 v17, 15, v1
    v_mul_u32_u24 v17, 320, v17
    v_lshrrev_b32 v121, 4, v1
    v_bfe_u32 v120, v1, 1, 2
    v_xor_b32 v121, v121, v120
    v_lshl_add_u32 v17, v121, 4, v17
    s_mul_i32 s80, s3, 20480
    v_add_u32 v17, s80, v17
    v_lshrrev_b32 v116, 2, v1
    v_and_b32 v117, 3, v1
    v_lshlrev_b32 v118, 3, v117
    v_mul_u32_u24 v119, 1280, v116
    s_add_u32 s44, s18, 32768
    buffer_load_dwordx4 a[132:135], v20, s[48:51], s44 offen offset:0 sc1
    v_add_u32 v119, v119, v118
    v_lshlrev_b32 v120, 3, v116
    v_lshlrev_b32 v16, 1, v119
    v_bfe_u32 v121, v1, 3, 2
    v_xor_b32 v121, v121, v117
    v_mul_u32_u24 v15, 320, v116
    v_lshl_add_u32 v15, v121, 4, v15
    s_mul_i32 s81, s3, 5120
    v_add_u32 v15, s81, v15
    v_lshlrev_b32 v18, 3, v1
    s_mov_b32 s64, s16
    s_mov_b32 s65, s17
    buffer_load_dwordx4 a[136:139], v20, s[48:51], s44 offen offset:1024 sc1
    s_mov_b32 s66, 2621440
    s_mov_b32 s67, 0x00020000
    s_mov_b32 s60, s32
    s_mov_b32 s61, s33
    s_mov_b32 s62, 1280
    s_mov_b32 s63, 0x00020000
    buffer_load_dword v21, v120, s[48:51], s24 offen sc1
    buffer_load_dwordx2 v[48:49], v119, s[64:67], s26 offen offset:0
    buffer_load_dwordx2 v[50:51], v118, s[60:63], s25 offen offset:0
    buffer_load_dwordx4 a[140:143], v20, s[48:51], s44 offen offset:2048 sc1
    buffer_load_dwordx2 v[52:53], v119, s[64:67], s26 offen offset:32
    buffer_load_dwordx2 v[54:55], v118, s[60:63], s25 offen offset:32
    buffer_load_dwordx2 v[56:57], v119, s[64:67], s26 offen offset:64
    buffer_load_dwordx2 v[58:59], v118, s[60:63], s25 offen offset:64
    buffer_load_dwordx2 v[60:61], v119, s[64:67], s26 offen offset:96
    buffer_load_dwordx2 v[62:63], v118, s[60:63], s25 offen offset:96
    buffer_load_dwordx4 a[144:147], v20, s[48:51], s44 offen offset:3072 sc1
    buffer_load_dwordx2 v[64:65], v119, s[64:67], s26 offen offset:128
    buffer_load_dwordx2 v[66:67], v118, s[60:63], s25 offen offset:128
    s_lshl_b32 s83, s5, 13
    s_add_u32 s83, s83, s14
    s_add_u32 s83, s83, 163840
    v_pk_mul_f32 v[192:193], v[192:193], v[88:89] op_sel_hi:[1,0]
    v_pk_mul_f32 v[194:195], v[194:195], v[88:89] op_sel_hi:[1,0]
    v_exp_f32 v192, v192
    v_exp_f32 v193, v193
    s_add_u32 s44, s19, 0
    buffer_load_dwordx4 a[148:151], v20, s[48:51], s44 offen offset:0 sc1
    v_pk_mul_f32 v[196:197], v[196:197], v[88:89] op_sel_hi:[1,0]
    v_exp_f32 v194, v194
    v_exp_f32 v195, v195
    v_pk_fma_f32 v[192:193], v[192:193], v[88:89], v[88:89] op_sel:[0,1,1]
    v_pk_mul_f32 v[198:199], v[198:199], v[88:89] op_sel_hi:[1,0]
    v_exp_f32 v196, v196
    v_exp_f32 v197, v197
    v_pk_fma_f32 v[194:195], v[194:195], v[88:89], v[88:89] op_sel:[0,1,1]
    buffer_load_dwordx4 a[152:155], v20, s[48:51], s44 offen offset:1024 sc1
    v_rcp_f32 v192, v192
    v_rcp_f32 v193, v193
    v_pk_mul_f32 v[200:201], v[200:201], v[88:89] op_sel_hi:[1,0]
    v_exp_f32 v198, v198
    v_exp_f32 v199, v199
    v_pk_fma_f32 v[196:197], v[196:197], v[88:89], v[88:89] op_sel:[0,1,1]
    v_rcp_f32 v194, v194
    buffer_load_dwordx4 a[156:159], v20, s[48:51], s44 offen offset:2048 sc1
    v_rcp_f32 v195, v195
    v_pk_mul_f32 v[192:193], v[192:193], v[208:209]
    v_cvt_pk_bf16_f32 v208, v192, v193
    v_pk_mul_f32 v[202:203], v[202:203], v[88:89] op_sel_hi:[1,0]
    v_exp_f32 v200, v200
    v_exp_f32 v201, v201
    v_pk_fma_f32 v[198:199], v[198:199], v[88:89], v[88:89] op_sel:[0,1,1]
    v_rcp_f32 v196, v196
    buffer_load_dwordx4 a[160:163], v20, s[48:51], s44 offen offset:3072 sc1
    v_rcp_f32 v197, v197
    v_pk_mul_f32 v[194:195], v[194:195], v[210:211]
    v_cvt_pk_bf16_f32 v209, v194, v195
    v_pk_mul_f32 v[204:205], v[204:205], v[88:89] op_sel_hi:[1,0]
    v_exp_f32 v202, v202
    v_exp_f32 v203, v203
    v_pk_fma_f32 v[200:201], v[200:201], v[88:89], v[88:89] op_sel:[0,1,1]
    v_rcp_f32 v198, v198
    s_add_u32 s44, s19, 32768
    buffer_load_dwordx4 a[164:167], v20, s[48:51], s44 offen offset:0 sc1
    v_rcp_f32 v199, v199
    v_pk_mul_f32 v[196:197], v[196:197], v[212:213]
    v_cvt_pk_bf16_f32 v210, v196, v197
    v_pk_mul_f32 v[206:207], v[206:207], v[88:89] op_sel_hi:[1,0]
    v_exp_f32 v204, v204
    v_exp_f32 v205, v205
    v_pk_fma_f32 v[202:203], v[202:203], v[88:89], v[88:89] op_sel:[0,1,1]
    v_rcp_f32 v200, v200
    buffer_load_dwordx4 a[168:171], v20, s[48:51], s44 offen offset:1024 sc1
    v_rcp_f32 v201, v201
    v_pk_mul_f32 v[198:199], v[198:199], v[214:215]
    v_cvt_pk_bf16_f32 v211, v198, v199
    buffer_store_dwordx4 v[208:211], v19, s[48:51], s83 offen offset:0 sc1
    v_pk_mul_f32 v[224:225], v[224:225], v[88:89] op_sel_hi:[1,0]
    v_exp_f32 v206, v206
    v_exp_f32 v207, v207
    v_pk_fma_f32 v[204:205], v[204:205], v[88:89], v[88:89] op_sel:[0,1,1]
    buffer_load_dwordx4 a[172:175], v20, s[48:51], s44 offen offset:2048 sc1
    v_rcp_f32 v202, v202
    v_rcp_f32 v203, v203
    v_pk_mul_f32 v[200:201], v[200:201], v[216:217]
    v_cvt_pk_bf16_f32 v216, v200, v201
    v_pk_mul_f32 v[226:227], v[226:227], v[88:89] op_sel_hi:[1,0]
    v_exp_f32 v224, v224
    v_exp_f32 v225, v225
    v_pk_fma_f32 v[206:207], v[206:207], v[88:89], v[88:89] op_sel:[0,1,1]
    buffer_load_dwordx4 a[176:179], v20, s[48:51], s44 offen offset:3072 sc1
    v_rcp_f32 v204, v204
    v_rcp_f32 v205, v205
    v_pk_mul_f32 v[202:203], v[202:203], v[218:219]
    v_cvt_pk_bf16_f32 v217, v202, v203
    v_pk_mul_f32 v[228:229], v[228:229], v[88:89] op_sel_hi:[1,0]
    v_exp_f32 v226, v226
    v_exp_f32 v227, v227
    v_pk_fma_f32 v[224:225], v[224:225], v[88:89], v[88:89] op_sel:[0,1,1]
    buffer_load_dwordx4 a[180:183], v20, s[48:51], s45 offen offset:1024 sc1
    v_rcp_f32 v206, v206
    v_rcp_f32 v207, v207
    v_pk_mul_f32 v[204:205], v[204:205], v[220:221]
    v_cvt_pk_bf16_f32 v218, v204, v205
    v_pk_mul_f32 v[230:231], v[230:231], v[88:89] op_sel_hi:[1,0]
    v_exp_f32 v228, v228
    v_exp_f32 v229, v229
    v_pk_fma_f32 v[226:227], v[226:227], v[88:89], v[88:89] op_sel:[0,1,1]
    buffer_load_dwordx4 a[184:187], v20, s[48:51], s45 offen offset:2048 sc1
    v_rcp_f32 v224, v224
    v_rcp_f32 v225, v225
    v_pk_mul_f32 v[206:207], v[206:207], v[222:223]
    v_cvt_pk_bf16_f32 v219, v206, v207
    buffer_store_dwordx4 v[216:219], v19, s[48:51], s83 offen offset:512 sc1
    s_add_u32 s83, s83, 4096
    v_pk_mul_f32 v[232:233], v[232:233], v[88:89] op_sel_hi:[1,0]
    v_exp_f32 v230, v230
    buffer_load_dwordx4 a[188:191], v20, s[48:51], s45 offen offset:3072 sc1
    v_exp_f32 v231, v231
    v_pk_fma_f32 v[228:229], v[228:229], v[88:89], v[88:89] op_sel:[0,1,1]
    v_rcp_f32 v226, v226
    v_rcp_f32 v227, v227
    v_pk_mul_f32 v[224:225], v[224:225], v[240:241]
    v_cvt_pk_bf16_f32 v240, v224, v225
    v_pk_mul_f32 v[234:235], v[234:235], v[88:89] op_sel_hi:[1,0]
    v_exp_f32 v232, v232
    s_add_u32 s45, s20, 372736
    buffer_load_dwordx4 a[192:195], v20, s[48:51], s45 offen offset:0 sc1
    v_exp_f32 v233, v233
    v_pk_fma_f32 v[230:231], v[230:231], v[88:89], v[88:89] op_sel:[0,1,1]
    v_rcp_f32 v228, v228
    v_rcp_f32 v229, v229
    v_pk_mul_f32 v[226:227], v[226:227], v[242:243]
    v_cvt_pk_bf16_f32 v241, v226, v227
    v_pk_mul_f32 v[236:237], v[236:237], v[88:89] op_sel_hi:[1,0]
    v_exp_f32 v234, v234
    s_add_u32 s45, s20, 409600
    buffer_load_dwordx4 a[196:199], v20, s[48:51], s45 offen offset:0 sc1
    v_exp_f32 v235, v235
    v_pk_fma_f32 v[232:233], v[232:233], v[88:89], v[88:89] op_sel:[0,1,1]
    v_rcp_f32 v230, v230
    v_rcp_f32 v231, v231
    v_pk_mul_f32 v[228:229], v[228:229], v[244:245]
    v_cvt_pk_bf16_f32 v242, v228, v229
    v_pk_mul_f32 v[238:239], v[238:239], v[88:89] op_sel_hi:[1,0]
    v_exp_f32 v236, v236
    buffer_load_dwordx4 a[200:203], v20, s[48:51], s45 offen offset:1024 sc1
    v_exp_f32 v237, v237
    v_pk_fma_f32 v[234:235], v[234:235], v[88:89], v[88:89] op_sel:[0,1,1]
    v_rcp_f32 v232, v232
    v_rcp_f32 v233, v233
    buffer_load_dword v5, v2, s[76:79], 0 offen offset:256 sc1
    v_pk_mul_f32 v[230:231], v[230:231], v[246:247]
    v_cvt_pk_bf16_f32 v243, v230, v231
    buffer_store_dwordx4 v[240:243], v19, s[48:51], s83 offen offset:0 sc1
    v_exp_f32 v238, v238
    buffer_load_dwordx4 a[204:207], v20, s[48:51], s45 offen offset:2048 sc1
    v_exp_f32 v239, v239
    v_pk_fma_f32 v[236:237], v[236:237], v[88:89], v[88:89] op_sel:[0,1,1]
    v_rcp_f32 v234, v234
    v_rcp_f32 v235, v235
    v_pk_mul_f32 v[232:233], v[232:233], v[248:249]
    v_cvt_pk_bf16_f32 v248, v232, v233
    v_pk_fma_f32 v[238:239], v[238:239], v[88:89], v[88:89] op_sel:[0,1,1]
    v_rcp_f32 v236, v236
    v_rcp_f32 v237, v237
    v_pk_mul_f32 v[234:235], v[234:235], v[250:251]
    v_cvt_pk_bf16_f32 v249, v234, v235
    v_rcp_f32 v238, v238
    v_rcp_f32 v239, v239
    s_nop 0
    v_pk_mul_f32 v[236:237], v[236:237], v[252:253]
    v_cvt_pk_bf16_f32 v250, v236, v237
    s_nop 0
    v_pk_mul_f32 v[238:239], v[238:239], v[254:255]
    v_cvt_pk_bf16_f32 v251, v238, v239
    buffer_store_dwordx4 v[248:251], v19, s[48:51], s83 offen offset:512 sc1
    s_mov_b32 s52, s42
    s_mov_b32 s53, s43
    s_mov_b32 s54, 5242880
    s_mov_b32 s55, 0x00020000
    buffer_load_dwordx4 v[88:91], v20, s[48:51], s45 offen offset:3072 sc1
    s_add_u32 s45, s20, 413696
    buffer_load_dwordx4 v[92:95], v20, s[48:51], s45 offen offset:0 sc1
    s_waitcnt vmcnt(37)
    v_mfma_f32_16x16x32_bf16 v[96:99], a[224:227], v[80:83], 0
    s_waitcnt vmcnt(32)
    v_and_b32 v22, 0xffff0000, v21
    v_mfma_f32_16x16x32_bf16 v[100:103], a[228:231], v[80:83], 0
    v_rcp_f32 v22, v22
    v_mfma_f32_16x16x32_bf16 v[104:107], a[232:235], v[80:83], 0
    v_lshlrev_b32 v21, 16, v21
    v_mul_f32 v21, v21, v22
    v_mfma_f32_16x16x32_bf16 v[108:111], a[236:239], v[80:83], 0
    v_lshlrev_b32 v28, 16, v48
    v_lshlrev_b32 v23, 16, v50
    v_mfma_f32_16x16x32_bf16 v[112:115], a[240:243], v[80:83], 0
    v_fma_f32 v24, v28, v22, v21
    v_fmac_f32 v28, v24, v23
    v_mfma_f32_16x16x32_bf16 v[116:119], a[224:227], v[84:87], 0
    v_and_b32 v29, 0xffff0000, v48
    v_and_b32 v23, 0xffff0000, v50
    v_mfma_f32_16x16x32_bf16 v[120:123], a[228:231], v[84:87], 0
    v_fma_f32 v24, v29, v22, v21
    v_fmac_f32 v29, v24, v23
    s_add_u32 s45, s20, 450560
    s_add_u32 s45, s45, s99
    v_mfma_f32_16x16x32_bf16 v[124:127], a[232:235], v[84:87], 0
    buffer_load_dwordx4 v[80:83], v20, s[48:51], s45 offen offset:0 sc1
    v_mfma_f32_16x16x32_bf16 v[128:131], a[236:239], v[84:87], 0
    v_lshlrev_b32 v30, 16, v49
    v_lshlrev_b32 v23, 16, v51
    v_mfma_f32_16x16x32_bf16 v[132:135], a[240:243], v[84:87], 0
    v_fma_f32 v24, v30, v22, v21
    v_fmac_f32 v30, v24, v23
    v_mfma_f32_16x16x32_bf16 v[136:139], a[224:227], a[124:127], 0
    v_and_b32 v31, 0xffff0000, v49
    v_and_b32 v23, 0xffff0000, v51
    v_mfma_f32_16x16x32_bf16 v[140:143], a[228:231], a[124:127], 0
    buffer_load_dwordx4 v[84:87], v20, s[48:51], s45 offen offset:1024 sc1
    v_mfma_f32_16x16x32_bf16 v[144:147], a[232:235], a[124:127], 0
    v_fma_f32 v24, v31, v22, v21
    v_fmac_f32 v31, v24, v23
    v_mfma_f32_16x16x32_bf16 v[148:151], a[236:239], a[124:127], 0
    s_waitcnt vmcnt(31)
    v_lshlrev_b32 v32, 16, v52
    v_mfma_f32_16x16x32_bf16 v[152:155], a[240:243], a[124:127], 0
    v_lshlrev_b32 v23, 16, v54
    v_fma_f32 v24, v32, v22, v21
    v_mfma_f32_16x16x32_bf16 v[156:159], a[224:227], a[128:131], 0
    v_fmac_f32 v32, v24, v23
    v_and_b32 v33, 0xffff0000, v52
    v_mfma_f32_16x16x32_bf16 v[160:163], a[228:231], a[128:131], 0
    v_and_b32 v23, 0xffff0000, v54
    v_fma_f32 v24, v33, v22, v21
    v_mfma_f32_16x16x32_bf16 v[164:167], a[232:235], a[128:131], 0
    v_fmac_f32 v33, v24, v23
    v_lshlrev_b32 v34, 16, v53
    v_mfma_f32_16x16x32_bf16 v[168:171], a[236:239], a[128:131], 0
    v_lshlrev_b32 v23, 16, v55
    v_fma_f32 v24, v34, v22, v21
    v_mfma_f32_16x16x32_bf16 v[172:175], a[240:243], a[128:131], 0
    v_fmac_f32 v34, v24, v23
    v_and_b32 v35, 0xffff0000, v53
    s_waitcnt vmcnt(26)
    v_mfma_f32_16x16x32_bf16 v[96:99], a[244:247], a[132:135], v[96:99]
    v_and_b32 v23, 0xffff0000, v55
    v_fma_f32 v24, v35, v22, v21
    v_mfma_f32_16x16x32_bf16 v[100:103], a[248:251], a[132:135], v[100:103]
    v_fmac_f32 v35, v24, v23
    v_lshlrev_b32 v36, 16, v56
    v_mfma_f32_16x16x32_bf16 v[104:107], a[0:3], a[132:135], v[104:107]
    v_lshlrev_b32 v23, 16, v58
    v_fma_f32 v24, v36, v22, v21
    v_mfma_f32_16x16x32_bf16 v[108:111], a[4:7], a[132:135], v[108:111]
    v_fmac_f32 v36, v24, v23
    v_and_b32 v37, 0xffff0000, v56
    v_mfma_f32_16x16x32_bf16 v[112:115], a[8:11], a[132:135], v[112:115]
    v_and_b32 v23, 0xffff0000, v58
    v_fma_f32 v24, v37, v22, v21
    v_mfma_f32_16x16x32_bf16 v[116:119], a[244:247], a[136:139], v[116:119]
    v_fmac_f32 v37, v24, v23
    v_lshlrev_b32 v38, 16, v57
    v_mfma_f32_16x16x32_bf16 v[120:123], a[248:251], a[136:139], v[120:123]
    v_lshlrev_b32 v23, 16, v59
    v_fma_f32 v24, v38, v22, v21
    v_mfma_f32_16x16x32_bf16 v[124:127], a[0:3], a[136:139], v[124:127]
    v_fmac_f32 v38, v24, v23
    v_and_b32 v39, 0xffff0000, v57
    v_mfma_f32_16x16x32_bf16 v[128:131], a[4:7], a[136:139], v[128:131]
    v_and_b32 v23, 0xffff0000, v59
    v_fma_f32 v24, v39, v22, v21
    v_mfma_f32_16x16x32_bf16 v[132:135], a[8:11], a[136:139], v[132:135]
    v_fmac_f32 v39, v24, v23
    v_lshlrev_b32 v40, 16, v60
    v_mfma_f32_16x16x32_bf16 v[136:139], a[244:247], a[140:143], v[136:139]
    s_waitcnt vmcnt(4)
    buffer_store_dword v26, v27, s[76:79], 0 offen offset:384 sc1
    v_mfma_f32_16x16x32_bf16 v[140:143], a[248:251], a[140:143], v[140:143]
    v_lshlrev_b32 v23, 16, v62
    v_fma_f32 v24, v40, v22, v21
    v_mfma_f32_16x16x32_bf16 v[144:147], a[0:3], a[140:143], v[144:147]
    v_fmac_f32 v40, v24, v23
    v_and_b32 v41, 0xffff0000, v60
    v_mfma_f32_16x16x32_bf16 v[148:151], a[4:7], a[140:143], v[148:151]
    v_and_b32 v23, 0xffff0000, v62
    v_fma_f32 v24, v41, v22, v21
    v_mfma_f32_16x16x32_bf16 v[152:155], a[8:11], a[140:143], v[152:155]
    v_fmac_f32 v41, v24, v23
    v_lshlrev_b32 v42, 16, v61
    v_mfma_f32_16x16x32_bf16 v[156:159], a[244:247], a[144:147], v[156:159]
    v_lshlrev_b32 v23, 16, v63
    v_fma_f32 v24, v42, v22, v21
    v_mfma_f32_16x16x32_bf16 v[160:163], a[248:251], a[144:147], v[160:163]
    v_fmac_f32 v42, v24, v23
    v_and_b32 v43, 0xffff0000, v61
    v_mfma_f32_16x16x32_bf16 v[164:167], a[0:3], a[144:147], v[164:167]
    v_and_b32 v23, 0xffff0000, v63
    v_fma_f32 v24, v43, v22, v21
    v_mfma_f32_16x16x32_bf16 v[168:171], a[4:7], a[144:147], v[168:171]
    v_fmac_f32 v43, v24, v23
    v_lshlrev_b32 v44, 16, v64
    v_mfma_f32_16x16x32_bf16 v[172:175], a[8:11], a[144:147], v[172:175]
    v_cmp_ne_u32 vcc, v5, v26
    s_nop 1
    s_and_b32 s34, vcc_lo, 0xffff
    s_cbranch_scc1 L_slow_41
L_ok_42:
    s_barrier
    s_add_u32 s44, s18, 65536
    buffer_load_dwordx4 a[124:127], v20, s[48:51], s44 offen offset:0 sc1
    v_mfma_f32_16x16x32_bf16 v[176:179], a[224:227], a[148:151], 0
    v_lshlrev_b32 v23, 16, v66
    v_fma_f32 v24, v44, v22, v21
    v_mfma_f32_16x16x32_bf16 v[180:183], a[228:231], a[148:151], 0
    v_fmac_f32 v44, v24, v23
    v_and_b32 v45, 0xffff0000, v64
    v_mfma_f32_16x16x32_bf16 v[184:187], a[232:235], a[148:151], 0
    v_and_b32 v23, 0xffff0000, v66
    v_fma_f32 v24, v45, v22, v21
    v_mfma_f32_16x16x32_bf16 v[188:191], a[236:239], a[148:151], 0
    buffer_load_dwordx4 a[128:131], v20, s[48:51], s44 offen offset:1024 sc1
    v_mfma_f32_16x16x32_bf16 v[192:195], a[240:243], a[148:151], 0
    v_fmac_f32 v45, v24, v23
    v_lshlrev_b32 v46, 16, v65
    v_mfma_f32_16x16x32_bf16 v[196:199], a[224:227], a[152:155], 0
    v_lshlrev_b32 v23, 16, v67
    v_fma_f32 v24, v46, v22, v21
    v_mfma_f32_16x16x32_bf16 v[200:203], a[228:231], a[152:155], 0
    v_fmac_f32 v46, v24, v23
    v_and_b32 v47, 0xffff0000, v65
    v_mfma_f32_16x16x32_bf16 v[204:207], a[232:235], a[152:155], 0
    buffer_load_dwordx4 a[132:135], v20, s[48:51], s44 offen offset:2048 sc1
    v_mfma_f32_16x16x32_bf16 v[208:211], a[236:239], a[152:155], 0
    v_and_b32 v23, 0xffff0000, v67
    v_fma_f32 v24, v47, v22, v21
    v_mfma_f32_16x16x32_bf16 v[212:215], a[240:243], a[152:155], 0
    v_fmac_f32 v47, v24, v23
    v_mfma_f32_16x16x32_bf16 v[216:219], a[224:227], a[156:159], 0
    v_mfma_f32_16x16x32_bf16 v[220:223], a[228:231], a[156:159], 0
    buffer_load_dwordx4 a[136:139], v20, s[48:51], s44 offen offset:3072 sc1
    v_mfma_f32_16x16x32_bf16 v[224:227], a[232:235], a[156:159], 0
    v_mfma_f32_16x16x32_bf16 v[228:231], a[236:239], a[156:159], 0
    v_mfma_f32_16x16x32_bf16 v[232:235], a[240:243], a[156:159], 0
    s_add_u32 s44, s18, 98304
    v_mfma_f32_16x16x32_bf16 v[236:239], a[224:227], a[160:163], 0
    buffer_load_dwordx4 a[140:143], v20, s[48:51], s44 offen offset:0 sc1
    v_mfma_f32_16x16x32_bf16 v[240:243], a[228:231], a[160:163], 0
    v_mfma_f32_16x16x32_bf16 v[244:247], a[232:235], a[160:163], 0
    v_mfma_f32_16x16x32_bf16 v[248:251], a[236:239], a[160:163], 0
    v_mfma_f32_16x16x32_bf16 v[252:255], a[240:243], a[160:163], 0
    buffer_load_dwordx4 a[144:147], v20, s[48:51], s44 offen offset:1024 sc1
    v_mfma_f32_16x16x32_bf16 v[176:179], a[244:247], a[164:167], v[176:179]
    v_mfma_f32_16x16x32_bf16 v[180:183], a[248:251], a[164:167], v[180:183]
    v_mfma_f32_16x16x32_bf16 v[184:187], a[0:3], a[164:167], v[184:187]
    v_mfma_f32_16x16x32_bf16 v[188:191], a[4:7], a[164:167], v[188:191]
    buffer_load_dwordx4 a[148:151], v20, s[48:51], s44 offen offset:2048 sc1
    v_mfma_f32_16x16x32_bf16 v[192:195], a[8:11], a[164:167], v[192:195]
    v_mfma_f32_16x16x32_bf16 v[196:199], a[244:247], a[168:171], v[196:199]
    v_mfma_f32_16x16x32_bf16 v[200:203], a[248:251], a[168:171], v[200:203]
    v_mfma_f32_16x16x32_bf16 v[204:207], a[0:3], a[168:171], v[204:207]
    buffer_load_dwordx4 v[48:51], v20, s[48:51], s44 offen offset:3072 sc1
    v_mfma_f32_16x16x32_bf16 v[208:211], a[4:7], a[168:171], v[208:211]
    v_mfma_f32_16x16x32_bf16 v[212:215], a[8:11], a[168:171], v[212:215]
    v_mfma_f32_16x16x32_bf16 v[216:219], a[244:247], a[172:175], v[216:219]
    s_add_u32 s44, s18, 131072
    v_mfma_f32_16x16x32_bf16 v[220:223], a[248:251], a[172:175], v[220:223]
    buffer_load_dwordx4 v[52:55], v20, s[48:51], s44 offen offset:0 sc1
    v_mfma_f32_16x16x32_bf16 v[224:227], a[0:3], a[172:175], v[224:227]
    v_mfma_f32_16x16x32_bf16 v[228:231], a[4:7], a[172:175], v[228:231]
    v_mfma_f32_16x16x32_bf16 v[232:235], a[8:11], a[172:175], v[232:235]
    v_mfma_f32_16x16x32_bf16 v[236:239], a[244:247], a[176:179], v[236:239]
    buffer_load_dwordx4 v[56:59], v20, s[48:51], s44 offen offset:1024 sc1
    v_mfma_f32_16x16x32_bf16 v[240:243], a[248:251], a[176:179], v[240:243]
    v_mfma_f32_16x16x32_bf16 v[244:247], a[0:3], a[176:179], v[244:247]
    v_mfma_f32_16x16x32_bf16 v[248:251], a[4:7], a[176:179], v[248:251]
    v_mfma_f32_16x16x32_bf16 v[252:255], a[8:11], a[176:179], v[252:255]
    buffer_load_dwordx4 v[60:63], v20, s[48:51], s44 offen offset:2048 sc1
    s_waitcnt vmcnt(7)
    v_mfma_f32_16x16x32_bf16 v[96:99], a[12:15], a[124:127], v[96:99]
    v_mfma_f32_16x16x32_bf16 v[100:103], a[16:19], a[124:127], v[100:103]
    v_mfma_f32_16x16x32_bf16 v[104:107], a[20:23], a[124:127], v[104:107]
    v_mfma_f32_16x16x32_bf16 v[108:111], a[24:27], a[124:127], v[108:111]
    buffer_load_dwordx4 v[64:67], v20, s[48:51], s44 offen offset:3072 sc1
    v_mfma_f32_16x16x32_bf16 v[112:115], a[28:31], a[124:127], v[112:115]
    v_mfma_f32_16x16x32_bf16 v[116:119], a[12:15], a[128:131], v[116:119]
    v_mfma_f32_16x16x32_bf16 v[120:123], a[16:19], a[128:131], v[120:123]
    s_add_u32 s44, s18, 163840
    v_mfma_f32_16x16x32_bf16 v[124:127], a[20:23], a[128:131], v[124:127]
    buffer_load_dwordx4 a[152:155], v20, s[48:51], s44 offen offset:0 sc1
    v_mfma_f32_16x16x32_bf16 v[128:131], a[24:27], a[128:131], v[128:131]
    v_mfma_f32_16x16x32_bf16 v[132:135], a[28:31], a[128:131], v[132:135]
    v_mfma_f32_16x16x32_bf16 v[136:139], a[12:15], a[132:135], v[136:139]
    v_mfma_f32_16x16x32_bf16 v[140:143], a[16:19], a[132:135], v[140:143]
    buffer_load_dwordx4 a[156:159], v20, s[48:51], s44 offen offset:1024 sc1
    v_mfma_f32_16x16x32_bf16 v[144:147], a[20:23], a[132:135], v[144:147]
    v_mfma_f32_16x16x32_bf16 v[148:151], a[24:27], a[132:135], v[148:151]
    v_mfma_f32_16x16x32_bf16 v[152:155], a[28:31], a[132:135], v[152:155]
    v_mfma_f32_16x16x32_bf16 v[156:159], a[12:15], a[136:139], v[156:159]
    buffer_load_dwordx4 a[160:163], v20, s[48:51], s44 offen offset:2048 sc1
    v_mfma_f32_16x16x32_bf16 v[160:163], a[16:19], a[136:139], v[160:163]
    v_mfma_f32_16x16x32_bf16 v[164:167], a[20:23], a[136:139], v[164:167]
    v_mfma_f32_16x16x32_bf16 v[168:171], a[24:27], a[136:139], v[168:171]
    v_mfma_f32_16x16x32_bf16 v[172:175], a[28:31], a[136:139], v[172:175]
    buffer_load_dwordx4 a[224:227], v20, s[48:51], s44 offen offset:3072 sc1
    s_waitcnt vmcnt(8)
    v_mfma_f32_16x16x32_bf16 v[96:99], a[32:35], a[140:143], v[96:99]
    v_mfma_f32_16x16x32_bf16 v[100:103], a[36:39], a[140:143], v[100:103]
    v_mfma_f32_16x16x32_bf16 v[104:107], a[40:43], a[140:143], v[104:107]
    s_add_u32 s44, s18, 196608
    v_mfma_f32_16x16x32_bf16 v[108:111], a[44:47], a[140:143], v[108:111]
    buffer_load_dwordx4 a[228:231], v20, s[48:51], s44 offen offset:0 sc1
    v_mfma_f32_16x16x32_bf16 v[112:115], a[48:51], a[140:143], v[112:115]
    v_mfma_f32_16x16x32_bf16 v[116:119], a[32:35], a[144:147], v[116:119]
    v_mfma_f32_16x16x32_bf16 v[120:123], a[36:39], a[144:147], v[120:123]
    v_mfma_f32_16x16x32_bf16 v[124:127], a[40:43], a[144:147], v[124:127]
    buffer_load_dwordx4 a[232:235], v20, s[48:51], s44 offen offset:1024 sc1
    v_mfma_f32_16x16x32_bf16 v[128:131], a[44:47], a[144:147], v[128:131]
    v_mfma_f32_16x16x32_bf16 v[132:135], a[48:51], a[144:147], v[132:135]
    v_mfma_f32_16x16x32_bf16 v[136:139], a[32:35], a[148:151], v[136:139]
    v_mfma_f32_16x16x32_bf16 v[140:143], a[36:39], a[148:151], v[140:143]
    buffer_load_dwordx4 a[236:239], v20, s[48:51], s44 offen offset:2048 sc1
    v_mfma_f32_16x16x32_bf16 v[144:147], a[40:43], a[148:151], v[144:147]
    v_mfma_f32_16x16x32_bf16 v[148:151], a[44:47], a[148:151], v[148:151]
    v_mfma_f32_16x16x32_bf16 v[152:155], a[48:51], a[148:151], v[152:155]
    v_mfma_f32_16x16x32_bf16 v[156:159], a[32:35], v[48:51], v[156:159]
    buffer_load_dwordx4 a[240:243], v20, s[48:51], s44 offen offset:3072 sc1
    v_mfma_f32_16x16x32_bf16 v[160:163], a[36:39], v[48:51], v[160:163]
    v_mfma_f32_16x16x32_bf16 v[164:167], a[40:43], v[48:51], v[164:167]
    v_mfma_f32_16x16x32_bf16 v[168:171], a[44:47], v[48:51], v[168:171]
    s_add_u32 s44, s19, 65536
    v_mfma_f32_16x16x32_bf16 v[172:175], a[48:51], v[48:51], v[172:175]
    buffer_load_dwordx4 a[164:167], v20, s[48:51], s44 offen offset:0 sc1
    s_waitcnt vmcnt(9)
    v_mfma_f32_16x16x32_bf16 v[96:99], a[52:55], v[52:55], v[96:99]
    v_mfma_f32_16x16x32_bf16 v[100:103], a[56:59], v[52:55], v[100:103]
    v_mfma_f32_16x16x32_bf16 v[104:107], a[60:63], v[52:55], v[104:107]
    v_mfma_f32_16x16x32_bf16 v[108:111], a[64:67], v[52:55], v[108:111]
    buffer_load_dwordx4 a[168:171], v20, s[48:51], s44 offen offset:1024 sc1
    v_mfma_f32_16x16x32_bf16 v[112:115], a[68:71], v[52:55], v[112:115]
    v_mfma_f32_16x16x32_bf16 v[116:119], a[52:55], v[56:59], v[116:119]
    v_mfma_f32_16x16x32_bf16 v[120:123], a[56:59], v[56:59], v[120:123]
    v_mfma_f32_16x16x32_bf16 v[124:127], a[60:63], v[56:59], v[124:127]
    buffer_load_dwordx4 a[172:175], v20, s[48:51], s44 offen offset:2048 sc1
    v_mfma_f32_16x16x32_bf16 v[128:131], a[64:67], v[56:59], v[128:131]
    v_mfma_f32_16x16x32_bf16 v[132:135], a[68:71], v[56:59], v[132:135]
    v_mfma_f32_16x16x32_bf16 v[136:139], a[52:55], v[60:63], v[136:139]
    v_mfma_f32_16x16x32_bf16 v[140:143], a[56:59], v[60:63], v[140:143]
    buffer_load_dwordx4 a[176:179], v20, s[48:51], s44 offen offset:3072 sc1
    v_mfma_f32_16x16x32_bf16 v[144:147], a[60:63], v[60:63], v[144:147]
    v_mfma_f32_16x16x32_bf16 v[148:151], a[64:67], v[60:63], v[148:151]
    v_mfma_f32_16x16x32_bf16 v[152:155], a[68:71], v[60:63], v[152:155]
    s_add_u32 s44, s19, 98304
    v_mfma_f32_16x16x32_bf16 v[156:159], a[52:55], v[64:67], v[156:159]
    buffer_load_dwordx4 a[244:247], v20, s[48:51], s44 offen offset:0 sc1
    v_mfma_f32_16x16x32_bf16 v[160:163], a[56:59], v[64:67], v[160:163]
    v_mfma_f32_16x16x32_bf16 v[164:167], a[60:63], v[64:67], v[164:167]
    v_mfma_f32_16x16x32_bf16 v[168:171], a[64:67], v[64:67], v[168:171]
    v_mfma_f32_16x16x32_bf16 v[172:175], a[68:71], v[64:67], v[172:175]
    buffer_load_dwordx4 a[248:251], v20, s[48:51], s44 offen offset:1024 sc1
    s_waitcnt vmcnt(10)
    v_mfma_f32_16x16x32_bf16 v[96:99], a[208:211], a[152:155], v[96:99]
    v_mfma_f32_16x16x32_bf16 v[100:103], a[212:215], a[152:155], v[100:103]
    v_mfma_f32_16x16x32_bf16 v[104:107], a[216:219], a[152:155], v[104:107]
    v_mfma_f32_16x16x32_bf16 v[108:111], a[220:223], a[152:155], v[108:111]
    buffer_load_dwordx4 a[0:3], v20, s[48:51], s44 offen offset:2048 sc1
    v_mfma_f32_16x16x32_bf16 v[112:115], a[252:255], a[152:155], v[112:115]
    v_mfma_f32_16x16x32_bf16 v[116:119], a[208:211], a[156:159], v[116:119]
    v_mfma_f32_16x16x32_bf16 v[120:123], a[212:215], a[156:159], v[120:123]
    v_mfma_f32_16x16x32_bf16 v[124:127], a[216:219], a[156:159], v[124:127]
    buffer_load_dwordx4 a[4:7], v20, s[48:51], s44 offen offset:3072 sc1
    v_mfma_f32_16x16x32_bf16 v[128:131], a[220:223], a[156:159], v[128:131]
    v_mfma_f32_16x16x32_bf16 v[132:135], a[252:255], a[156:159], v[132:135]
    v_mfma_f32_16x16x32_bf16 v[136:139], a[208:211], a[160:163], v[136:139]
    s_add_u32 s44, s19, 131072
    v_mfma_f32_16x16x32_bf16 v[140:143], a[212:215], a[160:163], v[140:143]
    buffer_load_dwordx4 a[8:11], v20, s[48:51], s44 offen offset:0 sc1
    v_mfma_f32_16x16x32_bf16 v[144:147], a[216:219], a[160:163], v[144:147]
    v_mfma_f32_16x16x32_bf16 v[148:151], a[220:223], a[160:163], v[148:151]
    v_mfma_f32_16x16x32_bf16 v[152:155], a[252:255], a[160:163], v[152:155]
    v_mfma_f32_16x16x32_bf16 v[156:159], a[208:211], a[224:227], v[156:159]
    buffer_load_dwordx4 a[124:127], v20, s[48:51], s44 offen offset:1024 sc1
    v_mfma_f32_16x16x32_bf16 v[160:163], a[212:215], a[224:227], v[160:163]
    v_mfma_f32_16x16x32_bf16 v[164:167], a[216:219], a[224:227], v[164:167]
    v_mfma_f32_16x16x32_bf16 v[168:171], a[220:223], a[224:227], v[168:171]
    v_mfma_f32_16x16x32_bf16 v[172:175], a[252:255], a[224:227], v[172:175]
    buffer_load_dwordx4 a[128:131], v20, s[48:51], s44 offen offset:2048 sc1
    s_waitcnt vmcnt(11)
    v_mfma_f32_16x16x32_bf16 v[96:99], a[72:75], a[228:231], v[96:99]
    v_mfma_f32_16x16x32_bf16 v[100:103], a[76:79], a[228:231], v[100:103]
    v_mfma_f32_16x16x32_bf16 v[104:107], a[80:83], a[228:231], v[104:107]
    v_mfma_f32_16x16x32_bf16 v[108:111], a[84:87], a[228:231], v[108:111]
    buffer_load_dwordx4 a[132:135], v20, s[48:51], s44 offen offset:3072 sc1
    v_mfma_f32_16x16x32_bf16 v[112:115], a[88:91], a[228:231], v[112:115]
    v_mfma_f32_16x16x32_bf16 v[116:119], a[72:75], a[232:235], v[116:119]
    v_mfma_f32_16x16x32_bf16 v[120:123], a[76:79], a[232:235], v[120:123]
    v_mfma_f32_16x16x32_bf16 v[124:127], a[80:83], a[232:235], v[124:127]
    buffer_load_dwordx4 a[136:139], v20, s[48:51], s45 offen offset:2048 sc1
    v_mfma_f32_16x16x32_bf16 v[128:131], a[84:87], a[232:235], v[128:131]
    v_mfma_f32_16x16x32_bf16 v[132:135], a[88:91], a[232:235], v[132:135]
    v_mfma_f32_16x16x32_bf16 v[136:139], a[72:75], a[236:239], v[136:139]
    v_mfma_f32_16x16x32_bf16 v[140:143], a[76:79], a[236:239], v[140:143]
    buffer_load_dword v5, v2, s[76:79], 0 offen offset:384 sc1
    v_mfma_f32_16x16x32_bf16 v[144:147], a[80:83], a[236:239], v[144:147]
    v_mfma_f32_16x16x32_bf16 v[148:151], a[84:87], a[236:239], v[148:151]
    v_mfma_f32_16x16x32_bf16 v[152:155], a[88:91], a[236:239], v[152:155]
    v_mfma_f32_16x16x32_bf16 v[156:159], a[72:75], a[240:243], v[156:159]
    buffer_load_dwordx4 a[140:143], v20, s[48:51], s45 offen offset:3072 sc1
    v_mfma_f32_16x16x32_bf16 v[160:163], a[76:79], a[240:243], v[160:163]
    v_mfma_f32_16x16x32_bf16 v[164:167], a[80:83], a[240:243], v[164:167]
    v_mfma_f32_16x16x32_bf16 v[168:171], a[84:87], a[240:243], v[168:171]
    s_add_u32 s45, s20, 454656
    s_add_u32 s45, s45, s99
    v_mfma_f32_16x16x32_bf16 v[172:175], a[88:91], a[240:243], v[172:175]
    buffer_load_dwordx4 a[144:147], v20, s[48:51], s45 offen offset:0 sc1
    s_waitcnt vmcnt(12)
    v_mfma_f32_16x16x32_bf16 v[176:179], a[12:15], a[164:167], v[176:179]
    v_mfma_f32_16x16x32_bf16 v[180:183], a[16:19], a[164:167], v[180:183]
    v_mfma_f32_16x16x32_bf16 v[184:187], a[20:23], a[164:167], v[184:187]
    s_add_u32 s44, s19, 163840
    v_mfma_f32_16x16x32_bf16 v[188:191], a[24:27], a[164:167], v[188:191]
    buffer_load_dwordx4 a[148:151], v20, s[48:51], s44 offen offset:0 sc1
    v_mfma_f32_16x16x32_bf16 v[192:195], a[28:31], a[164:167], v[192:195]
    v_mfma_f32_16x16x32_bf16 v[196:199], a[12:15], a[168:171], v[196:199]
    v_mfma_f32_16x16x32_bf16 v[200:203], a[16:19], a[168:171], v[200:203]
    v_mfma_f32_16x16x32_bf16 v[204:207], a[20:23], a[168:171], v[204:207]
    buffer_load_dwordx4 v[48:51], v20, s[48:51], s44 offen offset:1024 sc1
    v_mfma_f32_16x16x32_bf16 v[208:211], a[24:27], a[168:171], v[208:211]
    v_mfma_f32_16x16x32_bf16 v[212:215], a[28:31], a[168:171], v[212:215]
    v_mfma_f32_16x16x32_bf16 v[216:219], a[12:15], a[172:175], v[216:219]
    v_mfma_f32_16x16x32_bf16 v[220:223], a[16:19], a[172:175], v[220:223]
    buffer_load_dwordx4 v[52:55], v20, s[48:51], s44 offen offset:2048 sc1
    v_mfma_f32_16x16x32_bf16 v[224:227], a[20:23], a[172:175], v[224:227]
    v_mfma_f32_16x16x32_bf16 v[228:231], a[24:27], a[172:175], v[228:231]
    v_mfma_f32_16x16x32_bf16 v[232:235], a[28:31], a[172:175], v[232:235]
    v_mfma_f32_16x16x32_bf16 v[236:239], a[12:15], a[176:179], v[236:239]
    buffer_load_dwordx4 v[56:59], v20, s[48:51], s44 offen offset:3072 sc1
    v_mfma_f32_16x16x32_bf16 v[240:243], a[16:19], a[176:179], v[240:243]
    v_mfma_f32_16x16x32_bf16 v[244:247], a[20:23], a[176:179], v[244:247]
    v_mfma_f32_16x16x32_bf16 v[248:251], a[24:27], a[176:179], v[248:251]
    s_add_u32 s44, s19, 196608
    v_mfma_f32_16x16x32_bf16 v[252:255], a[28:31], a[176:179], v[252:255]
    buffer_load_dwordx4 v[60:63], v20, s[48:51], s44 offen offset:0 sc1
    s_waitcnt vmcnt(13)
    v_mfma_f32_16x16x32_bf16 v[176:179], a[32:35], a[244:247], v[176:179]
    v_mfma_f32_16x16x32_bf16 v[180:183], a[36:39], a[244:247], v[180:183]
    v_mfma_f32_16x16x32_bf16 v[184:187], a[40:43], a[244:247], v[184:187]
    v_mfma_f32_16x16x32_bf16 v[188:191], a[44:47], a[244:247], v[188:191]
    s_waitcnt vmcnt(7)
    v_cmp_ne_u32 vcc, v5, v26
    s_nop 1
    s_and_b32 s34, vcc_lo, 0xffff
    s_cbranch_scc1 L_slow_43
L_ok_44:
    s_barrier
    s_add_u32 s44, s18, 229376
    buffer_load_dwordx4 v[64:67], v20, s[48:51], s44 offen offset:0 sc1
    v_mfma_f32_16x16x32_bf16 v[192:195], a[48:51], a[244:247], v[192:195]
    v_mfma_f32_16x16x32_bf16 v[196:199], a[32:35], a[248:251], v[196:199]
    v_mfma_f32_16x16x32_bf16 v[200:203], a[36:39], a[248:251], v[200:203]
    v_mfma_f32_16x16x32_bf16 v[204:207], a[40:43], a[248:251], v[204:207]
    buffer_load_dwordx4 a[152:155], v20, s[48:51], s44 offen offset:1024 sc1
    v_mfma_f32_16x16x32_bf16 v[208:211], a[44:47], a[248:251], v[208:211]
    v_mfma_f32_16x16x32_bf16 v[212:215], a[48:51], a[248:251], v[212:215]
    v_mfma_f32_16x16x32_bf16 v[216:219], a[32:35], a[0:3], v[216:219]
    v_mfma_f32_16x16x32_bf16 v[220:223], a[36:39], a[0:3], v[220:223]
    buffer_load_dwordx4 a[156:159], v20, s[48:51], s44 offen offset:2048 sc1
    v_mfma_f32_16x16x32_bf16 v[224:227], a[40:43], a[0:3], v[224:227]
    v_mfma_f32_16x16x32_bf16 v[228:231], a[44:47], a[0:3], v[228:231]
    v_mfma_f32_16x16x32_bf16 v[232:235], a[48:51], a[0:3], v[232:235]
    v_mfma_f32_16x16x32_bf16 v[236:239], a[32:35], a[4:7], v[236:239]
    buffer_load_dwordx4 a[160:163], v20, s[48:51], s44 offen offset:3072 sc1
    v_mfma_f32_16x16x32_bf16 v[240:243], a[36:39], a[4:7], v[240:243]
    v_mfma_f32_16x16x32_bf16 v[244:247], a[40:43], a[4:7], v[244:247]
    v_mfma_f32_16x16x32_bf16 v[248:251], a[44:47], a[4:7], v[248:251]
    s_add_u32 s44, s18, 262144
    v_mfma_f32_16x16x32_bf16 v[252:255], a[48:51], a[4:7], v[252:255]
    buffer_load_dwordx4 a[224:227], v20, s[48:51], s44 offen offset:0 sc1
    v_mfma_f32_16x16x32_bf16 v[176:179], a[52:55], a[8:11], v[176:179]
    v_mfma_f32_16x16x32_bf16 v[180:183], a[56:59], a[8:11], v[180:183]
    v_mfma_f32_16x16x32_bf16 v[184:187], a[60:63], a[8:11], v[184:187]
    v_mfma_f32_16x16x32_bf16 v[188:191], a[64:67], a[8:11], v[188:191]
    buffer_load_dwordx4 a[228:231], v20, s[48:51], s44 offen offset:1024 sc1
    v_mfma_f32_16x16x32_bf16 v[192:195], a[68:71], a[8:11], v[192:195]
    v_mfma_f32_16x16x32_bf16 v[196:199], a[52:55], a[124:127], v[196:199]
    v_mfma_f32_16x16x32_bf16 v[200:203], a[56:59], a[124:127], v[200:203]
    v_mfma_f32_16x16x32_bf16 v[204:207], a[60:63], a[124:127], v[204:207]
    buffer_load_dwordx4 a[232:235], v20, s[48:51], s44 offen offset:2048 sc1
    v_mfma_f32_16x16x32_bf16 v[208:211], a[64:67], a[124:127], v[208:211]
    v_mfma_f32_16x16x32_bf16 v[212:215], a[68:71], a[124:127], v[212:215]
    v_mfma_f32_16x16x32_bf16 v[216:219], a[52:55], a[128:131], v[216:219]
    v_mfma_f32_16x16x32_bf16 v[220:223], a[56:59], a[128:131], v[220:223]
    buffer_load_dwordx4 a[236:239], v20, s[48:51], s44 offen offset:3072 sc1
    v_mfma_f32_16x16x32_bf16 v[224:227], a[60:63], a[128:131], v[224:227]
    v_mfma_f32_16x16x32_bf16 v[228:231], a[64:67], a[128:131], v[228:231]
    v_mfma_f32_16x16x32_bf16 v[232:235], a[68:71], a[128:131], v[232:235]
    s_add_u32 s44, s18, 294912
    v_mfma_f32_16x16x32_bf16 v[236:239], a[52:55], a[132:135], v[236:239]
    buffer_load_dwordx4 a[240:243], v20, s[48:51], s44 offen offset:0 sc1
    v_mfma_f32_16x16x32_bf16 v[240:243], a[56:59], a[132:135], v[240:243]
    v_mfma_f32_16x16x32_bf16 v[244:247], a[60:63], a[132:135], v[244:247]
    v_mfma_f32_16x16x32_bf16 v[248:251], a[64:67], a[132:135], v[248:251]
    s_add_u32 s44, s18, 327680
    v_mfma_f32_16x16x32_bf16 v[252:255], a[68:71], a[132:135], v[252:255]
    buffer_load_dwordx4 a[164:167], v20, s[48:51], s44 offen offset:0 sc1
    s_waitcnt vmcnt(6)
    v_mfma_f32_16x16x32_bf16 v[96:99], a[92:95], v[64:67], v[96:99]
    v_mfma_f32_16x16x32_bf16 v[100:103], a[96:99], v[64:67], v[100:103]
    v_mfma_f32_16x16x32_bf16 v[104:107], a[100:103], v[64:67], v[104:107]
    s_add_u32 s44, s18, 360448
    s_add_u32 s44, s44, s99
    v_mfma_f32_16x16x32_bf16 v[108:111], a[104:107], v[64:67], v[108:111]
    buffer_load_dwordx4 a[168:171], v20, s[48:51], s44 offen offset:0 sc1
    v_mfma_f32_16x16x32_bf16 v[112:115], a[108:111], v[64:67], v[112:115]
    v_mfma_f32_16x16x32_bf16 v[116:119], a[92:95], a[152:155], v[116:119]
    v_mfma_f32_16x16x32_bf16 v[120:123], a[96:99], a[152:155], v[120:123]
    s_add_u32 s44, s18, 294912
    v_mfma_f32_16x16x32_bf16 v[124:127], a[100:103], a[152:155], v[124:127]
    buffer_load_dwordx4 a[172:175], v20, s[48:51], s44 offen offset:1024 sc1
    v_mfma_f32_16x16x32_bf16 v[128:131], a[104:107], a[152:155], v[128:131]
    v_mfma_f32_16x16x32_bf16 v[132:135], a[108:111], a[152:155], v[132:135]
    v_mfma_f32_16x16x32_bf16 v[136:139], a[92:95], a[156:159], v[136:139]
    s_add_u32 s44, s18, 327680
    v_mfma_f32_16x16x32_bf16 v[140:143], a[96:99], a[156:159], v[140:143]
    buffer_load_dwordx4 a[176:179], v20, s[48:51], s44 offen offset:1024 sc1
    v_mfma_f32_16x16x32_bf16 v[144:147], a[100:103], a[156:159], v[144:147]
    v_mfma_f32_16x16x32_bf16 v[148:151], a[104:107], a[156:159], v[148:151]
    v_mfma_f32_16x16x32_bf16 v[152:155], a[108:111], a[156:159], v[152:155]
    s_add_u32 s44, s18, 360448
    s_add_u32 s44, s44, s99
    v_mfma_f32_16x16x32_bf16 v[156:159], a[92:95], a[160:163], v[156:159]
    buffer_load_dwordx4 a[12:15], v20, s[48:51], s44 offen offset:1024 sc1
    v_mfma_f32_16x16x32_bf16 v[160:163], a[96:99], a[160:163], v[160:163]
    v_mfma_f32_16x16x32_bf16 v[164:167], a[100:103], a[160:163], v[164:167]
    v_mfma_f32_16x16x32_bf16 v[168:171], a[104:107], a[160:163], v[168:171]
    s_add_u32 s44, s18, 294912
    v_mfma_f32_16x16x32_bf16 v[172:175], a[108:111], a[160:163], v[172:175]
    buffer_load_dwordx4 a[16:19], v20, s[48:51], s44 offen offset:2048 sc1
    s_waitcnt vmcnt(7)
    v_mfma_f32_16x16x32_bf16 v[96:99], a[112:115], a[224:227], v[96:99]
    v_mfma_f32_16x16x32_bf16 v[100:103], a[116:119], a[224:227], v[100:103]
    v_mfma_f32_16x16x32_bf16 v[104:107], a[120:123], a[224:227], v[104:107]
    s_add_u32 s44, s18, 327680
    v_mfma_f32_16x16x32_bf16 v[108:111], v[68:71], a[224:227], v[108:111]
    buffer_load_dwordx4 a[20:23], v20, s[48:51], s44 offen offset:2048 sc1
    v_mfma_f32_16x16x32_bf16 v[112:115], v[72:75], a[224:227], v[112:115]
    v_mfma_f32_16x16x32_bf16 v[116:119], a[112:115], a[228:231], v[116:119]
    v_mfma_f32_16x16x32_bf16 v[120:123], a[116:119], a[228:231], v[120:123]
    s_add_u32 s44, s18, 360448
    s_add_u32 s44, s44, s99
    v_mfma_f32_16x16x32_bf16 v[124:127], a[120:123], a[228:231], v[124:127]
    buffer_load_dwordx4 a[24:27], v20, s[48:51], s44 offen offset:2048 sc1
    v_mfma_f32_16x16x32_bf16 v[128:131], v[68:71], a[228:231], v[128:131]
    v_mfma_f32_16x16x32_bf16 v[132:135], v[72:75], a[228:231], v[132:135]
    v_mfma_f32_16x16x32_bf16 v[136:139], a[112:115], a[232:235], v[136:139]
    s_add_u32 s44, s18, 294912
    v_mfma_f32_16x16x32_bf16 v[140:143], a[116:119], a[232:235], v[140:143]
    buffer_load_dwordx4 a[28:31], v20, s[48:51], s44 offen offset:3072 sc1
    v_mfma_f32_16x16x32_bf16 v[144:147], a[120:123], a[232:235], v[144:147]
    v_mfma_f32_16x16x32_bf16 v[148:151], v[68:71], a[232:235], v[148:151]
    v_mfma_f32_16x16x32_bf16 v[152:155], v[72:75], a[232:235], v[152:155]
    s_add_u32 s44, s18, 327680
    v_mfma_f32_16x16x32_bf16 v[156:159], a[112:115], a[236:239], v[156:159]
    buffer_load_dwordx4 a[244:247], v20, s[48:51], s44 offen offset:3072 sc1
    v_mfma_f32_16x16x32_bf16 v[160:163], a[116:119], a[236:239], v[160:163]
    v_mfma_f32_16x16x32_bf16 v[164:167], a[120:123], a[236:239], v[164:167]
    v_mfma_f32_16x16x32_bf16 v[168:171], v[68:71], a[236:239], v[168:171]
    s_add_u32 s44, s18, 360448
    s_add_u32 s44, s44, s99
    v_mfma_f32_16x16x32_bf16 v[172:175], v[72:75], a[236:239], v[172:175]
    buffer_load_dwordx4 a[248:251], v20, s[48:51], s44 offen offset:3072 sc1
    s_waitcnt vmcnt(9)
    v_mfma_f32_16x16x32_bf16 v[96:99], v[76:79], a[240:243], v[96:99]
    v_mfma_f32_16x16x32_bf16 v[100:103], a[180:183], a[240:243], v[100:103]
    v_mfma_f32_16x16x32_bf16 v[104:107], a[184:187], a[240:243], v[104:107]
    s_add_u32 s44, s19, 196608
    v_mfma_f32_16x16x32_bf16 v[108:111], a[188:191], a[240:243], v[108:111]
    buffer_load_dwordx4 a[0:3], v20, s[48:51], s44 offen offset:1024 sc1
    v_mfma_f32_16x16x32_bf16 v[112:115], a[192:195], a[240:243], v[112:115]
    v_mfma_f32_16x16x32_bf16 v[96:99], a[196:199], a[164:167], v[96:99]
    v_mfma_f32_16x16x32_bf16 v[100:103], a[200:203], a[164:167], v[100:103]
    v_mfma_f32_16x16x32_bf16 v[104:107], a[204:207], a[164:167], v[104:107]
    buffer_load_dwordx4 a[4:7], v20, s[48:51], s44 offen offset:2048 sc1
    v_mfma_f32_16x16x32_bf16 v[108:111], v[88:91], a[164:167], v[108:111]
    v_mfma_f32_16x16x32_bf16 v[112:115], v[92:95], a[164:167], v[112:115]
    v_mfma_f32_16x16x32_bf16 v[96:99], v[80:83], a[168:171], v[96:99]
    v_mfma_f32_16x16x32_bf16 v[100:103], v[84:87], a[168:171], v[100:103]
    buffer_load_dwordx4 a[32:35], v20, s[48:51], s44 offen offset:3072 sc1
    v_mfma_f32_16x16x32_bf16 v[104:107], a[136:139], a[168:171], v[104:107]
    v_mfma_f32_16x16x32_bf16 v[108:111], a[140:143], a[168:171], v[108:111]
    v_mfma_f32_16x16x32_bf16 v[112:115], a[144:147], a[168:171], v[112:115]
    s_waitcnt vmcnt(9)
    s_add_u32 s44, s19, 229376
    v_mfma_f32_16x16x32_bf16 v[116:119], v[76:79], a[172:175], v[116:119]
    buffer_load_dwordx4 a[36:39], v20, s[48:51], s44 offen offset:0 sc1
    v_mfma_f32_16x16x32_bf16 v[120:123], a[180:183], a[172:175], v[120:123]
    v_mfma_f32_16x16x32_bf16 v[124:127], a[184:187], a[172:175], v[124:127]
    ds_write_b128 v17, v[96:99] offset:0
    v_mfma_f32_16x16x32_bf16 v[128:131], a[188:191], a[172:175], v[128:131]
    v_mfma_f32_16x16x32_bf16 v[132:135], a[192:195], a[172:175], v[132:135]
    buffer_load_dwordx4 a[40:43], v20, s[48:51], s44 offen offset:1024 sc1
    v_mfma_f32_16x16x32_bf16 v[116:119], a[196:199], a[176:179], v[116:119]
    ds_write_b128 v17, v[100:103] offset:64
    v_mfma_f32_16x16x32_bf16 v[120:123], a[200:203], a[176:179], v[120:123]
    v_mfma_f32_16x16x32_bf16 v[124:127], a[204:207], a[176:179], v[124:127]
    v_mfma_f32_16x16x32_bf16 v[128:131], v[88:91], a[176:179], v[128:131]
    buffer_load_dwordx4 a[44:47], v20, s[48:51], s44 offen offset:2048 sc1
    ds_write_b128 v17, v[104:107] offset:128
    v_mfma_f32_16x16x32_bf16 v[132:135], v[92:95], a[176:179], v[132:135]
    v_mfma_f32_16x16x32_bf16 v[116:119], v[80:83], a[12:15], v[116:119]
    v_mfma_f32_16x16x32_bf16 v[120:123], v[84:87], a[12:15], v[120:123]
    ds_write_b128 v17, v[108:111] offset:192
    v_mfma_f32_16x16x32_bf16 v[124:127], a[136:139], a[12:15], v[124:127]
    buffer_load_dwordx4 a[48:51], v20, s[48:51], s44 offen offset:3072 sc1
    v_mfma_f32_16x16x32_bf16 v[128:131], a[140:143], a[12:15], v[128:131]
    v_mfma_f32_16x16x32_bf16 v[132:135], a[144:147], a[12:15], v[132:135]
    ds_write_b128 v17, v[112:115] offset:256
    s_waitcnt vmcnt(10)
    v_mfma_f32_16x16x32_bf16 v[136:139], v[76:79], a[16:19], v[136:139]
    s_add_u32 s44, s19, 262144
    v_mfma_f32_16x16x32_bf16 v[140:143], a[180:183], a[16:19], v[140:143]
    buffer_load_dwordx4 a[8:11], v20, s[48:51], s44 offen offset:0 sc1
    v_mfma_f32_16x16x32_bf16 v[144:147], a[184:187], a[16:19], v[144:147]
    ds_write_b128 v17, v[116:119] offset:5120
    v_mfma_f32_16x16x32_bf16 v[148:151], a[188:191], a[16:19], v[148:151]
    v_mfma_f32_16x16x32_bf16 v[152:155], a[192:195], a[16:19], v[152:155]
    v_mfma_f32_16x16x32_bf16 v[136:139], a[196:199], a[20:23], v[136:139]
    buffer_load_dwordx4 a[124:127], v20, s[48:51], s44 offen offset:1024 sc1
    ds_write_b128 v17, v[120:123] offset:5184
    v_mfma_f32_16x16x32_bf16 v[140:143], a[200:203], a[20:23], v[140:143]
    v_mfma_f32_16x16x32_bf16 v[144:147], a[204:207], a[20:23], v[144:147]
    v_mfma_f32_16x16x32_bf16 v[148:151], v[88:91], a[20:23], v[148:151]
    ds_write_b128 v17, v[124:127] offset:5248
    v_mfma_f32_16x16x32_bf16 v[152:155], v[92:95], a[20:23], v[152:155]
    buffer_load_dwordx4 a[128:131], v20, s[48:51], s44 offen offset:2048 sc1
    v_mfma_f32_16x16x32_bf16 v[136:139], v[80:83], a[24:27], v[136:139]
    v_mfma_f32_16x16x32_bf16 v[140:143], v[84:87], a[24:27], v[140:143]
    ds_write_b128 v17, v[128:131] offset:5312
    v_mfma_f32_16x16x32_bf16 v[144:147], a[136:139], a[24:27], v[144:147]
    v_mfma_f32_16x16x32_bf16 v[148:151], a[140:143], a[24:27], v[148:151]
    buffer_load_dwordx4 a[132:135], v20, s[48:51], s44 offen offset:3072 sc1
    v_mfma_f32_16x16x32_bf16 v[152:155], a[144:147], a[24:27], v[152:155]
    ds_write_b128 v17, v[132:135] offset:5376
    s_waitcnt vmcnt(11)
    v_mfma_f32_16x16x32_bf16 v[156:159], v[76:79], a[28:31], v[156:159]
    v_mfma_f32_16x16x32_bf16 v[160:163], a[180:183], a[28:31], v[160:163]
    s_add_u32 s44, s19, 294912
    v_mfma_f32_16x16x32_bf16 v[164:167], a[184:187], a[28:31], v[164:167]
    buffer_load_dwordx4 a[52:55], v20, s[48:51], s44 offen offset:0 sc1
    ds_write_b128 v17, v[136:139] offset:10240
    v_mfma_f32_16x16x32_bf16 v[168:171], a[188:191], a[28:31], v[168:171]
    v_mfma_f32_16x16x32_bf16 v[172:175], a[192:195], a[28:31], v[172:175]
    v_mfma_f32_16x16x32_bf16 v[156:159], a[196:199], a[244:247], v[156:159]
    ds_write_b128 v17, v[140:143] offset:10304
    s_add_u32 s44, s19, 327680
    v_mfma_f32_16x16x32_bf16 v[160:163], a[200:203], a[244:247], v[160:163]
    buffer_load_dwordx4 a[56:59], v20, s[48:51], s44 offen offset:0 sc1
    v_mfma_f32_16x16x32_bf16 v[164:167], a[204:207], a[244:247], v[164:167]
    v_mfma_f32_16x16x32_bf16 v[168:171], v[88:91], a[244:247], v[168:171]
    ds_write_b128 v17, v[144:147] offset:10368
    v_mfma_f32_16x16x32_bf16 v[172:175], v[92:95], a[244:247], v[172:175]
    s_add_u32 s44, s19, 360448
    s_add_u32 s44, s44, s99
    v_mfma_f32_16x16x32_bf16 v[156:159], v[80:83], a[248:251], v[156:159]
    buffer_load_dwordx4 a[60:63], v20, s[48:51], s44 offen offset:0 sc1
    v_mfma_f32_16x16x32_bf16 v[160:163], v[84:87], a[248:251], v[160:163]
    ds_write_b128 v17, v[148:151] offset:10432
    v_mfma_f32_16x16x32_bf16 v[164:167], a[136:139], a[248:251], v[164:167]
    v_mfma_f32_16x16x32_bf16 v[168:171], a[140:143], a[248:251], v[168:171]
    s_add_u32 s44, s19, 294912
    v_mfma_f32_16x16x32_bf16 v[172:175], a[144:147], a[248:251], v[172:175]
    buffer_load_dwordx4 a[64:67], v20, s[48:51], s44 offen offset:1024 sc1
    ds_write_b128 v17, v[152:155] offset:10496
    v_mfma_f32_16x16x32_bf16 v[176:179], a[208:211], a[148:151], v[176:179]
    v_mfma_f32_16x16x32_bf16 v[180:183], a[212:215], a[148:151], v[180:183]
    v_mfma_f32_16x16x32_bf16 v[184:187], a[216:219], a[148:151], v[184:187]
    ds_write_b128 v17, v[156:159] offset:15360
    s_add_u32 s44, s19, 327680
    v_mfma_f32_16x16x32_bf16 v[188:191], a[220:223], a[148:151], v[188:191]
    buffer_load_dwordx4 a[68:71], v20, s[48:51], s44 offen offset:1024 sc1
    v_mfma_f32_16x16x32_bf16 v[192:195], a[252:255], a[148:151], v[192:195]
    v_mfma_f32_16x16x32_bf16 v[196:199], a[208:211], v[48:51], v[196:199]
    ds_write_b128 v17, v[160:163] offset:15424
    v_mfma_f32_16x16x32_bf16 v[200:203], a[212:215], v[48:51], v[200:203]
    s_add_u32 s44, s19, 360448
    s_add_u32 s44, s44, s99
    v_mfma_f32_16x16x32_bf16 v[204:207], a[216:219], v[48:51], v[204:207]
    buffer_load_dwordx4 v[64:67], v20, s[48:51], s44 offen offset:1024 sc1
    v_mfma_f32_16x16x32_bf16 v[208:211], a[220:223], v[48:51], v[208:211]
    ds_write_b128 v17, v[164:167] offset:15488
    v_mfma_f32_16x16x32_bf16 v[212:215], a[252:255], v[48:51], v[212:215]
    v_mfma_f32_16x16x32_bf16 v[216:219], a[208:211], v[52:55], v[216:219]
    s_add_u32 s44, s19, 294912
    v_mfma_f32_16x16x32_bf16 v[220:223], a[212:215], v[52:55], v[220:223]
    buffer_load_dwordx4 a[152:155], v20, s[48:51], s44 offen offset:2048 sc1
    ds_write_b128 v17, v[168:171] offset:15552
    v_mfma_f32_16x16x32_bf16 v[224:227], a[216:219], v[52:55], v[224:227]
    v_mfma_f32_16x16x32_bf16 v[228:231], a[220:223], v[52:55], v[228:231]
    v_mfma_f32_16x16x32_bf16 v[232:235], a[252:255], v[52:55], v[232:235]
    ds_write_b128 v17, v[172:175] offset:15616
    s_add_u32 s44, s19, 327680
    v_mfma_f32_16x16x32_bf16 v[236:239], a[208:211], v[56:59], v[236:239]
    buffer_load_dwordx4 a[156:159], v20, s[48:51], s44 offen offset:2048 sc1
    v_mfma_f32_16x16x32_bf16 v[240:243], a[212:215], v[56:59], v[240:243]
    v_mfma_f32_16x16x32_bf16 v[244:247], a[216:219], v[56:59], v[244:247]
    v_mfma_f32_16x16x32_bf16 v[248:251], a[220:223], v[56:59], v[248:251]
    s_add_u32 s44, s19, 360448
    s_add_u32 s44, s44, s99
    v_mfma_f32_16x16x32_bf16 v[252:255], a[252:255], v[56:59], v[252:255]
    buffer_load_dwordx4 a[160:163], v20, s[48:51], s44 offen offset:2048 sc1
    s_waitcnt vmcnt(17)
    v_mfma_f32_16x16x32_bf16 v[176:179], a[72:75], v[60:63], v[176:179]
    s_waitcnt lgkmcnt(0)
    s_barrier
    v_mfma_f32_16x16x32_bf16 v[180:183], a[76:79], v[60:63], v[180:183]
    ds_read_b128 v[96:99], v15 offset:0
    ds_read_b128 v[100:103], v15 offset:20480
    v_mfma_f32_16x16x32_bf16 v[184:187], a[80:83], v[60:63], v[184:187]
    ds_read_b128 v[104:107], v15 offset:40960
    ds_read_b128 v[108:111], v15 offset:61440
    s_add_u32 s44, s19, 294912
    v_mfma_f32_16x16x32_bf16 v[188:191], a[84:87], v[60:63], v[188:191]
    buffer_load_dwordx4 a[224:227], v20, s[48:51], s44 offen offset:3072 sc1
    v_mfma_f32_16x16x32_bf16 v[192:195], a[88:91], v[60:63], v[192:195]
    ds_read_b128 v[112:115], v15 offset:64
    ds_read_b128 v[116:119], v15 offset:20544
    v_mfma_f32_16x16x32_bf16 v[196:199], a[72:75], a[0:3], v[196:199]
    ds_read_b128 v[120:123], v15 offset:41024
    ds_read_b128 v[124:127], v15 offset:61504
    v_mfma_f32_16x16x32_bf16 v[200:203], a[76:79], a[0:3], v[200:203]
    ds_read_b128 v[128:131], v15 offset:128
    ds_read_b128 v[132:135], v15 offset:20608
    s_add_u32 s44, s19, 327680
    v_mfma_f32_16x16x32_bf16 v[204:207], a[80:83], a[0:3], v[204:207]
    buffer_load_dwordx4 a[228:231], v20, s[48:51], s44 offen offset:3072 sc1
    v_mfma_f32_16x16x32_bf16 v[208:211], a[84:87], a[0:3], v[208:211]
    ds_read_b128 v[136:139], v15 offset:41088
    ds_read_b128 v[140:143], v15 offset:61568
    v_mfma_f32_16x16x32_bf16 v[212:215], a[88:91], a[0:3], v[212:215]
    ds_read_b128 v[144:147], v15 offset:192
    ds_read_b128 v[148:151], v15 offset:20672
    v_mfma_f32_16x16x32_bf16 v[216:219], a[72:75], a[4:7], v[216:219]
    ds_read_b128 v[152:155], v15 offset:41152
    ds_read_b128 v[156:159], v15 offset:61632
    s_add_u32 s44, s19, 360448
    s_add_u32 s44, s44, s99
    v_mfma_f32_16x16x32_bf16 v[220:223], a[76:79], a[4:7], v[220:223]
    buffer_load_dwordx4 a[232:235], v20, s[48:51], s44 offen offset:3072 sc1
    v_mfma_f32_16x16x32_bf16 v[224:227], a[80:83], a[4:7], v[224:227]
    ds_read_b128 v[160:163], v15 offset:256
    ds_read_b128 v[164:167], v15 offset:20736
    v_mfma_f32_16x16x32_bf16 v[228:231], a[84:87], a[4:7], v[228:231]
    ds_read_b128 v[168:171], v15 offset:41216
    ds_read_b128 v[172:175], v15 offset:61696
    v_mfma_f32_16x16x32_bf16 v[232:235], a[88:91], a[4:7], v[232:235]
    v_mfma_f32_16x16x32_bf16 v[236:239], a[72:75], a[32:35], v[236:239]
    v_mfma_f32_16x16x32_bf16 v[240:243], a[76:79], a[32:35], v[240:243]
    s_waitcnt lgkmcnt(15)
    v_add_f32 v96, v96, v100
    v_add_f32 v97, v97, v101
    v_add_f32 v98, v98, v102
    v_mfma_f32_16x16x32_bf16 v[244:247], a[80:83], a[32:35], v[244:247]
    v_add_f32 v99, v99, v103
    v_add_f32 v104, v104, v108
    v_add_f32 v105, v105, v109
    v_add_f32 v106, v106, v110
    v_mfma_f32_16x16x32_bf16 v[248:251], a[84:87], a[32:35], v[248:251]
    v_add_f32 v107, v107, v111
    v_add_f32 v96, v96, v104
    v_add_f32 v97, v97, v105
    v_add_f32 v98, v98, v106
    v_mfma_f32_16x16x32_bf16 v[252:255], a[88:91], a[32:35], v[252:255]
    v_add_f32 v99, v99, v107
    v_cvt_pk_bf16_f32 v100, v96, v97
    v_cvt_pk_bf16_f32 v101, v98, v99
    s_waitcnt lgkmcnt(12)
    s_waitcnt vmcnt(16)
    v_mfma_f32_16x16x32_bf16 v[176:179], a[92:95], a[36:39], v[176:179]
    v_add_f32 v112, v112, v116
    v_add_f32 v113, v113, v117
    v_add_f32 v114, v114, v118
    v_add_f32 v115, v115, v119
    v_mfma_f32_16x16x32_bf16 v[180:183], a[96:99], a[36:39], v[180:183]
    v_add_f32 v120, v120, v124
    v_add_f32 v121, v121, v125
    v_add_f32 v122, v122, v126
    v_add_f32 v123, v123, v127
    v_mfma_f32_16x16x32_bf16 v[184:187], a[100:103], a[36:39], v[184:187]
    v_add_f32 v112, v112, v120
    v_add_f32 v113, v113, v121
    v_add_f32 v114, v114, v122
    v_add_f32 v115, v115, v123
    v_mfma_f32_16x16x32_bf16 v[188:191], a[104:107], a[36:39], v[188:191]
    v_cvt_pk_bf16_f32 v102, v112, v113
    v_cvt_pk_bf16_f32 v108, v114, v115
    v_mov_b32 v103, v26
    v_mfma_f32_16x16x32_bf16 v[192:195], a[108:111], a[36:39], v[192:195]
    buffer_store_dwordx4 v[100:103], v20, s[48:51], s22 offen offset:0 sc1
    s_waitcnt lgkmcnt(8)
    v_add_f32 v128, v128, v132
    v_mfma_f32_16x16x32_bf16 v[196:199], a[92:95], a[40:43], v[196:199]
    v_add_f32 v129, v129, v133
    v_add_f32 v130, v130, v134
    v_add_f32 v131, v131, v135
    v_add_f32 v136, v136, v140
    v_mfma_f32_16x16x32_bf16 v[200:203], a[96:99], a[40:43], v[200:203]
    v_add_f32 v137, v137, v141
    v_add_f32 v138, v138, v142
    v_add_f32 v139, v139, v143
    v_add_f32 v128, v128, v136
    v_mfma_f32_16x16x32_bf16 v[204:207], a[100:103], a[40:43], v[204:207]
    v_add_f32 v129, v129, v137
    v_add_f32 v130, v130, v138
    v_add_f32 v131, v131, v139
    v_cvt_pk_bf16_f32 v109, v128, v129
    v_mfma_f32_16x16x32_bf16 v[208:211], a[104:107], a[40:43], v[208:211]
    v_cvt_pk_bf16_f32 v110, v130, v131
    v_mov_b32 v111, v26
    v_mfma_f32_16x16x32_bf16 v[212:215], a[108:111], a[40:43], v[212:215]
    buffer_store_dwordx4 v[108:111], v20, s[48:51], s22 offen offset:1024 sc1
    s_waitcnt lgkmcnt(4)
    v_add_f32 v144, v144, v148
    v_mfma_f32_16x16x32_bf16 v[216:219], a[92:95], a[44:47], v[216:219]
    v_add_f32 v145, v145, v149
    v_add_f32 v146, v146, v150
    v_add_f32 v147, v147, v151
    v_add_f32 v152, v152, v156
    v_mfma_f32_16x16x32_bf16 v[220:223], a[96:99], a[44:47], v[220:223]
    v_add_f32 v153, v153, v157
    v_add_f32 v154, v154, v158
    v_add_f32 v155, v155, v159
    v_add_f32 v144, v144, v152
    v_mfma_f32_16x16x32_bf16 v[224:227], a[100:103], a[44:47], v[224:227]
    v_add_f32 v145, v145, v153
    v_add_f32 v146, v146, v154
    v_add_f32 v147, v147, v155
    v_cvt_pk_bf16_f32 v116, v144, v145
    v_mfma_f32_16x16x32_bf16 v[228:231], a[104:107], a[44:47], v[228:231]
    v_cvt_pk_bf16_f32 v117, v146, v147
    s_waitcnt lgkmcnt(0)
    v_add_f32 v160, v160, v164
    v_add_f32 v161, v161, v165
    v_mfma_f32_16x16x32_bf16 v[232:235], a[108:111], a[44:47], v[232:235]
    v_add_f32 v162, v162, v166
    v_add_f32 v163, v163, v167
    v_add_f32 v168, v168, v172
    v_add_f32 v169, v169, v173
    v_mfma_f32_16x16x32_bf16 v[236:239], a[92:95], a[48:51], v[236:239]
    v_add_f32 v170, v170, v174
    v_add_f32 v171, v171, v175
    v_add_f32 v160, v160, v168
    v_add_f32 v161, v161, v169
    v_mfma_f32_16x16x32_bf16 v[240:243], a[96:99], a[48:51], v[240:243]
    v_add_f32 v162, v162, v170
    v_add_f32 v163, v163, v171
    v_cvt_pk_bf16_f32 v118, v160, v161
    v_cvt_pk_bf16_f32 v124, v162, v163
    v_mfma_f32_16x16x32_bf16 v[244:247], a[100:103], a[48:51], v[244:247]
    v_mov_b32 v119, v26
    v_mfma_f32_16x16x32_bf16 v[248:251], a[104:107], a[48:51], v[248:251]
    buffer_store_dwordx4 v[116:119], v20, s[48:51], s22 offen offset:2048 sc1
    v_mov_b32 v125, v26
    v_mfma_f32_16x16x32_bf16 v[252:255], a[108:111], a[48:51], v[252:255]
    buffer_store_dwordx2 v[124:125], v18, s[48:51], s22 offen offset:3072 sc1
    s_barrier
    s_waitcnt vmcnt(16)
    v_mfma_f32_16x16x32_bf16 v[176:179], a[112:115], a[8:11], v[176:179]
    v_mfma_f32_16x16x32_bf16 v[180:183], a[116:119], a[8:11], v[180:183]
    v_mfma_f32_16x16x32_bf16 v[184:187], a[120:123], a[8:11], v[184:187]
    v_mfma_f32_16x16x32_bf16 v[188:191], v[68:71], a[8:11], v[188:191]
    v_mfma_f32_16x16x32_bf16 v[192:195], v[72:75], a[8:11], v[192:195]
    v_mfma_f32_16x16x32_bf16 v[196:199], a[112:115], a[124:127], v[196:199]
    v_mfma_f32_16x16x32_bf16 v[200:203], a[116:119], a[124:127], v[200:203]
    v_mfma_f32_16x16x32_bf16 v[204:207], a[120:123], a[124:127], v[204:207]
    v_mfma_f32_16x16x32_bf16 v[208:211], v[68:71], a[124:127], v[208:211]
    v_mfma_f32_16x16x32_bf16 v[212:215], v[72:75], a[124:127], v[212:215]
    v_mfma_f32_16x16x32_bf16 v[216:219], a[112:115], a[128:131], v[216:219]
    v_mfma_f32_16x16x32_bf16 v[220:223], a[116:119], a[128:131], v[220:223]
    v_mfma_f32_16x16x32_bf16 v[224:227], a[120:123], a[128:131], v[224:227]
    v_mfma_f32_16x16x32_bf16 v[228:231], v[68:71], a[128:131], v[228:231]
    v_mfma_f32_16x16x32_bf16 v[232:235], v[72:75], a[128:131], v[232:235]
    v_mfma_f32_16x16x32_bf16 v[236:239], a[112:115], a[132:135], v[236:239]
    v_mfma_f32_16x16x32_bf16 v[240:243], a[116:119], a[132:135], v[240:243]
    v_mfma_f32_16x16x32_bf16 v[244:247], a[120:123], a[132:135], v[244:247]
    v_mfma_f32_16x16x32_bf16 v[248:251], v[68:71], a[132:135], v[248:251]
    v_mfma_f32_16x16x32_bf16 v[252:255], v[72:75], a[132:135], v[252:255]
    s_waitcnt vmcnt(13)
    v_mfma_f32_16x16x32_bf16 v[176:179], v[76:79], a[52:55], v[176:179]
    v_mfma_f32_16x16x32_bf16 v[180:183], a[180:183], a[52:55], v[180:183]
    v_mfma_f32_16x16x32_bf16 v[184:187], a[184:187], a[52:55], v[184:187]
    v_mfma_f32_16x16x32_bf16 v[188:191], a[188:191], a[52:55], v[188:191]
    v_mfma_f32_16x16x32_bf16 v[192:195], a[192:195], a[52:55], v[192:195]
    v_mfma_f32_16x16x32_bf16 v[176:179], a[196:199], a[56:59], v[176:179]
    v_mfma_f32_16x16x32_bf16 v[180:183], a[200:203], a[56:59], v[180:183]
    v_mfma_f32_16x16x32_bf16 v[184:187], a[204:207], a[56:59], v[184:187]
    v_mfma_f32_16x16x32_bf16 v[188:191], v[88:91], a[56:59], v[188:191]
    v_mfma_f32_16x16x32_bf16 v[192:195], v[92:95], a[56:59], v[192:195]
    v_mfma_f32_16x16x32_bf16 v[176:179], v[80:83], a[60:63], v[176:179]
    v_mfma_f32_16x16x32_bf16 v[180:183], v[84:87], a[60:63], v[180:183]
    v_mfma_f32_16x16x32_bf16 v[184:187], a[136:139], a[60:63], v[184:187]
    v_mfma_f32_16x16x32_bf16 v[188:191], a[140:143], a[60:63], v[188:191]
    v_mfma_f32_16x16x32_bf16 v[192:195], a[144:147], a[60:63], v[192:195]
    s_waitcnt vmcnt(10)
    v_mfma_f32_16x16x32_bf16 v[196:199], v[76:79], a[64:67], v[196:199]
    v_mfma_f32_16x16x32_bf16 v[200:203], a[180:183], a[64:67], v[200:203]
    v_mfma_f32_16x16x32_bf16 v[204:207], a[184:187], a[64:67], v[204:207]
    ds_write_b128 v17, v[176:179] offset:0
    v_mfma_f32_16x16x32_bf16 v[208:211], a[188:191], a[64:67], v[208:211]
    v_mfma_f32_16x16x32_bf16 v[212:215], a[192:195], a[64:67], v[212:215]
    v_mfma_f32_16x16x32_bf16 v[196:199], a[196:199], a[68:71], v[196:199]
    ds_write_b128 v17, v[180:183] offset:64
    v_mfma_f32_16x16x32_bf16 v[200:203], a[200:203], a[68:71], v[200:203]
    v_mfma_f32_16x16x32_bf16 v[204:207], a[204:207], a[68:71], v[204:207]
    v_mfma_f32_16x16x32_bf16 v[208:211], v[88:91], a[68:71], v[208:211]
    ds_write_b128 v17, v[184:187] offset:128
    v_mfma_f32_16x16x32_bf16 v[212:215], v[92:95], a[68:71], v[212:215]
    v_mfma_f32_16x16x32_bf16 v[196:199], v[80:83], v[64:67], v[196:199]
    v_mfma_f32_16x16x32_bf16 v[200:203], v[84:87], v[64:67], v[200:203]
    ds_write_b128 v17, v[188:191] offset:192
    v_mfma_f32_16x16x32_bf16 v[204:207], a[136:139], v[64:67], v[204:207]
    v_mfma_f32_16x16x32_bf16 v[208:211], a[140:143], v[64:67], v[208:211]
    v_mfma_f32_16x16x32_bf16 v[212:215], a[144:147], v[64:67], v[212:215]
    ds_write_b128 v17, v[192:195] offset:256
    s_waitcnt vmcnt(7)
    v_mfma_f32_16x16x32_bf16 v[216:219], v[76:79], a[152:155], v[216:219]
    v_mfma_f32_16x16x32_bf16 v[220:223], a[180:183], a[152:155], v[220:223]
    buffer_load_dwordx4 v[96:99], v20, s[48:51], s23 offen offset:0 sc1
    v_mfma_f32_16x16x32_bf16 v[224:227], a[184:187], a[152:155], v[224:227]
    ds_write_b128 v17, v[196:199] offset:5120
    v_mfma_f32_16x16x32_bf16 v[228:231], a[188:191], a[152:155], v[228:231]
    v_mfma_f32_16x16x32_bf16 v[232:235], a[192:195], a[152:155], v[232:235]
    v_mfma_f32_16x16x32_bf16 v[216:219], a[196:199], a[156:159], v[216:219]
    ds_write_b128 v17, v[200:203] offset:5184
    v_mfma_f32_16x16x32_bf16 v[220:223], a[200:203], a[156:159], v[220:223]
    v_mfma_f32_16x16x32_bf16 v[224:227], a[204:207], a[156:159], v[224:227]
    buffer_load_dwordx4 v[100:103], v20, s[48:51], s23 offen offset:1024 sc1
    v_mfma_f32_16x16x32_bf16 v[228:231], v[88:91], a[156:159], v[228:231]
    ds_write_b128 v17, v[204:207] offset:5248
    v_mfma_f32_16x16x32_bf16 v[232:235], v[92:95], a[156:159], v[232:235]
    v_mfma_f32_16x16x32_bf16 v[216:219], v[80:83], a[160:163], v[216:219]
    v_mfma_f32_16x16x32_bf16 v[220:223], v[84:87], a[160:163], v[220:223]
    ds_write_b128 v17, v[208:211] offset:5312
    v_mfma_f32_16x16x32_bf16 v[224:227], a[136:139], a[160:163], v[224:227]
    v_mfma_f32_16x16x32_bf16 v[228:231], a[140:143], a[160:163], v[228:231]
    buffer_load_dwordx4 v[104:107], v20, s[48:51], s23 offen offset:2048 sc1
    v_mfma_f32_16x16x32_bf16 v[232:235], a[144:147], a[160:163], v[232:235]
    ds_write_b128 v17, v[212:215] offset:5376
    s_waitcnt vmcnt(7)
    v_mfma_f32_16x16x32_bf16 v[236:239], v[76:79], a[224:227], v[236:239]
    v_mfma_f32_16x16x32_bf16 v[240:243], a[180:183], a[224:227], v[240:243]
    v_mfma_f32_16x16x32_bf16 v[244:247], a[184:187], a[224:227], v[244:247]
    ds_write_b128 v17, v[216:219] offset:10240
    v_mfma_f32_16x16x32_bf16 v[248:251], a[188:191], a[224:227], v[248:251]
    v_mfma_f32_16x16x32_bf16 v[252:255], a[192:195], a[224:227], v[252:255]
    buffer_load_dwordx2 v[108:109], v18, s[48:51], s23 offen offset:3072 sc1
    v_mfma_f32_16x16x32_bf16 v[236:239], a[196:199], a[228:231], v[236:239]
    ds_write_b128 v17, v[220:223] offset:10304
    v_mfma_f32_16x16x32_bf16 v[240:243], a[200:203], a[228:231], v[240:243]
    v_mfma_f32_16x16x32_bf16 v[244:247], a[204:207], a[228:231], v[244:247]
    v_mfma_f32_16x16x32_bf16 v[248:251], v[88:91], a[228:231], v[248:251]
    ds_write_b128 v17, v[224:227] offset:10368
    v_mfma_f32_16x16x32_bf16 v[252:255], v[92:95], a[228:231], v[252:255]
    v_mfma_f32_16x16x32_bf16 v[236:239], v[80:83], a[232:235], v[236:239]
    v_mfma_f32_16x16x32_bf16 v[240:243], v[84:87], a[232:235], v[240:243]
    ds_write_b128 v17, v[228:231] offset:10432
    v_mfma_f32_16x16x32_bf16 v[244:247], a[136:139], a[232:235], v[244:247]
    v_mfma_f32_16x16x32_bf16 v[248:251], a[140:143], a[232:235], v[248:251]
    v_mfma_f32_16x16x32_bf16 v[252:255], a[144:147], a[232:235], v[252:255]
    ds_write_b128 v17, v[232:235] offset:10496
    s_nop 7
    ds_write_b128 v17, v[236:239] offset:15360
    ds_write_b128 v17, v[240:243] offset:15424
    ds_write_b128 v17, v[244:247] offset:15488
    ds_write_b128 v17, v[248:251] offset:15552
    ds_write_b128 v17, v[252:255] offset:15616
    s_waitcnt vmcnt(0)
    v_bitop3_b32 v99, v99, v103, v26 bitop3:0x7e
    v_bitop3_b32 v107, v107, v109, v26 bitop3:0x7e
    v_or_b32 v99, v99, v107
    v_cmp_ne_u32 vcc, 0, v99
    s_nop 1
    s_cmp_lg_u64 vcc, 0
    s_cbranch_scc1 L_slow_45
L_ok_46:
    v_lshlrev_b32 v8, 16, v96
    v_and_b32 v9, 0xffff0000, v96
    v_add_f32 v28, v28, v8
    v_add_f32 v29, v29, v9
    v_lshlrev_b32 v8, 16, v97
    v_and_b32 v9, 0xffff0000, v97
    v_add_f32 v30, v30, v8
    v_add_f32 v31, v31, v9
    v_lshlrev_b32 v8, 16, v98
    v_and_b32 v9, 0xffff0000, v98
    v_add_f32 v32, v32, v8
    v_add_f32 v33, v33, v9
    v_lshlrev_b32 v8, 16, v100
    v_and_b32 v9, 0xffff0000, v100
    v_add_f32 v34, v34, v8
    v_add_f32 v35, v35, v9
    v_lshlrev_b32 v8, 16, v101
    v_and_b32 v9, 0xffff0000, v101
    v_add_f32 v36, v36, v8
    v_add_f32 v37, v37, v9
    v_lshlrev_b32 v8, 16, v102
    v_and_b32 v9, 0xffff0000, v102
    v_add_f32 v38, v38, v8
    v_add_f32 v39, v39, v9
    v_lshlrev_b32 v8, 16, v104
    v_and_b32 v9, 0xffff0000, v104
    v_add_f32 v40, v40, v8
    v_add_f32 v41, v41, v9
    v_lshlrev_b32 v8, 16, v105
    v_and_b32 v9, 0xffff0000, v105
    v_add_f32 v42, v42, v8
    v_add_f32 v43, v43, v9
    v_lshlrev_b32 v8, 16, v106
    v_and_b32 v9, 0xffff0000, v106
    v_add_f32 v44, v44, v8
    v_add_f32 v45, v45, v9
    v_lshlrev_b32 v8, 16, v108
    v_and_b32 v9, 0xffff0000, v108
    v_add_f32 v46, v46, v8
    v_add_f32 v47, v47, v9
    s_waitcnt lgkmcnt(0)
    s_barrier
    ds_read_b128 v[176:179], v15 offset:0
    ds_read_b128 v[180:183], v15 offset:20480
    ds_read_b128 v[184:187], v15 offset:40960
    ds_read_b128 v[188:191], v15 offset:61440
    ds_read_b128 v[192:195], v15 offset:64
    ds_read_b128 v[196:199], v15 offset:20544
    ds_read_b128 v[200:203], v15 offset:41024
    ds_read_b128 v[204:207], v15 offset:61504
    ds_read_b128 v[208:211], v15 offset:128
    ds_read_b128 v[212:215], v15 offset:20608
    ds_read_b128 v[216:219], v15 offset:41088
    ds_read_b128 v[220:223], v15 offset:61568
    s_waitcnt lgkmcnt(8)
    v_pk_add_f32 v[176:177], v[176:177], v[180:181]
    v_pk_add_f32 v[184:185], v[184:185], v[188:189]
    v_pk_add_f32 v[178:179], v[178:179], v[182:183]
    v_pk_add_f32 v[186:187], v[186:187], v[190:191]
    v_pk_add_f32 v[28:29], v[28:29], v[176:177]
    v_pk_add_f32 v[30:31], v[30:31], v[178:179]
    v_pk_add_f32 v[28:29], v[28:29], v[184:185]
    v_pk_add_f32 v[30:31], v[30:31], v[186:187]
    buffer_store_dwordx4 v[28:31], v16, s[52:55], s21 offen offset:0 nt
    ds_read_b128 v[224:227], v15 offset:192
    ds_read_b128 v[228:231], v15 offset:20672
    ds_read_b128 v[232:235], v15 offset:41152
    ds_read_b128 v[236:239], v15 offset:61632
    s_waitcnt lgkmcnt(8)
    v_pk_add_f32 v[192:193], v[192:193], v[196:197]
    v_pk_add_f32 v[200:201], v[200:201], v[204:205]
    v_pk_add_f32 v[194:195], v[194:195], v[198:199]
    v_pk_add_f32 v[202:203], v[202:203], v[206:207]
    v_pk_add_f32 v[32:33], v[32:33], v[192:193]
    v_pk_add_f32 v[34:35], v[34:35], v[194:195]
    v_pk_add_f32 v[32:33], v[32:33], v[200:201]
    v_pk_add_f32 v[34:35], v[34:35], v[202:203]
    buffer_store_dwordx4 v[32:35], v16, s[52:55], s21 offen offset:64 nt
    ds_read_b128 v[240:243], v15 offset:256
    ds_read_b128 v[244:247], v15 offset:20736
    ds_read_b128 v[248:251], v15 offset:41216
    ds_read_b128 v[252:255], v15 offset:61696
    s_waitcnt lgkmcnt(8)
    v_pk_add_f32 v[208:209], v[208:209], v[212:213]
    v_pk_add_f32 v[216:217], v[216:217], v[220:221]
    v_pk_add_f32 v[210:211], v[210:211], v[214:215]
    v_pk_add_f32 v[218:219], v[218:219], v[222:223]
    v_pk_add_f32 v[36:37], v[36:37], v[208:209]
    v_pk_add_f32 v[38:39], v[38:39], v[210:211]
    v_pk_add_f32 v[36:37], v[36:37], v[216:217]
    v_pk_add_f32 v[38:39], v[38:39], v[218:219]
    buffer_store_dwordx4 v[36:39], v16, s[52:55], s21 offen offset:128 nt
    s_waitcnt lgkmcnt(4)
    v_pk_add_f32 v[224:225], v[224:225], v[228:229]
    v_pk_add_f32 v[232:233], v[232:233], v[236:237]
    v_pk_add_f32 v[226:227], v[226:227], v[230:231]
    v_pk_add_f32 v[234:235], v[234:235], v[238:239]
    v_pk_add_f32 v[40:41], v[40:41], v[224:225]
    v_pk_add_f32 v[42:43], v[42:43], v[226:227]
    v_pk_add_f32 v[40:41], v[40:41], v[232:233]
    v_pk_add_f32 v[42:43], v[42:43], v[234:235]
    buffer_store_dwordx4 v[40:43], v16, s[52:55], s21 offen offset:192 nt
    s_waitcnt lgkmcnt(0)
    v_pk_add_f32 v[240:241], v[240:241], v[244:245]
    v_pk_add_f32 v[248:249], v[248:249], v[252:253]
    v_pk_add_f32 v[242:243], v[242:243], v[246:247]
    v_pk_add_f32 v[250:251], v[250:251], v[254:255]
    v_pk_add_f32 v[44:45], v[44:45], v[240:241]
    v_pk_add_f32 v[46:47], v[46:47], v[242:243]
    v_pk_add_f32 v[44:45], v[44:45], v[248:249]
    v_pk_add_f32 v[46:47], v[46:47], v[250:251]
    buffer_store_dwordx4 v[44:47], v16, s[52:55], s21 offen offset:256 nt
    s_endpgm
L_slow_4:
    s_mov_b32 s98, 0
L_slow_4_l:
    s_sleep 1
    buffer_load_dwordx2 v[212:213], v210, s[48:51], s80 offen sc1
    buffer_load_dwordx4 v[216:219], v20, s[48:51], s81 offen offset:0 sc1
    buffer_load_dwordx4 v[220:223], v20, s[48:51], s81 offen offset:1024 sc1
    s_waitcnt vmcnt(0)
    v_xor_b32 v214, v213, v26
    v_bitop3_b32 v215, v217, v219, v26 bitop3:0x7e
    v_or_b32 v214, v214, v215
    v_bitop3_b32 v215, v221, v223, v26 bitop3:0x7e
    v_or_b32 v214, v214, v215
    v_cmp_ne_u32 vcc, 0, v214
    s_add_u32 s98, s98, 1
    s_cmp_gt_u32 s98, 40000
    s_cbranch_scc1 L_ok_5
    s_cmp_lg_u64 vcc, 0
    s_cbranch_scc1 L_slow_4_l
    s_branch L_ok_5
L_slow_8:
    s_mov_b32 s98, 0
L_slow_8_l:
    s_sleep 1
    buffer_load_dwordx4 a[208:211], v20, s[48:51], s0 offen offset:0 sc1
    buffer_load_dwordx4 a[212:215], v20, s[48:51], s0 offen offset:1024 sc1
    buffer_load_dwordx4 a[216:219], v20, s[48:51], s0 offen offset:2048 sc1
    buffer_load_dwordx4 a[220:223], v20, s[48:51], s0 offen offset:3072 sc1
    s_waitcnt vmcnt(0)
    v_accvgpr_read_b32 v93, a209
    v_accvgpr_read_b32 v6, a211
    v_bitop3_b32 v4, v93, v6, v26 bitop3:0x7e
    v_accvgpr_read_b32 v93, a213
    v_accvgpr_read_b32 v6, a215
    v_bitop3_b32 v93, v93, v6, v26 bitop3:0x7e
    v_or_b32 v4, v4, v93
    v_accvgpr_read_b32 v93, a217
    v_accvgpr_read_b32 v6, a219
    v_bitop3_b32 v93, v93, v6, v26 bitop3:0x7e
    v_or_b32 v4, v4, v93
    v_accvgpr_read_b32 v93, a221
    v_accvgpr_read_b32 v6, a223
    v_bitop3_b32 v93, v93, v6, v26 bitop3:0x7e
    v_or_b32 v4, v4, v93
    v_cmp_ne_u32 vcc, 0, v4
    s_add_u32 s98, s98, 1
    s_cmp_gt_u32 s98, 40000
    s_cbranch_scc1 L_ok_9
    s_cmp_lg_u64 vcc, 0
    s_cbranch_scc1 L_slow_8_l
    s_branch L_ok_9
L_slow_10:
    s_mov_b32 s98, 0
L_slow_10_l:
    s_sleep 1
    buffer_load_dwordx4 v[64:67], v80, s[64:67], 0 offen sc1
    buffer_load_dwordx4 v[68:71], v81, s[64:67], 0 offen sc1
    buffer_load_dwordx4 v[72:75], v82, s[64:67], 0 offen sc1
    buffer_load_dwordx4 v[76:79], v83, s[64:67], 0 offen sc1
    buffer_load_dwordx4 v[44:47], v84, s[64:67], 0 offen sc1
    buffer_load_dwordx4 v[48:51], v85, s[64:67], 0 offen sc1
    buffer_load_dwordx4 v[52:55], v86, s[64:67], 0 offen sc1
    buffer_load_dwordx4 v[56:59], v87, s[64:67], 0 offen sc1
    s_waitcnt vmcnt(0)
    v_bitop3_b32 v65, v65, v67, v26 bitop3:0x7e
    v_bitop3_b32 v69, v69, v71, v26 bitop3:0x7e
    v_bitop3_b32 v73, v73, v75, v26 bitop3:0x7e
    v_bitop3_b32 v77, v77, v79, v26 bitop3:0x7e
    v_bitop3_b32 v45, v45, v47, v26 bitop3:0x7e
    v_bitop3_b32 v49, v49, v51, v26 bitop3:0x7e
    v_bitop3_b32 v53, v53, v55, v26 bitop3:0x7e
    v_bitop3_b32 v57, v57, v59, v26 bitop3:0x7e
    v_or3_b32 v65, v65, v69, v73
    v_or3_b32 v77, v77, v45, v49
    v_or3_b32 v65, v65, v53, v57
    v_or_b32 v65, v65, v77
    v_cmp_ne_u32 vcc, 0, v65
    s_add_u32 s98, s98, 1
    s_cmp_gt_u32 s98, 40000
    s_cbranch_scc1 L_ok_11
    s_cmp_lg_u64 vcc, 0
    s_cbranch_scc1 L_slow_10_l
    s_branch L_ok_11
L_slow_12:
    s_mov_b32 s98, 0
L_slow_12_l:
    s_add_u32 s98, s98, 1
    s_cmp_gt_u32 s98, 40000
    s_cbranch_scc1 L_ok_13
    s_sleep 1
    buffer_load_dword v90, v91, s[76:79], 0 offen offset:0 sc1
    s_waitcnt vmcnt(0)
    v_cmp_ne_u32 vcc, v90, v26
    s_nop 1
    s_cmp_lg_u64 vcc, 0
    s_cbranch_scc1 L_slow_12_l
    s_branch L_ok_13
L_slow_14:
    s_mov_b32 s98, 0
L_slow_14_l:
    s_add_u32 s98, s98, 1
    s_cmp_gt_u32 s98, 40000
    s_cbranch_scc1 L_ok_15
    s_sleep 1
    buffer_load_dword v5, v2, s[76:79], 0 offen offset:128 sc1
    s_waitcnt vmcnt(0)
    v_cmp_ne_u32 vcc, v5, v26
    s_nop 1
    s_and_b32 s34, vcc_lo, s28
    s_cbranch_scc1 L_slow_14_l
    s_branch L_ok_15
L_slow_16:
    s_mov_b32 s98, 0
L_slow_16_l:
    s_sleep 1
    buffer_load_dwordx4 a[224:227], v20, s[48:51], s1 offen offset:0 sc1
    buffer_load_dwordx4 a[228:231], v20, s[48:51], s1 offen offset:1024 sc1
    buffer_load_dwordx4 a[232:235], v20, s[48:51], s1 offen offset:2048 sc1
    buffer_load_dwordx4 a[236:239], v20, s[48:51], s1 offen offset:3072 sc1
    s_waitcnt vmcnt(0)
    v_accvgpr_read_b32 v93, a225
    v_accvgpr_read_b32 v6, a227
    v_bitop3_b32 v4, v93, v6, v26 bitop3:0x7e
    v_accvgpr_read_b32 v93, a229
    v_accvgpr_read_b32 v6, a231
    v_bitop3_b32 v93, v93, v6, v26 bitop3:0x7e
    v_or_b32 v4, v4, v93
    v_accvgpr_read_b32 v93, a233
    v_accvgpr_read_b32 v6, a235
    v_bitop3_b32 v93, v93, v6, v26 bitop3:0x7e
    v_or_b32 v4, v4, v93
    v_accvgpr_read_b32 v93, a237
    v_accvgpr_read_b32 v6, a239
    v_bitop3_b32 v93, v93, v6, v26 bitop3:0x7e
    v_or_b32 v4, v4, v93
    v_cmp_ne_u32 vcc, 0, v4
    s_add_u32 s98, s98, 1
    s_cmp_gt_u32 s98, 40000
    s_cbranch_scc1 L_ok_17
    s_cmp_lg_u64 vcc, 0
    s_cbranch_scc1 L_slow_16_l
    s_branch L_ok_17
L_slow_18:
    s_mov_b32 s98, 0
L_slow_18_l:
    s_add_u32 s98, s98, 1
    s_cmp_gt_u32 s98, 40000
    s_cbranch_scc1 L_ok_19
    s_sleep 1
    buffer_load_dword v5, v2, s[76:79], 0 offen offset:256 sc1
    s_waitcnt vmcnt(0)
    v_cmp_ne_u32 vcc, v5, v26
    s_nop 1
    s_and_b32 s34, vcc_lo, 0xffff
    s_cbranch_scc1 L_slow_18_l
    s_branch L_ok_19
L_slow_20:
    s_mov_b32 s98, 0
L_slow_20_l:
    s_add_u32 s98, s98, 1
    s_cmp_gt_u32 s98, 40000
    s_cbranch_scc1 L_ok_21
    s_sleep 1
    buffer_load_dword v5, v2, s[76:79], 0 offen offset:384 sc1
    s_waitcnt vmcnt(0)
    v_cmp_ne_u32 vcc, v5, v26
    s_nop 1
    s_and_b32 s34, vcc_lo, 0xffff
    s_cbranch_scc1 L_slow_20_l
    s_branch L_ok_21
L_slow_22:
    s_mov_b32 s98, 0
L_slow_22_l:
    s_sleep 1
    buffer_load_dwordx4 v[96:99], v20, s[48:51], s23 offen offset:0 sc1
    buffer_load_dwordx4 v[100:103], v20, s[48:51], s23 offen offset:1024 sc1
    buffer_load_dwordx4 v[104:107], v20, s[48:51], s23 offen offset:2048 sc1
    buffer_load_dwordx2 v[108:109], v18, s[48:51], s23 offen offset:3072 sc1
    s_waitcnt vmcnt(0)
    v_bitop3_b32 v99, v99, v103, v26 bitop3:0x7e
    v_bitop3_b32 v107, v107, v109, v26 bitop3:0x7e
    v_or_b32 v99, v99, v107
    v_cmp_ne_u32 vcc, 0, v99
    s_add_u32 s98, s98, 1
    s_cmp_gt_u32 s98, 40000
    s_cbranch_scc1 L_ok_23
    s_cmp_lg_u64 vcc, 0
    s_cbranch_scc1 L_slow_22_l
    s_branch L_ok_23
L_slow_27:
    s_mov_b32 s98, 0
L_slow_27_l:
    s_sleep 1
    buffer_load_dwordx2 v[212:213], v210, s[48:51], s80 offen sc1
    buffer_load_dwordx4 v[216:219], v20, s[48:51], s81 offen offset:0 sc1
    buffer_load_dwordx4 v[220:223], v20, s[48:51], s81 offen offset:1024 sc1
    buffer_load_dwordx4 v[224:227], v20, s[48:51], s81 offen offset:2048 sc1
    buffer_load_dwordx4 v[228:231], v20, s[48:51], s81 offen offset:3072 sc1
    s_waitcnt vmcnt(0)
    v_xor_b32 v214, v213, v26
    v_bitop3_b32 v215, v217, v219, v26 bitop3:0x7e
    v_or_b32 v214, v214, v215
    v_bitop3_b32 v215, v221, v223, v26 bitop3:0x7e
    v_or_b32 v214, v214, v215
    v_bitop3_b32 v215, v225, v227, v26 bitop3:0x7e
    v_or_b32 v214, v214, v215
    v_bitop3_b32 v215, v229, v231, v26 bitop3:0x7e
    v_or_b32 v214, v214, v215
    v_cmp_ne_u32 vcc, 0, v214
    s_add_u32 s98, s98, 1
    s_cmp_gt_u32 s98, 40000
    s_cbranch_scc1 L_ok_28
    s_cmp_lg_u64 vcc, 0
    s_cbranch_scc1 L_slow_27_l
    s_branch L_ok_28
L_slow_31:
    s_mov_b32 s98, 0
L_slow_31_l:
    s_add_u32 s98, s98, 1
    s_cmp_gt_u32 s98, 40000
    s_cbranch_scc1 L_ok_32
    s_sleep 1
    buffer_load_dword v90, v91, s[76:79], 0 offen offset:0 sc1
    s_waitcnt vmcnt(0)
    v_cmp_ne_u32 vcc, v90, v26
    s_nop 1
    s_cmp_lg_u64 vcc, 0
    s_cbranch_scc1 L_slow_31_l
    s_branch L_ok_32
L_slow_33:
    s_mov_b32 s98, 0
L_slow_33_l:
    s_sleep 1
    buffer_load_dwordx4 v[160:163], v80, s[64:67], 0 offen sc1
    buffer_load_dwordx4 v[164:167], v81, s[64:67], 0 offen sc1
    buffer_load_dwordx4 v[168:171], v82, s[64:67], 0 offen sc1
    buffer_load_dwordx4 v[172:175], v83, s[64:67], 0 offen sc1
    buffer_load_dwordx4 v[176:179], v84, s[64:67], 0 offen sc1
    buffer_load_dwordx4 v[180:183], v85, s[64:67], 0 offen sc1
    buffer_load_dwordx4 v[184:187], v86, s[64:67], 0 offen sc1
    buffer_load_dwordx4 v[188:191], v87, s[64:67], 0 offen sc1
    s_waitcnt vmcnt(0)
    v_bitop3_b32 v161, v161, v163, v26 bitop3:0x7e
    v_bitop3_b32 v165, v165, v167, v26 bitop3:0x7e
    v_bitop3_b32 v169, v169, v171, v26 bitop3:0x7e
    v_bitop3_b32 v173, v173, v175, v26 bitop3:0x7e
    v_bitop3_b32 v177, v177, v179, v26 bitop3:0x7e
    v_bitop3_b32 v181, v181, v183, v26 bitop3:0x7e
    v_bitop3_b32 v185, v185, v187, v26 bitop3:0x7e
    v_bitop3_b32 v189, v189, v191, v26 bitop3:0x7e
    v_or3_b32 v161, v161, v165, v169
    v_or3_b32 v173, v173, v177, v181
    v_or3_b32 v161, v161, v185, v189
    v_or_b32 v161, v161, v173
    v_cmp_ne_u32 vcc, 0, v161
    s_add_u32 s98, s98, 1
    s_cmp_gt_u32 s98, 40000
    s_cbranch_scc1 L_ok_34
    s_cmp_lg_u64 vcc, 0
    s_cbranch_scc1 L_slow_33_l
    s_branch L_ok_34
L_slow_35:
    s_mov_b32 s98, 0
L_slow_35_l:
    s_sleep 1
    buffer_load_dwordx4 a[208:211], v20, s[48:51], s0 offen offset:0 sc1
    buffer_load_dwordx4 a[212:215], v20, s[48:51], s0 offen offset:1024 sc1
    buffer_load_dwordx4 a[216:219], v20, s[48:51], s0 offen offset:2048 sc1
    buffer_load_dwordx4 a[220:223], v20, s[48:51], s0 offen offset:3072 sc1
    s_waitcnt vmcnt(0)
    v_accvgpr_read_b32 v93, a209
    v_accvgpr_read_b32 v6, a211
    v_bitop3_b32 v4, v93, v6, v26 bitop3:0x7e
    v_accvgpr_read_b32 v93, a213
    v_accvgpr_read_b32 v6, a215
    v_bitop3_b32 v93, v93, v6, v26 bitop3:0x7e
    v_or_b32 v4, v4, v93
    v_accvgpr_read_b32 v93, a217
    v_accvgpr_read_b32 v6, a219
    v_bitop3_b32 v93, v93, v6, v26 bitop3:0x7e
    v_or_b32 v4, v4, v93
    v_accvgpr_read_b32 v93, a221
    v_accvgpr_read_b32 v6, a223
    v_bitop3_b32 v93, v93, v6, v26 bitop3:0x7e
    v_or_b32 v4, v4, v93
    v_cmp_ne_u32 vcc, 0, v4
    s_add_u32 s98, s98, 1
    s_cmp_gt_u32 s98, 40000
    s_cbranch_scc1 L_ok_36
    s_cmp_lg_u64 vcc, 0
    s_cbranch_scc1 L_slow_35_l
    s_branch L_ok_36
L_slow_37:
    s_mov_b32 s98, 0
L_slow_37_l:
    s_sleep 1
    buffer_load_dwordx4 v[96:99], v80, s[68:71], 0 offen sc1
    buffer_load_dwordx4 v[100:103], v81, s[68:71], 0 offen sc1
    buffer_load_dwordx4 v[104:107], v82, s[68:71], 0 offen sc1
    buffer_load_dwordx4 v[108:111], v83, s[68:71], 0 offen sc1
    buffer_load_dwordx4 v[112:115], v84, s[68:71], 0 offen sc1
    buffer_load_dwordx4 v[116:119], v85, s[68:71], 0 offen sc1
    buffer_load_dwordx4 v[120:123], v86, s[68:71], 0 offen sc1
    buffer_load_dwordx4 v[124:127], v87, s[68:71], 0 offen sc1
    s_waitcnt vmcnt(0)
    v_bitop3_b32 v97, v97, v99, v26 bitop3:0x7e
    v_bitop3_b32 v101, v101, v103, v26 bitop3:0x7e
    v_bitop3_b32 v105, v105, v107, v26 bitop3:0x7e
    v_bitop3_b32 v109, v109, v111, v26 bitop3:0x7e
    v_bitop3_b32 v113, v113, v115, v26 bitop3:0x7e
    v_bitop3_b32 v117, v117, v119, v26 bitop3:0x7e
    v_bitop3_b32 v121, v121, v123, v26 bitop3:0x7e
    v_bitop3_b32 v125, v125, v127, v26 bitop3:0x7e
    v_or3_b32 v97, v97, v101, v105
    v_or3_b32 v109, v109, v113, v117
    v_or3_b32 v97, v97, v121, v125
    v_or_b32 v97, v97, v109
    v_cmp_ne_u32 vcc, 0, v97
    s_add_u32 s98, s98, 1
    s_cmp_gt_u32 s98, 40000
    s_cbranch_scc1 L_ok_38
    s_cmp_lg_u64 vcc, 0
    s_cbranch_scc1 L_slow_37_l
    s_branch L_ok_38
L_slow_39:
    s_mov_b32 s98, 0
L_slow_39_l:
    s_add_u32 s98, s98, 1
    s_cmp_gt_u32 s98, 40000
    s_cbranch_scc1 L_ok_40
    s_sleep 1
    buffer_load_dword v5, v2, s[76:79], 0 offen offset:128 sc1
    s_waitcnt vmcnt(0)
    v_cmp_ne_u32 vcc, v5, v26
    s_nop 1
    s_and_b32 s34, vcc_lo, s28
    s_cbranch_scc1 L_slow_39_l
    s_branch L_ok_40
L_slow_41:
    s_mov_b32 s98, 0
L_slow_41_l:
    s_add_u32 s98, s98, 1
    s_cmp_gt_u32 s98, 40000
    s_cbranch_scc1 L_ok_42
    s_sleep 1
    buffer_load_dword v5, v2, s[76:79], 0 offen offset:256 sc1
    s_waitcnt vmcnt(0)
    v_cmp_ne_u32 vcc, v5, v26
    s_nop 1
    s_and_b32 s34, vcc_lo, 0xffff
    s_cbranch_scc1 L_slow_41_l
    s_branch L_ok_42
L_slow_43:
    s_mov_b32 s98, 0
L_slow_43_l:
    s_add_u32 s98, s98, 1
    s_cmp_gt_u32 s98, 40000
    s_cbranch_scc1 L_ok_44
    s_sleep 1
    buffer_load_dword v5, v2, s[76:79], 0 offen offset:384 sc1
    s_waitcnt vmcnt(0)
    v_cmp_ne_u32 vcc, v5, v26
    s_nop 1
    s_and_b32 s34, vcc_lo, 0xffff
    s_cbranch_scc1 L_slow_43_l
    s_branch L_ok_44
L_slow_45:
    s_mov_b32 s98, 0
L_slow_45_l:
    s_sleep 1
    buffer_load_dwordx4 v[96:99], v20, s[48:51], s23 offen offset:0 sc1
    buffer_load_dwordx4 v[100:103], v20, s[48:51], s23 offen offset:1024 sc1
    buffer_load_dwordx4 v[104:107], v20, s[48:51], s23 offen offset:2048 sc1
    buffer_load_dwordx2 v[108:109], v18, s[48:51], s23 offen offset:3072 sc1
    s_waitcnt vmcnt(0)
    v_bitop3_b32 v99, v99, v103, v26 bitop3:0x7e
    v_bitop3_b32 v107, v107, v109, v26 bitop3:0x7e
    v_or_b32 v99, v99, v107
    v_cmp_ne_u32 vcc, 0, v99
    s_add_u32 s98, s98, 1
    s_cmp_gt_u32 s98, 40000
    s_cbranch_scc1 L_ok_46
    s_cmp_lg_u64 vcc, 0
    s_cbranch_scc1 L_slow_45_l
    s_branch L_ok_46
L_end:
    s_endpgm
    s_endpgm
    s_endpgm
    s_endpgm
    s_endpgm
    s_endpgm
    s_endpgm
    s_endpgm
    s_endpgm
    s_endpgm
    s_endpgm
    s_endpgm
    s_endpgm
    s_endpgm
    s_endpgm
    s_endpgm
    s_endpgm
    s_endpgm
    s_endpgm
    s_endpgm
    s_endpgm
    s_endpgm
    s_endpgm
    s_endpgm
    s_endpgm
    s_endpgm
    s_endpgm
    s_endpgm
    s_endpgm
    s_endpgm
    s_endpgm
    s_endpgm
    s_endpgm
    s_endpgm
    s_endpgm
    s_endpgm
    s_endpgm
    s_endpgm
    s_endpgm
    s_endpgm
    s_endpgm
    s_endpgm
    s_endpgm
    s_endpgm
    s_endpgm
    s_endpgm
    s_endpgm
    s_endpgm
    s_endpgm
    s_endpgm
    s_endpgm
    s_endpgm
    s_endpgm
    s_endpgm
    s_endpgm
    s_endpgm
    s_endpgm
    s_endpgm
    s_endpgm
    s_endpgm
    s_endpgm
    s_endpgm
    s_endpgm
    s_endpgm
    s_endpgm
    s_endpgm
    s_endpgm
    s_endpgm
    s_endpgm
    s_endpgm
    s_endpgm
    s_endpgm
    s_endpgm
    s_endpgm
    s_endpgm
    s_endpgm
    s_endpgm
    s_endpgm
    s_endpgm
    s_endpgm
    s_endpgm
    s_endpgm
    s_endpgm
    s_endpgm
    s_endpgm
    s_endpgm
    s_endpgm
    s_endpgm
    s_endpgm
    s_endpgm
    s_endpgm
    s_endpgm
    s_endpgm
    s_endpgm
    s_endpgm
    s_endpgm
    s_endpgm
    s_endpgm
    s_endpgm
    s_endpgm
    s_endpgm
    s_endpgm
    s_endpgm
    s_endpgm
    s_endpgm
    s_endpgm
    s_endpgm
    s_endpgm
    s_endpgm
    s_endpgm
    s_endpgm
    s_endpgm
    s_endpgm
    s_endpgm
    s_endpgm
    s_endpgm
    s_endpgm
    s_endpgm
    s_endpgm
    s_endpgm
    s_endpgm
    s_endpgm
    s_endpgm
    s_endpgm
    s_endpgm
    s_endpgm
    s_endpgm
    s_endpgm
    s_endpgm
    s_endpgm
    s_endpgm
    s_endpgm
    s_endpgm
    s_endpgm
    s_endpgm
    s_endpgm
    s_endpgm
    s_endpgm
    s_endpgm
    s_endpgm
    s_endpgm
    s_endpgm
    s_endpgm
    s_endpgm
    s_endpgm
    s_endpgm
    s_endpgm
    s_endpgm
    s_endpgm
    s_endpgm
    s_endpgm
    s_endpgm
    s_endpgm
    s_endpgm
    s_endpgm
    s_endpgm
    s_endpgm
    s_endpgm
    s_endpgm
    s_endpgm
    s_endpgm
    s_endpgm
    s_endpgm
    s_endpgm
    s_endpgm
    s_endpgm
    s_endpgm
    s_endpgm
    s_endpgm
    s_endpgm
    s_endpgm
    s_endpgm
    s_endpgm
    s_endpgm
    s_endpgm
    s_endpgm
    s_endpgm
    s_endpgm
    s_endpgm
    s_endpgm
    s_endpgm
    s_endpgm
    s_endpgm
    s_endpgm
    s_endpgm
    s_endpgm
    s_endpgm
    s_endpgm
    s_endpgm
    s_endpgm
    s_endpgm
    s_endpgm
    s_endpgm
    s_endpgm
    s_endpgm
    s_endpgm
    s_endpgm
    s_endpgm
    s_endpgm
    s_endpgm
    s_endpgm
    s_endpgm
    s_endpgm
    s_endpgm
    s_endpgm
    s_endpgm
    s_endpgm
    s_endpgm
    s_endpgm
    s_endpgm
    s_endpgm
    s_endpgm
    s_endpgm
    s_endpgm
    s_endpgm
    s_endpgm
    s_endpgm
    s_endpgm
    s_endpgm
    s_endpgm
    s_endpgm
    s_endpgm
    s_endpgm
    s_endpgm
    s_endpgm
    s_endpgm
    s_endpgm
    s_endpgm
    s_endpgm
    s_endpgm
    s_endpgm
    s_endpgm
    s_endpgm
    s_endpgm
    s_endpgm
    s_endpgm
    s_endpgm
    s_endpgm
    s_endpgm
    s_endpgm
    s_endpgm
    s_endpgm
    s_endpgm
    s_endpgm
    s_endpgm
    s_endpgm
    s_endpgm
    s_endpgm
    s_endpgm
    s_endpgm
    s_endpgm
    s_endpgm
    s_endpgm
    s_endpgm
    s_endpgm
    s_endpgm
    s_endpgm
    s_endpgm
    s_endpgm
    s_endpgm
    s_endpgm
    s_endpgm
    s_endpgm
    s_endpgm
    s_endpgm
    s_endpgm
    s_endpgm
    s_endpgm
    s_endpgm
    s_endpgm
    s_endpgm
    s_endpgm
    s_endpgm
    s_endpgm
    s_endpgm
    s_endpgm
    s_endpgm
    s_endpgm
    s_endpgm
    s_endpgm
    s_endpgm
    s_endpgm
    s_endpgm
    s_endpgm
    s_endpgm
    s_endpgm
    s_endpgm
    s_endpgm
    s_endpgm
    s_endpgm
    s_endpgm
    s_endpgm
    s_endpgm
    s_endpgm
    s_endpgm
    s_endpgm
    s_endpgm
    s_endpgm
    s_endpgm
    s_endpgm
    s_endpgm
    s_endpgm
    s_endpgm
    s_endpgm
    s_endpgm
    s_endpgm
    s_endpgm
    s_endpgm
    s_endpgm
    s_endpgm
    s_endpgm
    s_endpgm
    s_endpgm
    s_endpgm
    s_endpgm
    s_endpgm
    s_endpgm
    s_endpgm
    s_endpgm
    s_endpgm
    s_endpgm
.section .rodata,"a"
.p2align 6
.amdhsa_kernel parallel_sum__ssm_conv_s5__glu_gated_glu__prompt_kernel
  .amdhsa_next_free_vgpr 512
  .amdhsa_next_free_sgpr 102
  .amdhsa_accum_offset 256
  .amdhsa_group_segment_fixed_size 0
  .amdhsa_kernarg_size 128
  .amdhsa_user_sgpr_count 2
  .amdhsa_user_sgpr_kernarg_segment_ptr 1
  .amdhsa_system_sgpr_workgroup_id_x 1
.end_amdhsa_kernel
```
